```python
import torch

def _softmax(x, axis=-1):
    return torch.softmax(x, dim=axis)
def _gelu(x):
    return torch.nn.functional.gelu(x, approximate="tanh")
def _silu(x):
    return torch.nn.functional.silu(x)
def _sigmoid(x):
    return torch.sigmoid(x)
def _layernorm(x, axis=-1, eps=1e-5):
    m = x.mean(dim=axis, keepdim=True)
    v = x.var(dim=axis, keepdim=True, unbiased=False)
    return (x - m) / torch.sqrt(v + eps)
def _scatter_add(tgt, idx, src, axis=0):
    return tgt.clone().index_add_(axis, idx, src)
def _segment_sum(src, seg, n):
    out = torch.zeros((n,) + src.shape[1:], dtype=src.dtype)
    return out.index_add_(0, seg, src)
def _pad(x, pw):
    flat = tuple(v for pair in reversed(pw) for v in pair)
    return torch.nn.functional.pad(x, flat)

kernel_name = 'parallel_sum__mha_block_cached__swiglu_ffn__decode'

def setup_inputs():

    _w = (lambda a: (lambda t: t.to(torch.bfloat16) if t.is_floating_point() else t)(torch.as_tensor(a)))
    def _A_setup():
        B, Sq, D = 4, 1, 640
        H, Sk, Dh = 32, 4096, 128
        return {
            "x": _w((lambda *s: torch.randn(*s, dtype=torch.bfloat16) * 0.05)(B, Sq, D)),
            "k_cache": _w((lambda *s: torch.randn(*s, dtype=torch.bfloat16) * 3.2)(B, H, Sk, Dh)),
            "v_cache": _w((lambda *s: torch.randn(*s, dtype=torch.bfloat16) * 1.6)(B, H, Sk, Dh)),
            "wq": _w((lambda *s: torch.randn(*s, dtype=torch.bfloat16) * 3.2)(D, H * Dh) * (D ** -0.5)),
            "wo": _w((lambda *s: torch.randn(*s, dtype=torch.bfloat16) * 1.6)(H * Dh, D) * ((H * Dh) ** -0.5)),
        }
    _A_in = _A_setup()

    def _B_setup():
        B, S, D, F = 4, 1, 640, 1728
        return {
            "x": _w((lambda *s: torch.randn(*s, dtype=torch.bfloat16) * 0.05)(B, S, D)),
            "w_gate": _w((lambda *s: torch.randn(*s, dtype=torch.bfloat16) * 0.05)(D, F)),
            "w_up": _w((lambda *s: torch.randn(*s, dtype=torch.bfloat16) * 0.05)(D, F)),
            "w_down": _w((lambda *s: torch.randn(*s, dtype=torch.bfloat16) * 0.05)(F, D)),
        }
    _B_in = _B_setup()

    return {
        "A_x": _A_in["x"],
        "A_k_cache": _A_in["k_cache"],
        "A_v_cache": _A_in["v_cache"],
        "A_wq": _A_in["wq"],
        "A_wo": _A_in["wo"],
        "B_x": _B_in["x"],
        "B_w_gate": _B_in["w_gate"],
        "B_w_up": _B_in["w_up"],
        "B_w_down": _B_in["w_down"],
    }

def reference(A_x, A_k_cache, A_v_cache, A_wq, A_wo, B_x, B_w_gate, B_w_up, B_w_down):
    def _A_ref(x, k_cache, v_cache, wq, wo):
        B, Sq, D = x.shape
        H, Dh = 32, 128
        q = (lambda x, *d: x.permute(*d))((x @ wq).reshape(B, Sq, H, Dh), 0, 2, 1, 3)
        scores = torch.einsum("bhqd,bhkd->bhqk", q, k_cache) * (Dh ** -0.5)
        p = _softmax(scores, axis=-1)
        o = torch.einsum("bhqk,bhkd->bhqd", p, v_cache)
        return (lambda x, *d: x.permute(*d))(o, 0, 2, 1, 3).reshape(B, Sq, H * Dh) @ wo

    def _B_ref(x, w_gate, w_up, w_down):
        g = _silu(x @ w_gate)
        u = x @ w_up
        return (g * u) @ w_down

    x = A_x
    xn = _layernorm(x, axis=-1)
    return x + _A_ref(xn, A_k_cache, A_v_cache, A_wq, A_wo) + _B_ref(xn, B_w_gate, B_w_up, B_w_down)
```

```asm
; @launch grid=(256,1,1) block=(256,1,1) lds=21760
.amdgcn_target "amdgcn-amd-amdhsa--gfx950"
.text
.globl parallel_sum__mha_block_cached__swiglu_ffn__decode_kernel
.p2align 8
.type parallel_sum__mha_block_cached__swiglu_ffn__decode_kernel,@function
parallel_sum__mha_block_cached__swiglu_ffn__decode_kernel:
    s_load_dwordx2 s[8:9], s[0:1], 8
    s_load_dwordx2 s[16:17], s[0:1], 24
    s_load_dwordx2 s[4:5], s[0:1], 0
    s_cmp_ge_u32 s2, 256
    s_cbranch_scc1 L_end
    v_and_b32 v10, 12, v0
    v_lshlrev_b32 v4, 6, v10
    v_bfe_u32 v2, v0, 4, 2
    v_lshl_add_u32 v4, v2, 6, v4
    v_and_b32 v12, 3, v0
    v_lshl_add_u32 v4, v12, 4, v4
    v_lshrrev_b32 v11, 6, v0
    s_and_b32 s47, s2, 7
    s_lshl_b32 s47, s47, 2
    s_bfe_u32 s3, s2, 0x20003
    s_add_u32 s47, s47, s3
    v_readfirstlane_b32 s46, v11
    s_lshr_b32 s48, s2, 6
    s_bfe_u32 s49, s2, 0x10005
    s_mov_b32 s89, 0x7500
    s_bitcmp1_b32 s89, s2
    s_cselect_b32 s90, 32, 28
    s_mul_i32 s3, s90, s49
    s_lshl_b32 s51, s48, 5
    s_add_u32 s51, s51, s47
    s_lshl_b32 s51, s51, 6
    s_add_u32 s51, s51, s3
    s_lshl_b32 s51, s51, 2
    s_add_u32 s51, s51, s46
    s_lshl_b32 s51, s51, 12
    s_brev_b32 s10, 16
    s_mov_b32 s11, 0x20000
    s_waitcnt lgkmcnt(0)
    s_add_u32 s56, s51, 0
    buffer_load_dwordx4 a[0:3], v4, s[8:11], s56 offen offset:0 nt
    buffer_load_dwordx4 a[4:7], v4, s[8:11], s56 offen offset:1024 nt
    v_and_b32 v3, 15, v0
    v_lshrrev_b32 v10, 3, v3
    v_lshl_add_u32 v10, v10, 2, v2
    v_and_b32 v11, 7, v0
    v_lshlrev_b32 v12, 4, v11
    v_lshl_add_u32 v6, v10, 13, v12
    s_mul_i32 s52, s46, 1310720
    s_lshl_b32 s3, s47, 8
    s_add_u32 s52, s52, s3
    s_mov_b32 s18, 5242880
    s_mov_b32 s19, s11
    s_add_u32 s57, s52, 0
    buffer_load_dwordx4 a[8:11], v6, s[16:19], s57 offen offset:0 nt
    buffer_load_dwordx4 a[12:15], v4, s[8:11], s56 offen offset:2048 nt
    v_and_b32 v1, 63, v0
    v_lshlrev_b32 v154, 2, v1
    v_lshl_add_u32 v155, v11, 3, v10
    v_lshlrev_b32 v155, 1, v155
    s_mul_i32 s68, s48, 1280
    s_mul_i32 s3, s46, 320
    s_add_u32 s88, s68, s3
    s_movk_i32 s6, 5120
    s_mov_b32 s7, s11
    buffer_load_dword v140, v154, s[4:7], s68 offen offset:0
    buffer_load_dword v141, v154, s[4:7], s68 offen offset:256
    buffer_load_dword v142, v154, s[4:7], s68 offen offset:512
    buffer_load_dword v143, v154, s[4:7], s68 offen offset:768
    buffer_load_dword v144, v154, s[4:7], s68 offen offset:1024
    buffer_load_ushort v32, v155, s[4:7], s88 offen offset:0
    buffer_load_ushort v33, v155, s[4:7], s88 offen offset:128
    buffer_load_ushort v34, v155, s[4:7], s88 offen offset:256
    v_mul_u32_u24 v7, 3456, v10
    v_add_u32 v7, v7, v12
    s_load_dwordx2 s[12:13], s[0:1], 16
    s_load_dwordx2 s[20:21], s[0:1], 32
    s_load_dwordx2 s[24:25], s[0:1], 48
    s_load_dwordx2 s[28:29], s[0:1], 56
    s_load_dwordx2 s[32:33], s[0:1], 64
    s_load_dwordx2 s[36:37], s[0:1], 88
    s_load_dwordx2 s[40:41], s[0:1], 72
    buffer_load_dwordx4 a[16:19], v6, s[16:19], s57 offen offset:128 nt
    buffer_load_dwordx4 a[20:23], v4, s[8:11], s56 offen offset:3072 nt
    s_add_u32 s57, s52, 65536
    buffer_load_dwordx4 a[24:27], v6, s[16:19], s57 offen offset:0 nt
    s_add_u32 s56, s51, 16384
    buffer_load_dwordx4 a[28:31], v4, s[8:11], s56 offen offset:0 nt
    buffer_load_dwordx4 a[32:35], v6, s[16:19], s57 offen offset:128 nt
    s_mov_b32 s14, 134217728
    s_mov_b32 s15, 0x20000
    s_mov_b32 s22, 5242880
    s_mov_b32 s23, 0x20000
    s_mov_b32 s26, 2211840
    s_mov_b32 s27, 0x20000
    s_mov_b32 s30, 2211840
    s_mov_b32 s31, 0x20000
    s_mov_b32 s34, 2211840
    s_mov_b32 s35, 0x20000
    s_mov_b32 s38, 672256
    s_mov_b32 s39, 0x20000
    s_mov_b32 s42, 5120
    s_mov_b32 s43, 0x20000
    v_and_b32 v10, 1, v3
    v_lshlrev_b32 v10, 4, v10
    v_mov_b32 v12, 0xffff
    v_lshlrev_b32 v12, v10, v12
    v_bfe_u32 v10, v3, 1, 2
    v_cmp_eq_u32 vcc, 0, v10
    s_nop 1
    v_cndmask_b32 v28, 0, v12, vcc
    v_cmp_eq_u32 vcc, 1, v10
    s_nop 1
    v_cndmask_b32 v29, 0, v12, vcc
    v_cmp_eq_u32 vcc, 2, v10
    s_nop 1
    v_cndmask_b32 v30, 0, v12, vcc
    v_cmp_eq_u32 vcc, 3, v10
    s_nop 1
    v_cndmask_b32 v31, 0, v12, vcc
    s_mov_b32 s60, 0x3fb8aa3b
    buffer_load_dwordx4 a[36:39], v4, s[8:11], s56 offen offset:1024 nt
    s_add_u32 s57, s52, 131072
    buffer_load_dwordx4 a[40:43], v6, s[16:19], s57 offen offset:0 nt
    buffer_load_dwordx4 a[44:47], v4, s[8:11], s56 offen offset:2048 nt
    buffer_load_dwordx4 a[48:51], v6, s[16:19], s57 offen offset:128 nt
    buffer_load_dwordx4 a[52:55], v4, s[8:11], s56 offen offset:3072 nt
    s_waitcnt vmcnt(13)
    v_lshlrev_b32 v48, 16, v140
    v_and_b32 v49, 0xffff0000, v140
    v_lshlrev_b32 v50, 16, v141
    v_and_b32 v51, 0xffff0000, v141
    v_lshlrev_b32 v52, 16, v142
    v_and_b32 v53, 0xffff0000, v142
    v_lshlrev_b32 v54, 16, v143
    v_and_b32 v55, 0xffff0000, v143
    v_lshlrev_b32 v56, 16, v144
    v_and_b32 v57, 0xffff0000, v144
    v_add_f32 v10, v48, v49
    v_add_f32 v10, v10, v50
    v_add_f32 v10, v10, v51
    v_add_f32 v10, v10, v52
    v_add_f32 v10, v10, v53
    v_add_f32 v10, v10, v54
    v_add_f32 v10, v10, v55
    v_add_f32 v10, v10, v56
    v_add_f32 v10, v10, v57
    s_nop 1
    v_add_f32_dpp v10, v10, v10 quad_perm:[1,0,3,2] row_mask:0xf bank_mask:0xf
    s_nop 1
    v_add_f32_dpp v10, v10, v10 quad_perm:[2,3,0,1] row_mask:0xf bank_mask:0xf
    s_nop 1
    v_add_f32_dpp v10, v10, v10 row_half_mirror row_mask:0xf bank_mask:0xf
    s_nop 1
    v_add_f32_dpp v10, v10, v10 row_mirror row_mask:0xf bank_mask:0xf
    s_nop 1
    v_add_f32_dpp v10, v10, v10 row_bcast:15 row_mask:0xa bank_mask:0xf
    s_nop 1
    v_add_f32_dpp v10, v10, v10 row_bcast:31 row_mask:0xc bank_mask:0xf
    s_nop 0
    v_readlane_b32 s88, v10, 63
    s_add_u32 s57, s52, 196608
    buffer_load_dwordx4 a[56:59], v6, s[16:19], s57 offen offset:0 nt
    v_mov_b32 v148, 0x3acccccd
    v_mul_f32 v148, s88, v148
    v_sub_f32 v48, v48, v148
    v_sub_f32 v49, v49, v148
    v_sub_f32 v50, v50, v148
    v_sub_f32 v51, v51, v148
    v_sub_f32 v52, v52, v148
    v_sub_f32 v53, v53, v148
    v_sub_f32 v54, v54, v148
    v_sub_f32 v55, v55, v148
    v_sub_f32 v56, v56, v148
    v_sub_f32 v57, v57, v148
    v_mul_f32 v10, v48, v48
    v_fmac_f32 v10, v49, v49
    v_fmac_f32 v10, v50, v50
    v_fmac_f32 v10, v51, v51
    v_fmac_f32 v10, v52, v52
    v_fmac_f32 v10, v53, v53
    v_fmac_f32 v10, v54, v54
    v_fmac_f32 v10, v55, v55
    v_fmac_f32 v10, v56, v56
    v_fmac_f32 v10, v57, v57
    s_nop 1
    v_add_f32_dpp v10, v10, v10 quad_perm:[1,0,3,2] row_mask:0xf bank_mask:0xf
    s_nop 1
    v_add_f32_dpp v10, v10, v10 quad_perm:[2,3,0,1] row_mask:0xf bank_mask:0xf
    s_nop 1
    v_add_f32_dpp v10, v10, v10 row_half_mirror row_mask:0xf bank_mask:0xf
    s_nop 1
    v_add_f32_dpp v10, v10, v10 row_mirror row_mask:0xf bank_mask:0xf
    s_nop 1
    v_add_f32_dpp v10, v10, v10 row_bcast:15 row_mask:0xa bank_mask:0xf
    s_nop 1
    v_add_f32_dpp v10, v10, v10 row_bcast:31 row_mask:0xc bank_mask:0xf
    s_nop 0
    v_readlane_b32 s88, v10, 63
    s_add_u32 s56, s51, 32768
    buffer_load_dwordx4 a[60:63], v4, s[8:11], s56 offen offset:0 nt
    v_mov_b32 v149, 0x3acccccd
    v_mul_f32 v149, s88, v149
    v_cvt_pk_bf16_f32 v149, 0, v149
    v_add_f32 v149, 0x3727c5ac, v149
    v_cvt_pk_bf16_f32 v149, 0, v149
    v_sqrt_f32 v149, v149
    v_cvt_pk_bf16_f32 v148, 0, v148
    v_cvt_pk_bf16_f32 v149, 0, v149
    v_rcp_f32 v150, v149
    s_waitcnt vmcnt(12)
    v_lshlrev_b32 v32, 16, v32
    v_sub_f32 v32, v32, v148
    v_cvt_pk_bf16_f32 v32, 0, v32
    v_mul_f32 v10, v32, v150
    v_fma_f32 v11, -v10, v149, v32
    v_fma_f32 v10, v11, v150, v10
    v_cvt_pk_bf16_f32 v32, v10, v10
    v_lshlrev_b32 v33, 16, v33
    v_sub_f32 v33, v33, v148
    v_cvt_pk_bf16_f32 v33, 0, v33
    v_mul_f32 v10, v33, v150
    v_fma_f32 v11, -v10, v149, v33
    v_fma_f32 v10, v11, v150, v10
    v_cvt_pk_bf16_f32 v33, v10, v10
    v_lshlrev_b32 v34, 16, v34
    v_sub_f32 v34, v34, v148
    v_cvt_pk_bf16_f32 v34, 0, v34
    v_mul_f32 v10, v34, v150
    v_fma_f32 v11, -v10, v149, v34
    v_fma_f32 v10, v11, v150, v10
    v_cvt_pk_bf16_f32 v34, v10, v10
    buffer_load_dwordx4 a[64:67], v6, s[16:19], s57 offen offset:128 nt
    s_lshl_b32 s67, s48, 7
    s_add_u32 s67, s67, 671744
    s_waitcnt lgkmcnt(0)
    s_load_dwordx2 s[44:45], s[36:37], s67
    s_and_b32 s50, s2, 31
    s_lshl_b32 s3, 1, s50
    s_sub_u32 s3, s3, 1
    s_and_b32 s3, s3, 0x7500
    s_bcnt1_i32_b32 s3, s3
    s_mov_b32 s88, 0x7500
    s_sub_u32 s3, s50, s3
    s_bitcmp1_b32 s88, s50
    s_cselect_b32 s50, 31, s3
    v_lshlrev_b32 v5, 4, v1
    v_mul_u32_u24 v8, 10240, v2
    v_lshl_add_u32 v8, v3, 4, v8
    v_mul_u32_u24 v9, 5120, v2
    v_lshl_add_u32 v9, v3, 4, v9
    s_mul_i32 s53, s46, 552960
    s_lshl_b32 s3, s50, 7
    s_add_u32 s53, s53, s3
    s_lshl_b32 s3, s47, 2
    s_add_u32 s3, s3, s46
    s_mul_i32 s54, s3, 40960
    s_lshl_b32 s3, s50, 2
    s_add_u32 s3, s3, s46
    s_mul_i32 s55, s3, 20480
    buffer_load_dwordx4 a[68:71], v4, s[8:11], s56 offen offset:1024 nt
    v_mov_b32 v48, 0
    v_mov_b32 v49, 0
    v_mov_b32 v50, 0
    v_mov_b32 v51, 0
    v_mov_b32 v52, 0
    v_mov_b32 v53, 0
    v_mov_b32 v54, 0
    v_mov_b32 v55, 0
    v_mov_b32 v56, 0
    v_mov_b32 v57, 0
    v_mov_b32 v58, 0
    v_mov_b32 v59, 0
    v_mov_b32 v60, 0
    v_mov_b32 v61, 0
    v_mov_b32 v62, 0
    v_mov_b32 v63, 0
    v_mov_b32 v13, 0xff800000
    v_mov_b32 v15, 0
    s_add_u32 s57, s52, 262144
    buffer_load_dwordx4 a[72:75], v6, s[16:19], s57 offen offset:0 nt
    buffer_load_dwordx4 a[76:79], v4, s[8:11], s56 offen offset:2048 nt
    buffer_load_dwordx4 a[80:83], v6, s[16:19], s57 offen offset:128 nt
    buffer_load_dwordx4 a[84:87], v4, s[8:11], s56 offen offset:3072 nt
    v_mov_b32_dpp v10, v32 row_newbcast:0 row_mask:0xf bank_mask:0x3
    v_mov_b32_dpp v10, v32 row_newbcast:8 row_mask:0xf bank_mask:0xc
    v_and_b32 v44, v10, v28
    v_and_b32 v45, v10, v29
    v_and_b32 v46, v10, v30
    v_and_b32 v47, v10, v31
    s_nop 1
    v_mfma_f32_16x16x32_bf16 v[64:67], v[44:47], a[8:11], 0
    s_waitcnt vmcnt(17)
    v_mfma_f32_16x16x32_bf16 v[68:71], v[44:47], a[16:19], 0
    s_add_u32 s57, s52, 327680
    buffer_load_dwordx4 a[88:91], v6, s[16:19], s57 offen offset:0 nt
    s_add_u32 s56, s51, 49152
    buffer_load_dwordx4 a[92:95], v4, s[8:11], s56 offen offset:0 nt
    buffer_load_dwordx4 a[96:99], v6, s[16:19], s57 offen offset:128 nt
    buffer_load_dwordx4 a[100:103], v4, s[8:11], s56 offen offset:1024 nt
    v_mov_b32_dpp v10, v32 row_newbcast:1 row_mask:0xf bank_mask:0x3
    v_mov_b32_dpp v10, v32 row_newbcast:9 row_mask:0xf bank_mask:0xc
    v_and_b32 v40, v10, v28
    v_and_b32 v41, v10, v29
    v_and_b32 v42, v10, v30
    v_and_b32 v43, v10, v31
    s_waitcnt vmcnt(19)
    s_nop 0
    v_mfma_f32_16x16x32_bf16 v[64:67], v[40:43], a[24:27], v[64:67]
    s_waitcnt vmcnt(17)
    v_mfma_f32_16x16x32_bf16 v[68:71], v[40:43], a[32:35], v[68:71]
    s_add_u32 s57, s52, 393216
    buffer_load_dwordx4 a[104:107], v6, s[16:19], s57 offen offset:0 nt
    buffer_load_dwordx4 a[108:111], v4, s[8:11], s56 offen offset:2048 nt
    buffer_load_dwordx4 a[112:115], v6, s[16:19], s57 offen offset:128 nt
    buffer_load_dwordx4 a[116:119], v4, s[8:11], s56 offen offset:3072 nt
    v_mov_b32_dpp v10, v32 row_newbcast:2 row_mask:0xf bank_mask:0x3
    v_mov_b32_dpp v10, v32 row_newbcast:10 row_mask:0xf bank_mask:0xc
    v_and_b32 v44, v10, v28
    v_and_b32 v45, v10, v29
    v_and_b32 v46, v10, v30
    v_and_b32 v47, v10, v31
    s_waitcnt vmcnt(19)
    s_nop 0
    v_mfma_f32_16x16x32_bf16 v[64:67], v[44:47], a[40:43], v[64:67]
    s_waitcnt vmcnt(17)
    v_mfma_f32_16x16x32_bf16 v[68:71], v[44:47], a[48:51], v[68:71]
    s_add_u32 s57, s52, 458752
    buffer_load_dwordx4 a[120:123], v6, s[16:19], s57 offen offset:0 nt
    s_add_u32 s56, s51, 65536
    buffer_load_dwordx4 a[124:127], v4, s[8:11], s56 offen offset:0 nt
    buffer_load_dwordx4 a[128:131], v6, s[16:19], s57 offen offset:128 nt
    buffer_load_dwordx4 a[132:135], v4, s[8:11], s56 offen offset:1024 nt
    v_mov_b32_dpp v10, v32 row_newbcast:3 row_mask:0xf bank_mask:0x3
    v_mov_b32_dpp v10, v32 row_newbcast:11 row_mask:0xf bank_mask:0xc
    v_and_b32 v40, v10, v28
    v_and_b32 v41, v10, v29
    v_and_b32 v42, v10, v30
    v_and_b32 v43, v10, v31
    s_waitcnt vmcnt(19)
    s_nop 0
    v_mfma_f32_16x16x32_bf16 v[64:67], v[40:43], a[56:59], v[64:67]
    s_waitcnt vmcnt(17)
    v_mfma_f32_16x16x32_bf16 v[68:71], v[40:43], a[64:67], v[68:71]
    s_add_u32 s57, s52, 524288
    buffer_load_dwordx4 a[136:139], v6, s[16:19], s57 offen offset:0 nt
    buffer_load_dwordx4 a[140:143], v4, s[8:11], s56 offen offset:2048 nt
    buffer_load_dwordx4 a[144:147], v6, s[16:19], s57 offen offset:128 nt
    buffer_load_dwordx4 a[148:151], v4, s[8:11], s56 offen offset:3072 nt
    v_mov_b32_dpp v10, v32 row_newbcast:4 row_mask:0xf bank_mask:0x3
    v_mov_b32_dpp v10, v32 row_newbcast:12 row_mask:0xf bank_mask:0xc
    v_and_b32 v44, v10, v28
    v_and_b32 v45, v10, v29
    v_and_b32 v46, v10, v30
    v_and_b32 v47, v10, v31
    s_waitcnt vmcnt(19)
    s_nop 0
    v_mfma_f32_16x16x32_bf16 v[64:67], v[44:47], a[72:75], v[64:67]
    s_waitcnt vmcnt(17)
    v_mfma_f32_16x16x32_bf16 v[68:71], v[44:47], a[80:83], v[68:71]
    s_add_u32 s57, s52, 589824
    buffer_load_dwordx4 a[152:155], v6, s[16:19], s57 offen offset:0 nt
    s_add_u32 s56, s51, 81920
    buffer_load_dwordx4 a[156:159], v4, s[8:11], s56 offen offset:0 nt
    buffer_load_dwordx4 a[160:163], v6, s[16:19], s57 offen offset:128 nt
    buffer_load_dwordx4 a[164:167], v4, s[8:11], s56 offen offset:1024 nt
    v_mov_b32_dpp v10, v32 row_newbcast:5 row_mask:0xf bank_mask:0x3
    v_mov_b32_dpp v10, v32 row_newbcast:13 row_mask:0xf bank_mask:0xc
    v_and_b32 v40, v10, v28
    v_and_b32 v41, v10, v29
    v_and_b32 v42, v10, v30
    v_and_b32 v43, v10, v31
    s_waitcnt vmcnt(19)
    s_nop 0
    v_mfma_f32_16x16x32_bf16 v[64:67], v[40:43], a[88:91], v[64:67]
    s_waitcnt vmcnt(17)
    v_mfma_f32_16x16x32_bf16 v[68:71], v[40:43], a[96:99], v[68:71]
    s_add_u32 s57, s52, 655360
    buffer_load_dwordx4 a[168:171], v6, s[16:19], s57 offen offset:0 nt
    buffer_load_dwordx4 a[172:175], v4, s[8:11], s56 offen offset:2048 nt
    buffer_load_dwordx4 a[176:179], v6, s[16:19], s57 offen offset:128 nt
    buffer_load_dwordx4 a[180:183], v4, s[8:11], s56 offen offset:3072 nt
    v_mov_b32_dpp v10, v32 row_newbcast:6 row_mask:0xf bank_mask:0x3
    v_mov_b32_dpp v10, v32 row_newbcast:14 row_mask:0xf bank_mask:0xc
    v_and_b32 v44, v10, v28
    v_and_b32 v45, v10, v29
    v_and_b32 v46, v10, v30
    v_and_b32 v47, v10, v31
    s_waitcnt vmcnt(19)
    s_nop 0
    v_mfma_f32_16x16x32_bf16 v[64:67], v[44:47], a[104:107], v[64:67]
    s_waitcnt vmcnt(17)
    v_mfma_f32_16x16x32_bf16 v[68:71], v[44:47], a[112:115], v[68:71]
    s_add_u32 s57, s52, 720896
    buffer_load_dwordx4 a[184:187], v6, s[16:19], s57 offen offset:0 nt
    s_add_u32 s56, s51, 98304
    buffer_load_dwordx4 a[188:191], v4, s[8:11], s56 offen offset:0 nt
    buffer_load_dwordx4 a[192:195], v6, s[16:19], s57 offen offset:128 nt
    buffer_load_dwordx4 a[196:199], v4, s[8:11], s56 offen offset:1024 nt
    v_mov_b32_dpp v10, v32 row_newbcast:7 row_mask:0xf bank_mask:0x3
    v_mov_b32_dpp v10, v32 row_newbcast:15 row_mask:0xf bank_mask:0xc
    v_and_b32 v40, v10, v28
    v_and_b32 v41, v10, v29
    v_and_b32 v42, v10, v30
    v_and_b32 v43, v10, v31
    s_waitcnt vmcnt(19)
    s_nop 0
    v_mfma_f32_16x16x32_bf16 v[64:67], v[40:43], a[120:123], v[64:67]
    s_waitcnt vmcnt(17)
    v_mfma_f32_16x16x32_bf16 v[68:71], v[40:43], a[128:131], v[68:71]
    s_add_u32 s57, s52, 786432
    buffer_load_dwordx4 a[200:203], v6, s[16:19], s57 offen offset:0 nt
    buffer_load_dwordx4 a[204:207], v4, s[8:11], s56 offen offset:2048 nt
    buffer_load_dwordx4 a[208:211], v6, s[16:19], s57 offen offset:128 nt
    buffer_load_dwordx4 a[212:215], v4, s[8:11], s56 offen offset:3072 nt
    v_mov_b32_dpp v10, v33 row_newbcast:0 row_mask:0xf bank_mask:0x3
    v_mov_b32_dpp v10, v33 row_newbcast:8 row_mask:0xf bank_mask:0xc
    v_and_b32 v44, v10, v28
    v_and_b32 v45, v10, v29
    v_and_b32 v46, v10, v30
    v_and_b32 v47, v10, v31
    s_waitcnt vmcnt(19)
    s_nop 0
    v_mfma_f32_16x16x32_bf16 v[64:67], v[44:47], a[136:139], v[64:67]
    s_waitcnt vmcnt(17)
    v_mfma_f32_16x16x32_bf16 v[68:71], v[44:47], a[144:147], v[68:71]
    s_add_u32 s57, s52, 851968
    buffer_load_dwordx4 a[216:219], v6, s[16:19], s57 offen offset:0 nt
    s_add_u32 s56, s51, 114688
    buffer_load_dwordx4 a[220:223], v4, s[8:11], s56 offen offset:0 nt
    buffer_load_dwordx4 a[224:227], v6, s[16:19], s57 offen offset:128 nt
    buffer_load_dwordx4 a[228:231], v4, s[8:11], s56 offen offset:1024 nt
    v_mov_b32_dpp v10, v33 row_newbcast:1 row_mask:0xf bank_mask:0x3
    v_mov_b32_dpp v10, v33 row_newbcast:9 row_mask:0xf bank_mask:0xc
    v_and_b32 v40, v10, v28
    v_and_b32 v41, v10, v29
    v_and_b32 v42, v10, v30
    v_and_b32 v43, v10, v31
    s_waitcnt vmcnt(19)
    s_nop 0
    v_mfma_f32_16x16x32_bf16 v[64:67], v[40:43], a[152:155], v[64:67]
    s_waitcnt vmcnt(17)
    v_mfma_f32_16x16x32_bf16 v[68:71], v[40:43], a[160:163], v[68:71]
    s_add_u32 s57, s52, 917504
    buffer_load_dwordx4 a[232:235], v6, s[16:19], s57 offen offset:0 nt
    buffer_load_dwordx4 a[236:239], v4, s[8:11], s56 offen offset:2048 nt
    buffer_load_dwordx4 a[240:243], v6, s[16:19], s57 offen offset:128 nt
    buffer_load_dwordx4 a[244:247], v4, s[8:11], s56 offen offset:3072 nt
    v_mov_b32_dpp v10, v33 row_newbcast:2 row_mask:0xf bank_mask:0x3
    v_mov_b32_dpp v10, v33 row_newbcast:10 row_mask:0xf bank_mask:0xc
    v_and_b32 v44, v10, v28
    v_and_b32 v45, v10, v29
    v_and_b32 v46, v10, v30
    v_and_b32 v47, v10, v31
    s_waitcnt vmcnt(19)
    s_nop 0
    v_mfma_f32_16x16x32_bf16 v[64:67], v[44:47], a[168:171], v[64:67]
    s_waitcnt vmcnt(17)
    v_mfma_f32_16x16x32_bf16 v[68:71], v[44:47], a[176:179], v[68:71]
    s_add_u32 s57, s52, 983040
    buffer_load_dwordx4 a[248:251], v6, s[16:19], s57 offen offset:0 nt
    s_add_u32 s56, s51, 131072
    buffer_load_dwordx4 a[252:255], v4, s[8:11], s56 offen offset:0 nt
    buffer_load_dwordx4 v[156:159], v6, s[16:19], s57 offen offset:128 nt
    buffer_load_dwordx4 v[160:163], v4, s[8:11], s56 offen offset:1024 nt
    v_mov_b32_dpp v10, v33 row_newbcast:3 row_mask:0xf bank_mask:0x3
    v_mov_b32_dpp v10, v33 row_newbcast:11 row_mask:0xf bank_mask:0xc
    v_and_b32 v40, v10, v28
    v_and_b32 v41, v10, v29
    v_and_b32 v42, v10, v30
    v_and_b32 v43, v10, v31
    s_waitcnt vmcnt(19)
    s_nop 0
    v_mfma_f32_16x16x32_bf16 v[64:67], v[40:43], a[184:187], v[64:67]
    s_waitcnt vmcnt(17)
    v_mfma_f32_16x16x32_bf16 v[68:71], v[40:43], a[192:195], v[68:71]
    s_add_u32 s57, s52, 1048576
    buffer_load_dwordx4 v[164:167], v6, s[16:19], s57 offen offset:0 nt
    buffer_load_dwordx4 v[168:171], v4, s[8:11], s56 offen offset:2048 nt
    buffer_load_dwordx4 v[172:175], v6, s[16:19], s57 offen offset:128 nt
    buffer_load_dwordx4 v[176:179], v4, s[8:11], s56 offen offset:3072 nt
    v_mov_b32_dpp v10, v33 row_newbcast:4 row_mask:0xf bank_mask:0x3
    v_mov_b32_dpp v10, v33 row_newbcast:12 row_mask:0xf bank_mask:0xc
    v_and_b32 v44, v10, v28
    v_and_b32 v45, v10, v29
    v_and_b32 v46, v10, v30
    v_and_b32 v47, v10, v31
    s_waitcnt vmcnt(19)
    s_nop 0
    v_mfma_f32_16x16x32_bf16 v[64:67], v[44:47], a[200:203], v[64:67]
    s_waitcnt vmcnt(17)
    v_mfma_f32_16x16x32_bf16 v[68:71], v[44:47], a[208:211], v[68:71]
    s_add_u32 s57, s52, 1114112
    buffer_load_dwordx4 v[180:183], v6, s[16:19], s57 offen offset:0 nt
    s_add_u32 s56, s51, 147456
    buffer_load_dwordx4 v[184:187], v4, s[8:11], s56 offen offset:0 nt
    buffer_load_dwordx4 v[188:191], v6, s[16:19], s57 offen offset:128 nt
    buffer_load_dwordx4 v[192:195], v4, s[8:11], s56 offen offset:1024 nt
    v_mov_b32_dpp v10, v33 row_newbcast:5 row_mask:0xf bank_mask:0x3
    v_mov_b32_dpp v10, v33 row_newbcast:13 row_mask:0xf bank_mask:0xc
    v_and_b32 v40, v10, v28
    v_and_b32 v41, v10, v29
    v_and_b32 v42, v10, v30
    v_and_b32 v43, v10, v31
    s_waitcnt vmcnt(19)
    s_nop 0
    v_mfma_f32_16x16x32_bf16 v[64:67], v[40:43], a[216:219], v[64:67]
    s_waitcnt vmcnt(17)
    v_mfma_f32_16x16x32_bf16 v[68:71], v[40:43], a[224:227], v[68:71]
    s_add_u32 s57, s52, 1179648
    buffer_load_dwordx4 v[196:199], v6, s[16:19], s57 offen offset:0 nt
    buffer_load_dwordx4 v[200:203], v4, s[8:11], s56 offen offset:2048 nt
    buffer_load_dwordx4 v[204:207], v6, s[16:19], s57 offen offset:128 nt
    buffer_load_dwordx4 v[208:211], v4, s[8:11], s56 offen offset:3072 nt
    v_mov_b32_dpp v10, v33 row_newbcast:6 row_mask:0xf bank_mask:0x3
    v_mov_b32_dpp v10, v33 row_newbcast:14 row_mask:0xf bank_mask:0xc
    v_and_b32 v44, v10, v28
    v_and_b32 v45, v10, v29
    v_and_b32 v46, v10, v30
    v_and_b32 v47, v10, v31
    s_waitcnt vmcnt(19)
    s_nop 0
    v_mfma_f32_16x16x32_bf16 v[64:67], v[44:47], a[232:235], v[64:67]
    s_waitcnt vmcnt(17)
    v_mfma_f32_16x16x32_bf16 v[68:71], v[44:47], a[240:243], v[68:71]
    s_add_u32 s57, s52, 1245184
    buffer_load_dwordx4 v[212:215], v6, s[16:19], s57 offen offset:0 nt
    s_add_u32 s56, s51, 163840
    buffer_load_dwordx4 v[216:219], v4, s[8:11], s56 offen offset:0 nt
    buffer_load_dwordx4 v[220:223], v6, s[16:19], s57 offen offset:128 nt
    buffer_load_dwordx4 v[224:227], v4, s[8:11], s56 offen offset:1024 nt
    v_mov_b32_dpp v10, v33 row_newbcast:7 row_mask:0xf bank_mask:0x3
    v_mov_b32_dpp v10, v33 row_newbcast:15 row_mask:0xf bank_mask:0xc
    v_and_b32 v40, v10, v28
    v_and_b32 v41, v10, v29
    v_and_b32 v42, v10, v30
    v_and_b32 v43, v10, v31
    s_waitcnt vmcnt(19)
    s_nop 0
    v_mfma_f32_16x16x32_bf16 v[64:67], v[40:43], a[248:251], v[64:67]
    s_waitcnt vmcnt(17)
    v_mfma_f32_16x16x32_bf16 v[68:71], v[40:43], v[156:159], v[68:71]
    buffer_load_dwordx4 v[228:231], v4, s[8:11], s56 offen offset:2048 nt
    buffer_load_dwordx4 v[232:235], v4, s[8:11], s56 offen offset:3072 nt
    s_add_u32 s56, s51, 180224
    buffer_load_dwordx4 v[236:239], v4, s[8:11], s56 offen offset:0 nt
    buffer_load_dwordx4 v[240:243], v4, s[8:11], s56 offen offset:1024 nt
    v_mov_b32_dpp v10, v34 row_newbcast:0 row_mask:0xf bank_mask:0x3
    v_mov_b32_dpp v10, v34 row_newbcast:8 row_mask:0xf bank_mask:0xc
    v_and_b32 v44, v10, v28
    v_and_b32 v45, v10, v29
    v_and_b32 v46, v10, v30
    v_and_b32 v47, v10, v31
    s_waitcnt vmcnt(19)
    s_nop 0
    v_mfma_f32_16x16x32_bf16 v[64:67], v[44:47], v[164:167], v[64:67]
    s_waitcnt vmcnt(17)
    v_mfma_f32_16x16x32_bf16 v[68:71], v[44:47], v[172:175], v[68:71]
    buffer_load_dwordx4 v[244:247], v4, s[8:11], s56 offen offset:2048 nt
    buffer_load_dwordx4 v[248:251], v4, s[8:11], s56 offen offset:3072 nt
    s_cmp_eq_u32 s90, 32
    s_cbranch_scc1 L_var_c
    s_cmp_lg_u32 s49, 0
    s_cbranch_scc1 L_var_b
    s_add_u32 s58, s53, 0
    buffer_load_dwordx4 v[252:255], v7, s[24:27], s58 offen offset:0 nt
    s_add_u32 s56, s51, 196608
    buffer_load_dwordx4 a[8:11], v4, s[8:11], s56 offen offset:0 nt
    v_mov_b32_dpp v10, v34 row_newbcast:1 row_mask:0xf bank_mask:0x3
    v_mov_b32_dpp v10, v34 row_newbcast:9 row_mask:0xf bank_mask:0xc
    v_and_b32 v40, v10, v28
    v_and_b32 v41, v10, v29
    v_and_b32 v42, v10, v30
    v_and_b32 v43, v10, v31
    s_waitcnt vmcnt(19)
    s_nop 0
    v_mfma_f32_16x16x32_bf16 v[64:67], v[40:43], v[180:183], v[64:67]
    s_waitcnt vmcnt(17)
    v_mfma_f32_16x16x32_bf16 v[68:71], v[40:43], v[188:191], v[68:71]
    buffer_load_dwordx4 a[16:19], v4, s[8:11], s56 offen offset:1024 nt
    buffer_load_dwordx4 a[24:27], v7, s[28:31], s58 offen offset:0 nt
    buffer_load_dwordx4 a[32:35], v4, s[8:11], s56 offen offset:2048 nt
    buffer_load_dwordx4 a[40:43], v4, s[8:11], s56 offen offset:3072 nt
    v_mov_b32_dpp v10, v34 row_newbcast:2 row_mask:0xf bank_mask:0x3
    v_mov_b32_dpp v10, v34 row_newbcast:10 row_mask:0xf bank_mask:0xc
    v_and_b32 v44, v10, v28
    v_and_b32 v45, v10, v29
    v_and_b32 v46, v10, v30
    v_and_b32 v47, v10, v31
    s_waitcnt vmcnt(19)
    s_nop 0
    v_mfma_f32_16x16x32_bf16 v[64:67], v[44:47], v[196:199], v[64:67]
    s_waitcnt vmcnt(17)
    v_mfma_f32_16x16x32_bf16 v[68:71], v[44:47], v[204:207], v[68:71]
    s_add_u32 s58, s53, 27648
    buffer_load_dwordx4 a[48:51], v7, s[24:27], s58 offen offset:0 nt
    s_add_u32 s56, s51, 212992
    buffer_load_dwordx4 a[56:59], v4, s[8:11], s56 offen offset:0 nt
    buffer_load_dwordx4 a[64:67], v7, s[28:31], s58 offen offset:0 nt
    buffer_load_dwordx4 a[72:75], v4, s[8:11], s56 offen offset:1024 nt
    v_mov_b32_dpp v10, v34 row_newbcast:3 row_mask:0xf bank_mask:0x3
    v_mov_b32_dpp v10, v34 row_newbcast:11 row_mask:0xf bank_mask:0xc
    v_and_b32 v40, v10, v28
    v_and_b32 v41, v10, v29
    v_and_b32 v42, v10, v30
    v_and_b32 v43, v10, v31
    s_waitcnt vmcnt(19)
    s_nop 0
    v_mfma_f32_16x16x32_bf16 v[64:67], v[40:43], v[212:215], v[64:67]
    s_waitcnt vmcnt(17)
    v_mfma_f32_16x16x32_bf16 v[68:71], v[40:43], v[220:223], v[68:71]
    v_lshrrev_b32 v10, 3, v3
    v_lshlrev_b32 v19, 9, v10
    v_and_b32 v10, 7, v3
    v_lshl_add_u32 v19, v10, 5, v19
    v_and_b32 v10, 1, v2
    v_lshl_add_u32 v19, v10, 4, v19
    s_lshl_b32 s3, s46, 10
    v_add_u32 v19, s3, v19
    s_mov_b32 exec_lo, 0x00ff00ff
    s_mov_b32 exec_hi, 0xff00ff00
    ds_write_b128 v19, v[64:67] offset:0
    ds_write_b128 v19, v[68:71] offset:256
    s_mov_b64 exec, -1
    v_lshrrev_b32 v10, 2, v3
    v_lshlrev_b32 v10, 10, v10
    v_lshl_add_u32 v10, v2, 7, v10
    v_and_b32 v11, 3, v3
    v_lshl_add_u32 v10, v11, 5, v10
    buffer_load_dwordx4 a[80:83], v4, s[8:11], s56 offen offset:2048 nt
    s_waitcnt lgkmcnt(0)
    s_barrier
    ds_read_b128 v[140:143], v10 offset:0
    ds_read_b128 v[144:147], v10 offset:16
    ds_read_b128 v[148:151], v10 offset:512
    ds_read_b128 v[152:155], v10 offset:528
    s_add_u32 s44, s44, 0x9e3779b9
    s_add_u32 s45, s45, 0x85ebca6b
    s_waitcnt lgkmcnt(0)
    v_pk_add_f32 v[140:141], v[140:141], v[148:149]
    v_pk_add_f32 v[142:143], v[142:143], v[150:151]
    v_pk_add_f32 v[144:145], v[144:145], v[152:153]
    v_pk_add_f32 v[146:147], v[146:147], v[154:155]
    v_add_f32_dpp v140, v140, v140 row_ror:4 row_mask:0xf bank_mask:0xf
    v_add_f32_dpp v141, v141, v141 row_ror:4 row_mask:0xf bank_mask:0xf
    v_add_f32_dpp v142, v142, v142 row_ror:4 row_mask:0xf bank_mask:0xf
    v_add_f32_dpp v143, v143, v143 row_ror:4 row_mask:0xf bank_mask:0xf
    v_add_f32_dpp v144, v144, v144 row_ror:4 row_mask:0xf bank_mask:0xf
    v_add_f32_dpp v145, v145, v145 row_ror:4 row_mask:0xf bank_mask:0xf
    v_add_f32_dpp v146, v146, v146 row_ror:4 row_mask:0xf bank_mask:0xf
    v_add_f32_dpp v147, v147, v147 row_ror:4 row_mask:0xf bank_mask:0xf
    v_add_f32_dpp v140, v140, v140 row_ror:8 row_mask:0xf bank_mask:0xf
    v_add_f32_dpp v141, v141, v141 row_ror:8 row_mask:0xf bank_mask:0xf
    v_add_f32_dpp v142, v142, v142 row_ror:8 row_mask:0xf bank_mask:0xf
    v_add_f32_dpp v143, v143, v143 row_ror:8 row_mask:0xf bank_mask:0xf
    v_add_f32_dpp v144, v144, v144 row_ror:8 row_mask:0xf bank_mask:0xf
    v_add_f32_dpp v145, v145, v145 row_ror:8 row_mask:0xf bank_mask:0xf
    v_add_f32_dpp v146, v146, v146 row_ror:8 row_mask:0xf bank_mask:0xf
    v_add_f32_dpp v147, v147, v147 row_ror:8 row_mask:0xf bank_mask:0xf
    s_add_u32 s58, s53, 55296
    buffer_load_dwordx4 a[88:91], v7, s[24:27], s58 offen offset:0 nt
    v_cvt_pk_bf16_f32 v148, v140, v141
    v_cvt_pk_bf16_f32 v149, v142, v143
    v_cvt_pk_bf16_f32 v150, v144, v145
    v_cvt_pk_bf16_f32 v151, v146, v147
    v_mov_b32_dpp v48, v148 quad_perm:[0,1,2,3] row_mask:0xf bank_mask:0x1
    v_mov_b32_dpp v49, v149 quad_perm:[0,1,2,3] row_mask:0xf bank_mask:0x1
    v_mov_b32_dpp v50, v150 quad_perm:[0,1,2,3] row_mask:0xf bank_mask:0x1
    v_mov_b32_dpp v51, v151 quad_perm:[0,1,2,3] row_mask:0xf bank_mask:0x1
    v_mov_b32_dpp v52, v148 quad_perm:[0,1,2,3] row_mask:0xf bank_mask:0x2
    v_mov_b32_dpp v53, v149 quad_perm:[0,1,2,3] row_mask:0xf bank_mask:0x2
    v_mov_b32_dpp v54, v150 quad_perm:[0,1,2,3] row_mask:0xf bank_mask:0x2
    v_mov_b32_dpp v55, v151 quad_perm:[0,1,2,3] row_mask:0xf bank_mask:0x2
    v_mov_b32_dpp v56, v148 quad_perm:[0,1,2,3] row_mask:0xf bank_mask:0x4
    v_mov_b32_dpp v57, v149 quad_perm:[0,1,2,3] row_mask:0xf bank_mask:0x4
    v_mov_b32_dpp v58, v150 quad_perm:[0,1,2,3] row_mask:0xf bank_mask:0x4
    v_mov_b32_dpp v59, v151 quad_perm:[0,1,2,3] row_mask:0xf bank_mask:0x4
    v_mov_b32_dpp v60, v148 quad_perm:[0,1,2,3] row_mask:0xf bank_mask:0x8
    v_mov_b32_dpp v61, v149 quad_perm:[0,1,2,3] row_mask:0xf bank_mask:0x8
    v_mov_b32_dpp v62, v150 quad_perm:[0,1,2,3] row_mask:0xf bank_mask:0x8
    v_mov_b32_dpp v63, v151 quad_perm:[0,1,2,3] row_mask:0xf bank_mask:0x8
    v_mfma_f32_16x16x32_bf16 v[72:75], a[0:3], v[48:51], 0
    v_mfma_f32_16x16x32_bf16 v[72:75], a[4:7], v[52:55], v[72:75]
    v_mfma_f32_16x16x32_bf16 v[72:75], a[12:15], v[56:59], v[72:75]
    v_mfma_f32_16x16x32_bf16 v[72:75], a[20:23], v[60:63], v[72:75]
    buffer_load_dwordx4 a[96:99], v4, s[8:11], s56 offen offset:3072 nt
    v_mfma_f32_16x16x32_bf16 v[76:79], a[28:31], v[48:51], 0
    v_mfma_f32_16x16x32_bf16 v[76:79], a[36:39], v[52:55], v[76:79]
    v_mfma_f32_16x16x32_bf16 v[76:79], a[44:47], v[56:59], v[76:79]
    v_mfma_f32_16x16x32_bf16 v[76:79], a[52:55], v[60:63], v[76:79]
    s_nop 2
    v_mov_b32_dpp v104, v72 quad_perm:[0,0,0,0] row_mask:0xf bank_mask:0xf
    v_add_f32_dpp v104, v73, v104 quad_perm:[1,1,1,1] row_mask:0xf bank_mask:0xf
    v_add_f32_dpp v104, v74, v104 quad_perm:[2,2,2,2] row_mask:0xf bank_mask:0xf
    v_add_f32_dpp v104, v75, v104 quad_perm:[3,3,3,3] row_mask:0xf bank_mask:0xf
    v_cvt_pk_bf16_f32 v104, 0, v104
    v_mul_f32 v104, 0x3db504f3, v104
    v_cvt_pk_bf16_f32 v104, 0, v104
    v_max_f32 v13, v13, v104
    v_mfma_f32_16x16x32_bf16 v[72:75], a[60:63], v[48:51], 0
    v_mfma_f32_16x16x32_bf16 v[72:75], a[68:71], v[52:55], v[72:75]
    v_mfma_f32_16x16x32_bf16 v[72:75], a[76:79], v[56:59], v[72:75]
    v_mfma_f32_16x16x32_bf16 v[72:75], a[84:87], v[60:63], v[72:75]
    v_mov_b32_dpp v105, v76 quad_perm:[0,0,0,0] row_mask:0xf bank_mask:0xf
    v_add_f32_dpp v105, v77, v105 quad_perm:[1,1,1,1] row_mask:0xf bank_mask:0xf
    v_add_f32_dpp v105, v78, v105 quad_perm:[2,2,2,2] row_mask:0xf bank_mask:0xf
    v_add_f32_dpp v105, v79, v105 quad_perm:[3,3,3,3] row_mask:0xf bank_mask:0xf
    v_cvt_pk_bf16_f32 v105, 0, v105
    v_mul_f32 v105, 0x3db504f3, v105
    v_cvt_pk_bf16_f32 v105, 0, v105
    v_max_f32 v13, v13, v105
    buffer_load_dwordx4 a[104:107], v7, s[28:31], s58 offen offset:0 nt
    v_mfma_f32_16x16x32_bf16 v[76:79], a[92:95], v[48:51], 0
    v_mfma_f32_16x16x32_bf16 v[76:79], a[100:103], v[52:55], v[76:79]
    v_mfma_f32_16x16x32_bf16 v[76:79], a[108:111], v[56:59], v[76:79]
    v_mfma_f32_16x16x32_bf16 v[76:79], a[116:119], v[60:63], v[76:79]
    v_mov_b32_dpp v106, v72 quad_perm:[0,0,0,0] row_mask:0xf bank_mask:0xf
    v_add_f32_dpp v106, v73, v106 quad_perm:[1,1,1,1] row_mask:0xf bank_mask:0xf
    v_add_f32_dpp v106, v74, v106 quad_perm:[2,2,2,2] row_mask:0xf bank_mask:0xf
    v_add_f32_dpp v106, v75, v106 quad_perm:[3,3,3,3] row_mask:0xf bank_mask:0xf
    v_cvt_pk_bf16_f32 v106, 0, v106
    v_mul_f32 v106, 0x3db504f3, v106
    v_cvt_pk_bf16_f32 v106, 0, v106
    v_max_f32 v13, v13, v106
    v_mfma_f32_16x16x32_bf16 v[72:75], a[124:127], v[48:51], 0
    v_mfma_f32_16x16x32_bf16 v[72:75], a[132:135], v[52:55], v[72:75]
    v_mfma_f32_16x16x32_bf16 v[72:75], a[140:143], v[56:59], v[72:75]
    v_mfma_f32_16x16x32_bf16 v[72:75], a[148:151], v[60:63], v[72:75]
    v_mov_b32_dpp v107, v76 quad_perm:[0,0,0,0] row_mask:0xf bank_mask:0xf
    v_add_f32_dpp v107, v77, v107 quad_perm:[1,1,1,1] row_mask:0xf bank_mask:0xf
    v_add_f32_dpp v107, v78, v107 quad_perm:[2,2,2,2] row_mask:0xf bank_mask:0xf
    v_add_f32_dpp v107, v79, v107 quad_perm:[3,3,3,3] row_mask:0xf bank_mask:0xf
    v_cvt_pk_bf16_f32 v107, 0, v107
    v_mul_f32 v107, 0x3db504f3, v107
    v_cvt_pk_bf16_f32 v107, 0, v107
    v_max_f32 v13, v13, v107
    s_add_u32 s56, s51, 229376
    buffer_load_dwordx4 a[112:115], v4, s[8:11], s56 offen offset:0 nt
    v_mfma_f32_16x16x32_bf16 v[76:79], a[156:159], v[48:51], 0
    v_mfma_f32_16x16x32_bf16 v[76:79], a[164:167], v[52:55], v[76:79]
    v_mfma_f32_16x16x32_bf16 v[76:79], a[172:175], v[56:59], v[76:79]
    v_mfma_f32_16x16x32_bf16 v[76:79], a[180:183], v[60:63], v[76:79]
    v_mov_b32_dpp v108, v72 quad_perm:[0,0,0,0] row_mask:0xf bank_mask:0xf
    v_add_f32_dpp v108, v73, v108 quad_perm:[1,1,1,1] row_mask:0xf bank_mask:0xf
    v_add_f32_dpp v108, v74, v108 quad_perm:[2,2,2,2] row_mask:0xf bank_mask:0xf
    v_add_f32_dpp v108, v75, v108 quad_perm:[3,3,3,3] row_mask:0xf bank_mask:0xf
    v_cvt_pk_bf16_f32 v108, 0, v108
    v_mul_f32 v108, 0x3db504f3, v108
    v_cvt_pk_bf16_f32 v108, 0, v108
    v_max_f32 v13, v13, v108
    v_mfma_f32_16x16x32_bf16 v[72:75], a[188:191], v[48:51], 0
    v_mfma_f32_16x16x32_bf16 v[72:75], a[196:199], v[52:55], v[72:75]
    v_mfma_f32_16x16x32_bf16 v[72:75], a[204:207], v[56:59], v[72:75]
    v_mfma_f32_16x16x32_bf16 v[72:75], a[212:215], v[60:63], v[72:75]
    v_mov_b32_dpp v109, v76 quad_perm:[0,0,0,0] row_mask:0xf bank_mask:0xf
    v_add_f32_dpp v109, v77, v109 quad_perm:[1,1,1,1] row_mask:0xf bank_mask:0xf
    v_add_f32_dpp v109, v78, v109 quad_perm:[2,2,2,2] row_mask:0xf bank_mask:0xf
    v_add_f32_dpp v109, v79, v109 quad_perm:[3,3,3,3] row_mask:0xf bank_mask:0xf
    v_cvt_pk_bf16_f32 v109, 0, v109
    v_mul_f32 v109, 0x3db504f3, v109
    v_cvt_pk_bf16_f32 v109, 0, v109
    v_max_f32 v13, v13, v109
    buffer_load_dwordx4 a[120:123], v4, s[8:11], s56 offen offset:1024 nt
    v_mfma_f32_16x16x32_bf16 v[76:79], a[220:223], v[48:51], 0
    v_mfma_f32_16x16x32_bf16 v[76:79], a[228:231], v[52:55], v[76:79]
    v_mfma_f32_16x16x32_bf16 v[76:79], a[236:239], v[56:59], v[76:79]
    v_mfma_f32_16x16x32_bf16 v[76:79], a[244:247], v[60:63], v[76:79]
    v_mov_b32_dpp v110, v72 quad_perm:[0,0,0,0] row_mask:0xf bank_mask:0xf
    v_add_f32_dpp v110, v73, v110 quad_perm:[1,1,1,1] row_mask:0xf bank_mask:0xf
    v_add_f32_dpp v110, v74, v110 quad_perm:[2,2,2,2] row_mask:0xf bank_mask:0xf
    v_add_f32_dpp v110, v75, v110 quad_perm:[3,3,3,3] row_mask:0xf bank_mask:0xf
    v_cvt_pk_bf16_f32 v110, 0, v110
    v_mul_f32 v110, 0x3db504f3, v110
    v_cvt_pk_bf16_f32 v110, 0, v110
    v_max_f32 v13, v13, v110
    v_mfma_f32_16x16x32_bf16 v[72:75], a[252:255], v[48:51], 0
    v_mfma_f32_16x16x32_bf16 v[72:75], v[160:163], v[52:55], v[72:75]
    v_mfma_f32_16x16x32_bf16 v[72:75], v[168:171], v[56:59], v[72:75]
    v_mfma_f32_16x16x32_bf16 v[72:75], v[176:179], v[60:63], v[72:75]
    v_mov_b32_dpp v111, v76 quad_perm:[0,0,0,0] row_mask:0xf bank_mask:0xf
    v_add_f32_dpp v111, v77, v111 quad_perm:[1,1,1,1] row_mask:0xf bank_mask:0xf
    v_add_f32_dpp v111, v78, v111 quad_perm:[2,2,2,2] row_mask:0xf bank_mask:0xf
    v_add_f32_dpp v111, v79, v111 quad_perm:[3,3,3,3] row_mask:0xf bank_mask:0xf
    v_cvt_pk_bf16_f32 v111, 0, v111
    v_mul_f32 v111, 0x3db504f3, v111
    v_cvt_pk_bf16_f32 v111, 0, v111
    v_max_f32 v13, v13, v111
    s_add_u32 s58, s53, 82944
    buffer_load_dwordx4 a[128:131], v7, s[24:27], s58 offen offset:0 nt
    v_mfma_f32_16x16x32_bf16 v[76:79], v[184:187], v[48:51], 0
    v_mfma_f32_16x16x32_bf16 v[76:79], v[192:195], v[52:55], v[76:79]
    v_mfma_f32_16x16x32_bf16 v[76:79], v[200:203], v[56:59], v[76:79]
    v_mfma_f32_16x16x32_bf16 v[76:79], v[208:211], v[60:63], v[76:79]
    v_mov_b32_dpp v112, v72 quad_perm:[0,0,0,0] row_mask:0xf bank_mask:0xf
    v_add_f32_dpp v112, v73, v112 quad_perm:[1,1,1,1] row_mask:0xf bank_mask:0xf
    v_add_f32_dpp v112, v74, v112 quad_perm:[2,2,2,2] row_mask:0xf bank_mask:0xf
    v_add_f32_dpp v112, v75, v112 quad_perm:[3,3,3,3] row_mask:0xf bank_mask:0xf
    v_cvt_pk_bf16_f32 v112, 0, v112
    v_mul_f32 v112, 0x3db504f3, v112
    v_cvt_pk_bf16_f32 v112, 0, v112
    v_max_f32 v13, v13, v112
    v_mfma_f32_16x16x32_bf16 v[72:75], v[216:219], v[48:51], 0
    s_waitcnt vmcnt(23)
    v_mfma_f32_16x16x32_bf16 v[72:75], v[224:227], v[52:55], v[72:75]
    s_waitcnt vmcnt(22)
    v_mfma_f32_16x16x32_bf16 v[72:75], v[228:231], v[56:59], v[72:75]
    s_waitcnt vmcnt(21)
    v_mfma_f32_16x16x32_bf16 v[72:75], v[232:235], v[60:63], v[72:75]
    v_mov_b32_dpp v113, v76 quad_perm:[0,0,0,0] row_mask:0xf bank_mask:0xf
    v_add_f32_dpp v113, v77, v113 quad_perm:[1,1,1,1] row_mask:0xf bank_mask:0xf
    v_add_f32_dpp v113, v78, v113 quad_perm:[2,2,2,2] row_mask:0xf bank_mask:0xf
    v_add_f32_dpp v113, v79, v113 quad_perm:[3,3,3,3] row_mask:0xf bank_mask:0xf
    v_cvt_pk_bf16_f32 v113, 0, v113
    v_mul_f32 v113, 0x3db504f3, v113
    v_cvt_pk_bf16_f32 v113, 0, v113
    v_max_f32 v13, v13, v113
    buffer_load_dwordx4 a[136:139], v4, s[8:11], s56 offen offset:2048 nt
    s_waitcnt vmcnt(21)
    v_mfma_f32_16x16x32_bf16 v[76:79], v[236:239], v[48:51], 0
    s_waitcnt vmcnt(20)
    v_mfma_f32_16x16x32_bf16 v[76:79], v[240:243], v[52:55], v[76:79]
    s_waitcnt vmcnt(19)
    v_mfma_f32_16x16x32_bf16 v[76:79], v[244:247], v[56:59], v[76:79]
    s_waitcnt vmcnt(18)
    v_mfma_f32_16x16x32_bf16 v[76:79], v[248:251], v[60:63], v[76:79]
    v_mov_b32_dpp v114, v72 quad_perm:[0,0,0,0] row_mask:0xf bank_mask:0xf
    v_add_f32_dpp v114, v73, v114 quad_perm:[1,1,1,1] row_mask:0xf bank_mask:0xf
    v_add_f32_dpp v114, v74, v114 quad_perm:[2,2,2,2] row_mask:0xf bank_mask:0xf
    v_add_f32_dpp v114, v75, v114 quad_perm:[3,3,3,3] row_mask:0xf bank_mask:0xf
    v_cvt_pk_bf16_f32 v114, 0, v114
    v_mul_f32 v114, 0x3db504f3, v114
    v_cvt_pk_bf16_f32 v114, 0, v114
    v_max_f32 v13, v13, v114
    buffer_load_dwordx4 a[144:147], v7, s[28:31], s58 offen offset:0 nt
    buffer_load_dwordx4 a[152:155], v4, s[8:11], s56 offen offset:3072 nt
    s_add_u32 s56, s51, 245760
    buffer_load_dwordx4 a[160:163], v4, s[8:11], s56 offen offset:0 nt
    v_mov_b32_dpp v10, v32 row_newbcast:0 row_mask:0xf bank_mask:0x3
    v_mov_b32_dpp v10, v32 row_newbcast:8 row_mask:0xf bank_mask:0xc
    v_and_b32 v44, v10, v28
    v_and_b32 v45, v10, v29
    v_and_b32 v46, v10, v30
    v_and_b32 v47, v10, v31
    s_waitcnt vmcnt(20)
    s_nop 0
    v_mfma_f32_16x16x32_bf16 v[64:67], v[44:47], v[252:255], 0
    s_waitcnt vmcnt(17)
    v_mfma_f32_16x16x32_bf16 v[68:71], v[44:47], a[24:27], 0
    s_add_u32 s58, s53, 110592
    buffer_load_dwordx4 a[168:171], v7, s[24:27], s58 offen offset:0 nt
    buffer_load_dwordx4 a[176:179], v4, s[8:11], s56 offen offset:1024 nt
    v_mfma_f32_16x16x32_bf16 v[72:75], a[8:11], v[48:51], 0
    v_mfma_f32_16x16x32_bf16 v[72:75], a[16:19], v[52:55], v[72:75]
    s_waitcnt vmcnt(18)
    v_mfma_f32_16x16x32_bf16 v[72:75], a[32:35], v[56:59], v[72:75]
    s_waitcnt vmcnt(17)
    v_mfma_f32_16x16x32_bf16 v[72:75], a[40:43], v[60:63], v[72:75]
    v_mov_b32_dpp v115, v76 quad_perm:[0,0,0,0] row_mask:0xf bank_mask:0xf
    v_add_f32_dpp v115, v77, v115 quad_perm:[1,1,1,1] row_mask:0xf bank_mask:0xf
    v_add_f32_dpp v115, v78, v115 quad_perm:[2,2,2,2] row_mask:0xf bank_mask:0xf
    v_add_f32_dpp v115, v79, v115 quad_perm:[3,3,3,3] row_mask:0xf bank_mask:0xf
    v_cvt_pk_bf16_f32 v115, 0, v115
    v_mul_f32 v115, 0x3db504f3, v115
    v_cvt_pk_bf16_f32 v115, 0, v115
    v_max_f32 v13, v13, v115
    buffer_load_dwordx4 a[184:187], v7, s[28:31], s58 offen offset:0 nt
    buffer_load_dwordx4 a[192:195], v4, s[8:11], s56 offen offset:2048 nt
    buffer_load_dwordx4 a[200:203], v4, s[8:11], s56 offen offset:3072 nt
    v_mov_b32_dpp v10, v32 row_newbcast:1 row_mask:0xf bank_mask:0x3
    v_mov_b32_dpp v10, v32 row_newbcast:9 row_mask:0xf bank_mask:0xc
    v_and_b32 v40, v10, v28
    v_and_b32 v41, v10, v29
    v_and_b32 v42, v10, v30
    v_and_b32 v43, v10, v31
    s_waitcnt vmcnt(19)
    s_nop 0
    v_mfma_f32_16x16x32_bf16 v[64:67], v[40:43], a[48:51], v[64:67]
    s_waitcnt vmcnt(17)
    v_mfma_f32_16x16x32_bf16 v[68:71], v[40:43], a[64:67], v[68:71]
    s_add_u32 s58, s53, 138240
    buffer_load_dwordx4 a[208:211], v7, s[24:27], s58 offen offset:0 nt
    s_add_u32 s56, s51, 262144
    buffer_load_dwordx4 a[216:219], v4, s[8:11], s56 offen offset:0 nt
    buffer_load_dwordx4 a[224:227], v4, s[8:11], s56 offen offset:1024 nt
    buffer_load_dwordx4 a[232:235], v7, s[28:31], s58 offen offset:0 nt
    v_mfma_f32_16x16x32_bf16 v[76:79], a[56:59], v[48:51], 0
    s_waitcnt vmcnt(20)
    v_mfma_f32_16x16x32_bf16 v[76:79], a[72:75], v[52:55], v[76:79]
    s_waitcnt vmcnt(19)
    v_mfma_f32_16x16x32_bf16 v[76:79], a[80:83], v[56:59], v[76:79]
    s_waitcnt vmcnt(17)
    v_mfma_f32_16x16x32_bf16 v[76:79], a[96:99], v[60:63], v[76:79]
    v_mov_b32_dpp v116, v72 quad_perm:[0,0,0,0] row_mask:0xf bank_mask:0xf
    v_add_f32_dpp v116, v73, v116 quad_perm:[1,1,1,1] row_mask:0xf bank_mask:0xf
    v_add_f32_dpp v116, v74, v116 quad_perm:[2,2,2,2] row_mask:0xf bank_mask:0xf
    v_add_f32_dpp v116, v75, v116 quad_perm:[3,3,3,3] row_mask:0xf bank_mask:0xf
    v_cvt_pk_bf16_f32 v116, 0, v116
    v_mul_f32 v116, 0x3db504f3, v116
    v_cvt_pk_bf16_f32 v116, 0, v116
    v_max_f32 v13, v13, v116
    buffer_load_dwordx4 a[240:243], v4, s[8:11], s56 offen offset:2048 nt
    v_mov_b32_dpp v10, v32 row_newbcast:2 row_mask:0xf bank_mask:0x3
    v_mov_b32_dpp v10, v32 row_newbcast:10 row_mask:0xf bank_mask:0xc
    v_and_b32 v44, v10, v28
    v_and_b32 v45, v10, v29
    v_and_b32 v46, v10, v30
    v_and_b32 v47, v10, v31
    s_nop 1
    v_mfma_f32_16x16x32_bf16 v[64:67], v[44:47], a[88:91], v[64:67]
    s_waitcnt vmcnt(17)
    v_mfma_f32_16x16x32_bf16 v[68:71], v[44:47], a[104:107], v[68:71]
    s_add_u32 s58, s53, 165888
    buffer_load_dwordx4 a[248:251], v7, s[24:27], s58 offen offset:0 nt
    buffer_load_dwordx4 v[156:159], v4, s[8:11], s56 offen offset:3072 nt
    s_add_u32 s56, s51, 278528
    buffer_load_dwordx4 v[164:167], v4, s[8:11], s56 offen offset:0 nt
    buffer_load_dwordx4 v[172:175], v7, s[28:31], s58 offen offset:0 nt
    buffer_load_dwordx4 v[180:183], v4, s[8:11], s56 offen offset:1024 nt
    v_mov_b32_dpp v10, v32 row_newbcast:3 row_mask:0xf bank_mask:0x3
    v_mov_b32_dpp v10, v32 row_newbcast:11 row_mask:0xf bank_mask:0xc
    v_and_b32 v40, v10, v28
    v_and_b32 v41, v10, v29
    v_and_b32 v42, v10, v30
    v_and_b32 v43, v10, v31
    s_waitcnt vmcnt(19)
    s_nop 0
    v_mfma_f32_16x16x32_bf16 v[64:67], v[40:43], a[128:131], v[64:67]
    s_waitcnt vmcnt(17)
    v_mfma_f32_16x16x32_bf16 v[68:71], v[40:43], a[144:147], v[68:71]
    s_add_u32 s58, s53, 193536
    buffer_load_dwordx4 v[188:191], v7, s[24:27], s58 offen offset:0 nt
    v_mfma_f32_16x16x32_bf16 v[72:75], a[112:115], v[48:51], 0
    v_mfma_f32_16x16x32_bf16 v[72:75], a[120:123], v[52:55], v[72:75]
    v_mfma_f32_16x16x32_bf16 v[72:75], a[136:139], v[56:59], v[72:75]
    s_waitcnt vmcnt(17)
    v_mfma_f32_16x16x32_bf16 v[72:75], a[152:155], v[60:63], v[72:75]
    v_mov_b32_dpp v117, v76 quad_perm:[0,0,0,0] row_mask:0xf bank_mask:0xf
    v_add_f32_dpp v117, v77, v117 quad_perm:[1,1,1,1] row_mask:0xf bank_mask:0xf
    v_add_f32_dpp v117, v78, v117 quad_perm:[2,2,2,2] row_mask:0xf bank_mask:0xf
    v_add_f32_dpp v117, v79, v117 quad_perm:[3,3,3,3] row_mask:0xf bank_mask:0xf
    v_cvt_pk_bf16_f32 v117, 0, v117
    v_mul_f32 v117, 0x3db504f3, v117
    v_cvt_pk_bf16_f32 v117, 0, v117
    v_max_f32 v13, v13, v117
    buffer_load_dwordx4 v[196:199], v4, s[8:11], s56 offen offset:2048 nt
    buffer_load_dwordx4 v[204:207], v4, s[8:11], s56 offen offset:3072 nt
    buffer_load_dwordx4 v[212:215], v7, s[28:31], s58 offen offset:0 nt
    s_add_u32 s56, s51, 294912
    buffer_load_dwordx4 v[220:223], v4, s[8:11], s56 offen offset:0 nt
    v_mov_b32_dpp v10, v32 row_newbcast:4 row_mask:0xf bank_mask:0x3
    v_mov_b32_dpp v10, v32 row_newbcast:12 row_mask:0xf bank_mask:0xc
    v_and_b32 v44, v10, v28
    v_and_b32 v45, v10, v29
    v_and_b32 v46, v10, v30
    v_and_b32 v47, v10, v31
    s_waitcnt vmcnt(19)
    s_nop 0
    v_mfma_f32_16x16x32_bf16 v[64:67], v[44:47], a[168:171], v[64:67]
    s_waitcnt vmcnt(17)
    v_mfma_f32_16x16x32_bf16 v[68:71], v[44:47], a[184:187], v[68:71]
    s_add_u32 s58, s53, 221184
    buffer_load_dwordx4 a[0:3], v7, s[24:27], s58 offen offset:0 nt
    buffer_load_dwordx4 a[4:7], v4, s[8:11], s56 offen offset:1024 nt
    v_mfma_f32_16x16x32_bf16 v[76:79], a[160:163], v[48:51], 0
    v_mfma_f32_16x16x32_bf16 v[76:79], a[176:179], v[52:55], v[76:79]
    s_waitcnt vmcnt(18)
    v_mfma_f32_16x16x32_bf16 v[76:79], a[192:195], v[56:59], v[76:79]
    s_waitcnt vmcnt(17)
    v_mfma_f32_16x16x32_bf16 v[76:79], a[200:203], v[60:63], v[76:79]
    v_mov_b32_dpp v118, v72 quad_perm:[0,0,0,0] row_mask:0xf bank_mask:0xf
    v_add_f32_dpp v118, v73, v118 quad_perm:[1,1,1,1] row_mask:0xf bank_mask:0xf
    v_add_f32_dpp v118, v74, v118 quad_perm:[2,2,2,2] row_mask:0xf bank_mask:0xf
    v_add_f32_dpp v118, v75, v118 quad_perm:[3,3,3,3] row_mask:0xf bank_mask:0xf
    v_cvt_pk_bf16_f32 v118, 0, v118
    v_mul_f32 v118, 0x3db504f3, v118
    v_cvt_pk_bf16_f32 v118, 0, v118
    v_max_f32 v13, v13, v118
    buffer_load_dwordx4 a[12:15], v4, s[8:11], s56 offen offset:2048 nt
    buffer_load_dwordx4 a[20:23], v7, s[28:31], s58 offen offset:0 nt
    buffer_load_dwordx4 a[28:31], v4, s[8:11], s56 offen offset:3072 nt
    s_add_u32 s58, s53, 248832
    buffer_load_dwordx4 a[36:39], v7, s[24:27], s58 offen offset:0 nt
    v_mov_b32_dpp v10, v32 row_newbcast:5 row_mask:0xf bank_mask:0x3
    v_mov_b32_dpp v10, v32 row_newbcast:13 row_mask:0xf bank_mask:0xc
    v_and_b32 v40, v10, v28
    v_and_b32 v41, v10, v29
    v_and_b32 v42, v10, v30
    v_and_b32 v43, v10, v31
    s_waitcnt vmcnt(20)
    s_nop 0
    v_mfma_f32_16x16x32_bf16 v[64:67], v[40:43], a[208:211], v[64:67]
    s_waitcnt vmcnt(17)
    v_mfma_f32_16x16x32_bf16 v[68:71], v[40:43], a[232:235], v[68:71]
    s_add_u32 s56, s51, 311296
    buffer_load_dwordx4 a[44:47], v4, s[8:11], s56 offen offset:0 nt
    buffer_load_dwordx4 a[52:55], v4, s[8:11], s56 offen offset:1024 nt
    buffer_load_dwordx4 a[60:63], v7, s[28:31], s58 offen offset:0 nt
    v_mfma_f32_16x16x32_bf16 v[72:75], a[216:219], v[48:51], 0
    v_mfma_f32_16x16x32_bf16 v[72:75], a[224:227], v[52:55], v[72:75]
    s_waitcnt vmcnt(19)
    v_mfma_f32_16x16x32_bf16 v[72:75], a[240:243], v[56:59], v[72:75]
    s_waitcnt vmcnt(17)
    v_mfma_f32_16x16x32_bf16 v[72:75], v[156:159], v[60:63], v[72:75]
    v_mov_b32_dpp v119, v76 quad_perm:[0,0,0,0] row_mask:0xf bank_mask:0xf
    v_add_f32_dpp v119, v77, v119 quad_perm:[1,1,1,1] row_mask:0xf bank_mask:0xf
    v_add_f32_dpp v119, v78, v119 quad_perm:[2,2,2,2] row_mask:0xf bank_mask:0xf
    v_add_f32_dpp v119, v79, v119 quad_perm:[3,3,3,3] row_mask:0xf bank_mask:0xf
    v_cvt_pk_bf16_f32 v119, 0, v119
    v_mul_f32 v119, 0x3db504f3, v119
    v_cvt_pk_bf16_f32 v119, 0, v119
    v_max_f32 v13, v13, v119
    buffer_load_dwordx4 a[68:71], v4, s[8:11], s56 offen offset:2048 nt
    s_add_u32 s58, s53, 276480
    buffer_load_dwordx4 a[76:79], v7, s[24:27], s58 offen offset:0 nt
    v_mov_b32_dpp v10, v32 row_newbcast:6 row_mask:0xf bank_mask:0x3
    v_mov_b32_dpp v10, v32 row_newbcast:14 row_mask:0xf bank_mask:0xc
    v_and_b32 v44, v10, v28
    v_and_b32 v45, v10, v29
    v_and_b32 v46, v10, v30
    v_and_b32 v47, v10, v31
    s_nop 1
    v_mfma_f32_16x16x32_bf16 v[64:67], v[44:47], a[248:251], v[64:67]
    s_waitcnt vmcnt(17)
    v_mfma_f32_16x16x32_bf16 v[68:71], v[44:47], v[172:175], v[68:71]
    buffer_load_dwordx4 a[84:87], v4, s[8:11], s56 offen offset:3072 nt
    s_add_u32 s56, s51, 327680
    buffer_load_dwordx4 a[92:95], v4, s[8:11], s56 offen offset:0 nt
    buffer_load_dwordx4 a[100:103], v7, s[28:31], s58 offen offset:0 nt
    buffer_load_dwordx4 a[108:111], v4, s[8:11], s56 offen offset:1024 nt
    v_mfma_f32_16x16x32_bf16 v[76:79], v[164:167], v[48:51], 0
    s_waitcnt vmcnt(20)
    v_mfma_f32_16x16x32_bf16 v[76:79], v[180:183], v[52:55], v[76:79]
    s_waitcnt vmcnt(18)
    v_mfma_f32_16x16x32_bf16 v[76:79], v[196:199], v[56:59], v[76:79]
    s_waitcnt vmcnt(17)
    v_mfma_f32_16x16x32_bf16 v[76:79], v[204:207], v[60:63], v[76:79]
    v_mov_b32_dpp v120, v72 quad_perm:[0,0,0,0] row_mask:0xf bank_mask:0xf
    v_add_f32_dpp v120, v73, v120 quad_perm:[1,1,1,1] row_mask:0xf bank_mask:0xf
    v_add_f32_dpp v120, v74, v120 quad_perm:[2,2,2,2] row_mask:0xf bank_mask:0xf
    v_add_f32_dpp v120, v75, v120 quad_perm:[3,3,3,3] row_mask:0xf bank_mask:0xf
    v_cvt_pk_bf16_f32 v120, 0, v120
    v_mul_f32 v120, 0x3db504f3, v120
    v_cvt_pk_bf16_f32 v120, 0, v120
    v_max_f32 v13, v13, v120
    buffer_load_dwordx4 a[116:119], v4, s[8:11], s56 offen offset:2048 nt
    v_mov_b32_dpp v10, v32 row_newbcast:7 row_mask:0xf bank_mask:0x3
    v_mov_b32_dpp v10, v32 row_newbcast:15 row_mask:0xf bank_mask:0xc
    v_and_b32 v40, v10, v28
    v_and_b32 v41, v10, v29
    v_and_b32 v42, v10, v30
    v_and_b32 v43, v10, v31
    s_nop 1
    v_mfma_f32_16x16x32_bf16 v[64:67], v[40:43], v[188:191], v[64:67]
    s_waitcnt vmcnt(17)
    v_mfma_f32_16x16x32_bf16 v[68:71], v[40:43], v[212:215], v[68:71]
    s_add_u32 s58, s53, 304128
    buffer_load_dwordx4 a[124:127], v7, s[24:27], s58 offen offset:0 nt
    buffer_load_dwordx4 a[132:135], v4, s[8:11], s56 offen offset:3072 nt
    buffer_load_dwordx4 a[140:143], v7, s[28:31], s58 offen offset:0 nt
    s_add_u32 s56, s51, 344064
    buffer_load_dwordx4 a[148:151], v4, s[8:11], s56 offen offset:0 nt
    buffer_load_dwordx4 a[156:159], v4, s[8:11], s56 offen offset:1024 nt
    v_mov_b32_dpp v10, v33 row_newbcast:0 row_mask:0xf bank_mask:0x3
    v_mov_b32_dpp v10, v33 row_newbcast:8 row_mask:0xf bank_mask:0xc
    v_and_b32 v44, v10, v28
    v_and_b32 v45, v10, v29
    v_and_b32 v46, v10, v30
    v_and_b32 v47, v10, v31
    s_waitcnt vmcnt(20)
    s_nop 0
    v_mfma_f32_16x16x32_bf16 v[64:67], v[44:47], a[0:3], v[64:67]
    s_waitcnt vmcnt(17)
    v_mfma_f32_16x16x32_bf16 v[68:71], v[44:47], a[20:23], v[68:71]
    s_add_u32 s58, s53, 331776
    buffer_load_dwordx4 a[164:167], v7, s[24:27], s58 offen offset:0 nt
    v_mfma_f32_16x16x32_bf16 v[72:75], v[220:223], v[48:51], 0
    v_mfma_f32_16x16x32_bf16 v[72:75], a[4:7], v[52:55], v[72:75]
    v_mfma_f32_16x16x32_bf16 v[72:75], a[12:15], v[56:59], v[72:75]
    s_waitcnt vmcnt(17)
    v_mfma_f32_16x16x32_bf16 v[72:75], a[28:31], v[60:63], v[72:75]
    v_mov_b32_dpp v121, v76 quad_perm:[0,0,0,0] row_mask:0xf bank_mask:0xf
    v_add_f32_dpp v121, v77, v121 quad_perm:[1,1,1,1] row_mask:0xf bank_mask:0xf
    v_add_f32_dpp v121, v78, v121 quad_perm:[2,2,2,2] row_mask:0xf bank_mask:0xf
    v_add_f32_dpp v121, v79, v121 quad_perm:[3,3,3,3] row_mask:0xf bank_mask:0xf
    v_cvt_pk_bf16_f32 v121, 0, v121
    v_mul_f32 v121, 0x3db504f3, v121
    v_cvt_pk_bf16_f32 v121, 0, v121
    v_max_f32 v13, v13, v121
    buffer_load_dwordx4 a[172:175], v4, s[8:11], s56 offen offset:2048 nt
    buffer_load_dwordx4 a[180:183], v7, s[28:31], s58 offen offset:0 nt
    buffer_load_dwordx4 a[188:191], v4, s[8:11], s56 offen offset:3072 nt
    s_add_u32 s56, s51, 360448
    buffer_load_dwordx4 a[196:199], v4, s[8:11], s56 offen offset:0 nt
    v_mov_b32_dpp v10, v33 row_newbcast:1 row_mask:0xf bank_mask:0x3
    v_mov_b32_dpp v10, v33 row_newbcast:9 row_mask:0xf bank_mask:0xc
    v_and_b32 v40, v10, v28
    v_and_b32 v41, v10, v29
    v_and_b32 v42, v10, v30
    v_and_b32 v43, v10, v31
    s_waitcnt vmcnt(20)
    s_nop 0
    v_mfma_f32_16x16x32_bf16 v[64:67], v[40:43], a[36:39], v[64:67]
    s_waitcnt vmcnt(17)
    v_mfma_f32_16x16x32_bf16 v[68:71], v[40:43], a[60:63], v[68:71]
    s_add_u32 s58, s53, 359424
    buffer_load_dwordx4 a[204:207], v7, s[24:27], s58 offen offset:0 nt
    buffer_load_dwordx4 a[212:215], v4, s[8:11], s56 offen offset:1024 nt
    buffer_load_dwordx4 a[220:223], v7, s[28:31], s58 offen offset:0 nt
    v_mfma_f32_16x16x32_bf16 v[76:79], a[44:47], v[48:51], 0
    v_mfma_f32_16x16x32_bf16 v[76:79], a[52:55], v[52:55], v[76:79]
    s_waitcnt vmcnt(19)
    v_mfma_f32_16x16x32_bf16 v[76:79], a[68:71], v[56:59], v[76:79]
    s_waitcnt vmcnt(17)
    v_mfma_f32_16x16x32_bf16 v[76:79], a[84:87], v[60:63], v[76:79]
    v_mov_b32_dpp v122, v72 quad_perm:[0,0,0,0] row_mask:0xf bank_mask:0xf
    v_add_f32_dpp v122, v73, v122 quad_perm:[1,1,1,1] row_mask:0xf bank_mask:0xf
    v_add_f32_dpp v122, v74, v122 quad_perm:[2,2,2,2] row_mask:0xf bank_mask:0xf
    v_add_f32_dpp v122, v75, v122 quad_perm:[3,3,3,3] row_mask:0xf bank_mask:0xf
    v_cvt_pk_bf16_f32 v122, 0, v122
    v_mul_f32 v122, 0x3db504f3, v122
    v_cvt_pk_bf16_f32 v122, 0, v122
    v_max_f32 v13, v13, v122
    buffer_load_dwordx4 a[228:231], v4, s[8:11], s56 offen offset:2048 nt
    buffer_load_dwordx4 a[236:239], v4, s[8:11], s56 offen offset:3072 nt
    v_mov_b32_dpp v10, v33 row_newbcast:2 row_mask:0xf bank_mask:0x3
    v_mov_b32_dpp v10, v33 row_newbcast:10 row_mask:0xf bank_mask:0xc
    v_and_b32 v44, v10, v28
    v_and_b32 v45, v10, v29
    v_and_b32 v46, v10, v30
    v_and_b32 v47, v10, v31
    s_nop 1
    v_mfma_f32_16x16x32_bf16 v[64:67], v[44:47], a[76:79], v[64:67]
    s_waitcnt vmcnt(17)
    v_mfma_f32_16x16x32_bf16 v[68:71], v[44:47], a[100:103], v[68:71]
    s_add_u32 s58, s53, 387072
    buffer_load_dwordx4 a[244:247], v7, s[24:27], s58 offen offset:0 nt
    s_add_u32 s56, s51, 376832
    buffer_load_dwordx4 a[252:255], v4, s[8:11], s56 offen offset:0 nt
    buffer_load_dwordx4 v[160:163], v7, s[28:31], s58 offen offset:0 nt
    buffer_load_dwordx4 v[168:171], v4, s[8:11], s56 offen offset:1024 nt
    v_mfma_f32_16x16x32_bf16 v[72:75], a[92:95], v[48:51], 0
    s_waitcnt vmcnt(20)
    v_mfma_f32_16x16x32_bf16 v[72:75], a[108:111], v[52:55], v[72:75]
    s_waitcnt vmcnt(19)
    v_mfma_f32_16x16x32_bf16 v[72:75], a[116:119], v[56:59], v[72:75]
    s_waitcnt vmcnt(17)
    v_mfma_f32_16x16x32_bf16 v[72:75], a[132:135], v[60:63], v[72:75]
    v_mov_b32_dpp v123, v76 quad_perm:[0,0,0,0] row_mask:0xf bank_mask:0xf
    v_add_f32_dpp v123, v77, v123 quad_perm:[1,1,1,1] row_mask:0xf bank_mask:0xf
    v_add_f32_dpp v123, v78, v123 quad_perm:[2,2,2,2] row_mask:0xf bank_mask:0xf
    v_add_f32_dpp v123, v79, v123 quad_perm:[3,3,3,3] row_mask:0xf bank_mask:0xf
    v_cvt_pk_bf16_f32 v123, 0, v123
    v_mul_f32 v123, 0x3db504f3, v123
    v_cvt_pk_bf16_f32 v123, 0, v123
    v_max_f32 v13, v13, v123
    buffer_load_dwordx4 v[176:179], v4, s[8:11], s56 offen offset:2048 nt
    v_mov_b32_dpp v10, v33 row_newbcast:3 row_mask:0xf bank_mask:0x3
    v_mov_b32_dpp v10, v33 row_newbcast:11 row_mask:0xf bank_mask:0xc
    v_and_b32 v40, v10, v28
    v_and_b32 v41, v10, v29
    v_and_b32 v42, v10, v30
    v_and_b32 v43, v10, v31
    s_nop 1
    v_mfma_f32_16x16x32_bf16 v[64:67], v[40:43], a[124:127], v[64:67]
    s_waitcnt vmcnt(17)
    v_mfma_f32_16x16x32_bf16 v[68:71], v[40:43], a[140:143], v[68:71]
    s_add_u32 s58, s53, 414720
    buffer_load_dwordx4 v[184:187], v7, s[24:27], s58 offen offset:0 nt
    buffer_load_dwordx4 v[192:195], v4, s[8:11], s56 offen offset:3072 nt
    s_add_u32 s56, s51, 393216
    buffer_load_dwordx4 v[200:203], v4, s[8:11], s56 offen offset:0 nt
    buffer_load_dwordx4 v[208:211], v7, s[28:31], s58 offen offset:0 nt
    buffer_load_dwordx4 v[216:219], v4, s[8:11], s56 offen offset:1024 nt
    v_mov_b32_dpp v10, v33 row_newbcast:4 row_mask:0xf bank_mask:0x3
    v_mov_b32_dpp v10, v33 row_newbcast:12 row_mask:0xf bank_mask:0xc
    v_and_b32 v44, v10, v28
    v_and_b32 v45, v10, v29
    v_and_b32 v46, v10, v30
    v_and_b32 v47, v10, v31
    s_waitcnt vmcnt(19)
    s_nop 0
    v_mfma_f32_16x16x32_bf16 v[64:67], v[44:47], a[164:167], v[64:67]
    s_waitcnt vmcnt(17)
    v_mfma_f32_16x16x32_bf16 v[68:71], v[44:47], a[180:183], v[68:71]
    s_add_u32 s58, s53, 442368
    buffer_load_dwordx4 v[224:227], v7, s[24:27], s58 offen offset:0 nt
    v_mfma_f32_16x16x32_bf16 v[76:79], a[148:151], v[48:51], 0
    v_mfma_f32_16x16x32_bf16 v[76:79], a[156:159], v[52:55], v[76:79]
    v_mfma_f32_16x16x32_bf16 v[76:79], a[172:175], v[56:59], v[76:79]
    s_waitcnt vmcnt(17)
    v_mfma_f32_16x16x32_bf16 v[76:79], a[188:191], v[60:63], v[76:79]
    v_mov_b32_dpp v124, v72 quad_perm:[0,0,0,0] row_mask:0xf bank_mask:0xf
    v_add_f32_dpp v124, v73, v124 quad_perm:[1,1,1,1] row_mask:0xf bank_mask:0xf
    v_add_f32_dpp v124, v74, v124 quad_perm:[2,2,2,2] row_mask:0xf bank_mask:0xf
    v_add_f32_dpp v124, v75, v124 quad_perm:[3,3,3,3] row_mask:0xf bank_mask:0xf
    v_cvt_pk_bf16_f32 v124, 0, v124
    v_mul_f32 v124, 0x3db504f3, v124
    v_cvt_pk_bf16_f32 v124, 0, v124
    v_max_f32 v13, v13, v124
    buffer_load_dwordx4 v[228:231], v4, s[8:11], s56 offen offset:2048 nt
    buffer_load_dwordx4 v[232:235], v4, s[8:11], s56 offen offset:3072 nt
    buffer_load_dwordx4 v[236:239], v7, s[28:31], s58 offen offset:0 nt
    s_add_u32 s56, s51, 409600
    buffer_load_dwordx4 v[240:243], v4, s[8:11], s56 offen offset:0 nt
    v_mov_b32_dpp v10, v33 row_newbcast:5 row_mask:0xf bank_mask:0x3
    v_mov_b32_dpp v10, v33 row_newbcast:13 row_mask:0xf bank_mask:0xc
    v_and_b32 v40, v10, v28
    v_and_b32 v41, v10, v29
    v_and_b32 v42, v10, v30
    v_and_b32 v43, v10, v31
    s_waitcnt vmcnt(19)
    s_nop 0
    v_mfma_f32_16x16x32_bf16 v[64:67], v[40:43], a[204:207], v[64:67]
    s_waitcnt vmcnt(17)
    v_mfma_f32_16x16x32_bf16 v[68:71], v[40:43], a[220:223], v[68:71]
    s_add_u32 s58, s53, 470016
    buffer_load_dwordx4 v[244:247], v7, s[24:27], s58 offen offset:0 nt
    buffer_load_dwordx4 v[248:251], v4, s[8:11], s56 offen offset:1024 nt
    v_mfma_f32_16x16x32_bf16 v[72:75], a[196:199], v[48:51], 0
    v_mfma_f32_16x16x32_bf16 v[72:75], a[212:215], v[52:55], v[72:75]
    s_waitcnt vmcnt(18)
    v_mfma_f32_16x16x32_bf16 v[72:75], a[228:231], v[56:59], v[72:75]
    s_waitcnt vmcnt(17)
    v_mfma_f32_16x16x32_bf16 v[72:75], a[236:239], v[60:63], v[72:75]
    v_mov_b32_dpp v125, v76 quad_perm:[0,0,0,0] row_mask:0xf bank_mask:0xf
    v_add_f32_dpp v125, v77, v125 quad_perm:[1,1,1,1] row_mask:0xf bank_mask:0xf
    v_add_f32_dpp v125, v78, v125 quad_perm:[2,2,2,2] row_mask:0xf bank_mask:0xf
    v_add_f32_dpp v125, v79, v125 quad_perm:[3,3,3,3] row_mask:0xf bank_mask:0xf
    v_cvt_pk_bf16_f32 v125, 0, v125
    v_mul_f32 v125, 0x3db504f3, v125
    v_cvt_pk_bf16_f32 v125, 0, v125
    v_max_f32 v13, v13, v125
    buffer_load_dwordx4 v[252:255], v4, s[8:11], s56 offen offset:2048 nt
    buffer_load_dwordx4 a[24:27], v7, s[28:31], s58 offen offset:0 nt
    buffer_load_dwordx4 a[8:11], v4, s[8:11], s56 offen offset:3072 nt
    v_mov_b32_dpp v10, v33 row_newbcast:6 row_mask:0xf bank_mask:0x3
    v_mov_b32_dpp v10, v33 row_newbcast:14 row_mask:0xf bank_mask:0xc
    v_and_b32 v44, v10, v28
    v_and_b32 v45, v10, v29
    v_and_b32 v46, v10, v30
    v_and_b32 v47, v10, v31
    s_waitcnt vmcnt(19)
    s_nop 0
    v_mfma_f32_16x16x32_bf16 v[64:67], v[44:47], a[244:247], v[64:67]
    s_waitcnt vmcnt(17)
    v_mfma_f32_16x16x32_bf16 v[68:71], v[44:47], v[160:163], v[68:71]
    s_add_u32 s58, s53, 497664
    buffer_load_dwordx4 a[16:19], v7, s[24:27], s58 offen offset:0 nt
    s_add_u32 s56, s51, 425984
    buffer_load_dwordx4 a[32:35], v4, s[8:11], s56 offen offset:0 nt
    buffer_load_dwordx4 a[40:43], v4, s[8:11], s56 offen offset:1024 nt
    buffer_load_dwordx4 a[48:51], v7, s[28:31], s58 offen offset:0 nt
    v_mfma_f32_16x16x32_bf16 v[76:79], a[252:255], v[48:51], 0
    s_waitcnt vmcnt(20)
    v_mfma_f32_16x16x32_bf16 v[76:79], v[168:171], v[52:55], v[76:79]
    s_waitcnt vmcnt(19)
    v_mfma_f32_16x16x32_bf16 v[76:79], v[176:179], v[56:59], v[76:79]
    s_waitcnt vmcnt(17)
    v_mfma_f32_16x16x32_bf16 v[76:79], v[192:195], v[60:63], v[76:79]
    v_mov_b32_dpp v126, v72 quad_perm:[0,0,0,0] row_mask:0xf bank_mask:0xf
    v_add_f32_dpp v126, v73, v126 quad_perm:[1,1,1,1] row_mask:0xf bank_mask:0xf
    v_add_f32_dpp v126, v74, v126 quad_perm:[2,2,2,2] row_mask:0xf bank_mask:0xf
    v_add_f32_dpp v126, v75, v126 quad_perm:[3,3,3,3] row_mask:0xf bank_mask:0xf
    v_cvt_pk_bf16_f32 v126, 0, v126
    v_mul_f32 v126, 0x3db504f3, v126
    v_cvt_pk_bf16_f32 v126, 0, v126
    v_max_f32 v13, v13, v126
    buffer_load_dwordx4 a[64:67], v4, s[8:11], s56 offen offset:2048 nt
    s_add_u32 s58, s53, 525312
    buffer_load_dwordx4 a[56:59], v7, s[24:27], s58 offen offset:0 nt
    v_mov_b32_dpp v10, v33 row_newbcast:7 row_mask:0xf bank_mask:0x3
    v_mov_b32_dpp v10, v33 row_newbcast:15 row_mask:0xf bank_mask:0xc
    v_and_b32 v40, v10, v28
    v_and_b32 v41, v10, v29
    v_and_b32 v42, v10, v30
    v_and_b32 v43, v10, v31
    s_nop 1
    v_mfma_f32_16x16x32_bf16 v[64:67], v[40:43], v[184:187], v[64:67]
    s_waitcnt vmcnt(17)
    v_mfma_f32_16x16x32_bf16 v[68:71], v[40:43], v[208:211], v[68:71]
    buffer_load_dwordx4 a[72:75], v4, s[8:11], s56 offen offset:3072 nt
    s_add_u32 s56, s51, 442368
    buffer_load_dwordx4 a[80:83], v4, s[8:11], s56 offen offset:0 nt
    buffer_load_dwordx4 a[96:99], v7, s[28:31], s58 offen offset:0 nt
    buffer_load_dwordx4 a[88:91], v4, s[8:11], s56 offen offset:1024 nt
    v_mfma_f32_16x16x32_bf16 v[72:75], v[200:203], v[48:51], 0
    s_waitcnt vmcnt(20)
    v_mfma_f32_16x16x32_bf16 v[72:75], v[216:219], v[52:55], v[72:75]
    s_waitcnt vmcnt(18)
    v_mfma_f32_16x16x32_bf16 v[72:75], v[228:231], v[56:59], v[72:75]
    s_waitcnt vmcnt(17)
    v_mfma_f32_16x16x32_bf16 v[72:75], v[232:235], v[60:63], v[72:75]
    v_mov_b32_dpp v127, v76 quad_perm:[0,0,0,0] row_mask:0xf bank_mask:0xf
    v_add_f32_dpp v127, v77, v127 quad_perm:[1,1,1,1] row_mask:0xf bank_mask:0xf
    v_add_f32_dpp v127, v78, v127 quad_perm:[2,2,2,2] row_mask:0xf bank_mask:0xf
    v_add_f32_dpp v127, v79, v127 quad_perm:[3,3,3,3] row_mask:0xf bank_mask:0xf
    v_cvt_pk_bf16_f32 v127, 0, v127
    v_mul_f32 v127, 0x3db504f3, v127
    v_cvt_pk_bf16_f32 v127, 0, v127
    v_max_f32 v13, v13, v127
    buffer_load_dwordx4 a[104:107], v4, s[8:11], s56 offen offset:2048 nt
    v_mov_b32_dpp v10, v34 row_newbcast:0 row_mask:0xf bank_mask:0x3
    v_mov_b32_dpp v10, v34 row_newbcast:8 row_mask:0xf bank_mask:0xc
    v_and_b32 v44, v10, v28
    v_and_b32 v45, v10, v29
    v_and_b32 v46, v10, v30
    v_and_b32 v47, v10, v31
    s_nop 1
    v_mfma_f32_16x16x32_bf16 v[64:67], v[44:47], v[224:227], v[64:67]
    s_waitcnt vmcnt(17)
    v_mfma_f32_16x16x32_bf16 v[68:71], v[44:47], v[236:239], v[68:71]
    buffer_load_dwordx4 a[128:131], v4, s[8:11], s56 offen offset:3072 nt
    s_add_u32 s56, s51, 0
    buffer_load_dwordx4 a[144:147], v5, s[12:15], s56 offen offset:0 nt
    buffer_load_dwordx4 a[112:115], v5, s[12:15], s56 offen offset:1024 nt
    s_add_u32 s58, s55, 0
    buffer_load_dwordx4 a[120:123], v9, s[32:35], s58 offen offset:0
    buffer_load_dwordx4 a[136:139], v5, s[12:15], s56 offen offset:2048 nt
    v_mov_b32_dpp v10, v34 row_newbcast:1 row_mask:0xf bank_mask:0x3
    v_mov_b32_dpp v10, v34 row_newbcast:9 row_mask:0xf bank_mask:0xc
    v_and_b32 v40, v10, v28
    v_and_b32 v41, v10, v29
    v_and_b32 v42, v10, v30
    v_and_b32 v43, v10, v31
    s_waitcnt vmcnt(20)
    s_nop 0
    v_mfma_f32_16x16x32_bf16 v[64:67], v[40:43], v[244:247], v[64:67]
    s_waitcnt vmcnt(17)
    v_mfma_f32_16x16x32_bf16 v[68:71], v[40:43], a[24:27], v[68:71]
    buffer_load_dwordx4 a[152:155], v9, s[32:35], s58 offen offset:256
    v_mfma_f32_16x16x32_bf16 v[76:79], v[240:243], v[48:51], 0
    v_mfma_f32_16x16x32_bf16 v[76:79], v[248:251], v[52:55], v[76:79]
    v_mfma_f32_16x16x32_bf16 v[76:79], v[252:255], v[56:59], v[76:79]
    s_waitcnt vmcnt(17)
    v_mfma_f32_16x16x32_bf16 v[76:79], a[8:11], v[60:63], v[76:79]
    v_mov_b32_dpp v128, v72 quad_perm:[0,0,0,0] row_mask:0xf bank_mask:0xf
    v_add_f32_dpp v128, v73, v128 quad_perm:[1,1,1,1] row_mask:0xf bank_mask:0xf
    v_add_f32_dpp v128, v74, v128 quad_perm:[2,2,2,2] row_mask:0xf bank_mask:0xf
    v_add_f32_dpp v128, v75, v128 quad_perm:[3,3,3,3] row_mask:0xf bank_mask:0xf
    v_cvt_pk_bf16_f32 v128, 0, v128
    v_mul_f32 v128, 0x3db504f3, v128
    v_cvt_pk_bf16_f32 v128, 0, v128
    v_max_f32 v13, v13, v128
    buffer_load_dwordx4 a[168:171], v5, s[12:15], s56 offen offset:3072 nt
    buffer_load_dwordx4 a[184:187], v9, s[32:35], s58 offen offset:512
    s_add_u32 s56, s51, 16384
    buffer_load_dwordx4 a[160:163], v5, s[12:15], s56 offen offset:0 nt
    buffer_load_dwordx4 a[176:179], v9, s[32:35], s58 offen offset:768
    v_mov_b32_dpp v10, v34 row_newbcast:2 row_mask:0xf bank_mask:0x3
    v_mov_b32_dpp v10, v34 row_newbcast:10 row_mask:0xf bank_mask:0xc
    v_and_b32 v44, v10, v28
    v_and_b32 v45, v10, v29
    v_and_b32 v46, v10, v30
    v_and_b32 v47, v10, v31
    s_waitcnt vmcnt(20)
    s_nop 0
    v_mfma_f32_16x16x32_bf16 v[64:67], v[44:47], a[16:19], v[64:67]
    s_waitcnt vmcnt(17)
    v_mfma_f32_16x16x32_bf16 v[68:71], v[44:47], a[48:51], v[68:71]
    buffer_load_dwordx4 a[192:195], v5, s[12:15], s56 offen offset:1024 nt
    buffer_load_dwordx4 a[200:203], v9, s[32:35], s58 offen offset:1024
    buffer_load_dwordx4 a[208:211], v5, s[12:15], s56 offen offset:2048 nt
    v_mfma_f32_16x16x32_bf16 v[72:75], a[32:35], v[48:51], 0
    v_mfma_f32_16x16x32_bf16 v[72:75], a[40:43], v[52:55], v[72:75]
    s_waitcnt vmcnt(19)
    v_mfma_f32_16x16x32_bf16 v[72:75], a[64:67], v[56:59], v[72:75]
    s_waitcnt vmcnt(17)
    v_mfma_f32_16x16x32_bf16 v[72:75], a[72:75], v[60:63], v[72:75]
    v_mov_b32_dpp v129, v76 quad_perm:[0,0,0,0] row_mask:0xf bank_mask:0xf
    v_add_f32_dpp v129, v77, v129 quad_perm:[1,1,1,1] row_mask:0xf bank_mask:0xf
    v_add_f32_dpp v129, v78, v129 quad_perm:[2,2,2,2] row_mask:0xf bank_mask:0xf
    v_add_f32_dpp v129, v79, v129 quad_perm:[3,3,3,3] row_mask:0xf bank_mask:0xf
    v_cvt_pk_bf16_f32 v129, 0, v129
    v_mul_f32 v129, 0x3db504f3, v129
    v_cvt_pk_bf16_f32 v129, 0, v129
    v_max_f32 v13, v13, v129
    buffer_load_dwordx4 a[232:235], v9, s[32:35], s58 offen offset:1280
    buffer_load_dwordx4 a[216:219], v5, s[12:15], s56 offen offset:3072 nt
    v_mov_b32_dpp v10, v34 row_newbcast:3 row_mask:0xf bank_mask:0x3
    v_mov_b32_dpp v10, v34 row_newbcast:11 row_mask:0xf bank_mask:0xc
    v_and_b32 v40, v10, v28
    v_and_b32 v41, v10, v29
    v_and_b32 v42, v10, v30
    v_and_b32 v43, v10, v31
    s_nop 1
    v_mfma_f32_16x16x32_bf16 v[64:67], v[40:43], a[56:59], v[64:67]
    s_waitcnt vmcnt(17)
    v_mfma_f32_16x16x32_bf16 v[68:71], v[40:43], a[96:99], v[68:71]
    buffer_load_dwordx4 a[224:227], v9, s[32:35], s58 offen offset:1536
    s_add_u32 s56, s51, 32768
    buffer_load_dwordx4 a[240:243], v5, s[12:15], s56 offen offset:0 nt
    buffer_load_dwordx4 v[156:159], v9, s[32:35], s58 offen offset:1792
    v_mfma_f32_16x16x32_bf16 v[76:79], a[80:83], v[48:51], 0
    s_waitcnt vmcnt(19)
    v_mfma_f32_16x16x32_bf16 v[76:79], a[88:91], v[52:55], v[76:79]
    s_waitcnt vmcnt(18)
    v_mfma_f32_16x16x32_bf16 v[76:79], a[104:107], v[56:59], v[76:79]
    s_waitcnt vmcnt(17)
    v_mfma_f32_16x16x32_bf16 v[76:79], a[128:131], v[60:63], v[76:79]
    v_mov_b32_dpp v130, v72 quad_perm:[0,0,0,0] row_mask:0xf bank_mask:0xf
    v_add_f32_dpp v130, v73, v130 quad_perm:[1,1,1,1] row_mask:0xf bank_mask:0xf
    v_add_f32_dpp v130, v74, v130 quad_perm:[2,2,2,2] row_mask:0xf bank_mask:0xf
    v_add_f32_dpp v130, v75, v130 quad_perm:[3,3,3,3] row_mask:0xf bank_mask:0xf
    v_cvt_pk_bf16_f32 v130, 0, v130
    v_mul_f32 v130, 0x3db504f3, v130
    v_cvt_pk_bf16_f32 v130, 0, v130
    v_max_f32 v13, v13, v130
    v_mov_b32_dpp v131, v76 quad_perm:[0,0,0,0] row_mask:0xf bank_mask:0xf
    v_add_f32_dpp v131, v77, v131 quad_perm:[1,1,1,1] row_mask:0xf bank_mask:0xf
    v_add_f32_dpp v131, v78, v131 quad_perm:[2,2,2,2] row_mask:0xf bank_mask:0xf
    v_add_f32_dpp v131, v79, v131 quad_perm:[3,3,3,3] row_mask:0xf bank_mask:0xf
    v_cvt_pk_bf16_f32 v131, 0, v131
    v_mul_f32 v131, 0x3db504f3, v131
    v_cvt_pk_bf16_f32 v131, 0, v131
    v_max_f32 v13, v13, v131
    s_nop 1
    v_max_f32_dpp v13, v13, v13 row_ror:4 row_mask:0xf bank_mask:0xf
    s_nop 1
    v_max_f32_dpp v13, v13, v13 row_ror:8 row_mask:0xf bank_mask:0xf
    s_lshl_b32 s3, s46, 4
    v_lshl_add_u32 v20, v2, 2, s3
    ds_write_b32 v20, v13 offset:8192
    s_mov_b32 exec_lo, 0x00ff00ff
    s_mov_b32 exec_hi, 0xff00ff00
    ds_write_b128 v19, v[64:67] offset:4096
    ds_write_b128 v19, v[68:71] offset:4352
    s_mov_b64 exec, -1
    v_and_b32 v10, 7, v3
    v_lshlrev_b32 v10, 9, v10
    v_lshl_add_u32 v10, v2, 4, v10
    v_lshrrev_b32 v11, 3, v3
    v_lshl_add_u32 v10, v11, 2, v10
    s_lshl_b32 s3, s46, 6
    s_add_u32 s3, s3, 4096
    v_add_u32 v10, s3, v10
    v_lshlrev_b32 v12, 2, v3
    buffer_load_dwordx4 a[248:251], v5, s[12:15], s56 offen offset:1024 nt
    s_waitcnt lgkmcnt(0)
    s_barrier
    ds_read_b32 v13, v12 offset:8192
    ds_read2_b32 v[140:141], v10 offset0:0 offset1:64
    ds_read2_b32 v[142:143], v10 offset0:2 offset1:66
    s_waitcnt lgkmcnt(0)
    v_max_f32_dpp v13, v13, v13 quad_perm:[1,0,3,2] row_mask:0xf bank_mask:0xf
    s_nop 1
    v_max_f32_dpp v13, v13, v13 quad_perm:[2,3,0,1] row_mask:0xf bank_mask:0xf
    s_nop 1
    v_max_f32_dpp v13, v13, v13 row_half_mirror row_mask:0xf bank_mask:0xf
    s_nop 1
    v_max_f32_dpp v13, v13, v13 row_mirror row_mask:0xf bank_mask:0xf
    v_mul_f32 v14, s60, v13
    v_add_f32_dpp v140, v140, v140 quad_perm:[1,0,3,2] row_mask:0xf bank_mask:0xf
    s_nop 1
    v_add_f32_dpp v140, v140, v140 quad_perm:[2,3,0,1] row_mask:0xf bank_mask:0xf
    s_nop 1
    v_add_f32_dpp v140, v140, v140 row_half_mirror row_mask:0xf bank_mask:0xf
    v_add_f32_dpp v141, v141, v141 quad_perm:[1,0,3,2] row_mask:0xf bank_mask:0xf
    s_nop 1
    v_add_f32_dpp v141, v141, v141 quad_perm:[2,3,0,1] row_mask:0xf bank_mask:0xf
    s_nop 1
    v_add_f32_dpp v141, v141, v141 row_half_mirror row_mask:0xf bank_mask:0xf
    v_cvt_pk_bf16_f32 v140, 0, v140
    v_cvt_pk_bf16_f32 v141, 0, v141
    v_mul_f32 v10, s60, v140
    v_exp_f32 v10, -v10
    s_nop 0
    v_add_f32 v10, 1.0, v10
    v_rcp_f32 v10, v10
    s_nop 0
    v_mul_f32 v140, v140, v10
    v_cvt_pk_bf16_f32 v140, 0, v140
    v_mul_f32 v140, v140, v141
    v_cvt_pk_bf16_f32 v140, v140, v140
    s_nop 1
    v_and_b32_dpp v48, v140, v28 row_newbcast:0 row_mask:0xf bank_mask:0xf
    v_and_b32_dpp v49, v140, v29 row_newbcast:0 row_mask:0xf bank_mask:0xf
    v_and_b32_dpp v50, v140, v30 row_newbcast:0 row_mask:0xf bank_mask:0xf
    v_and_b32_dpp v51, v140, v31 row_newbcast:0 row_mask:0xf bank_mask:0xf
    v_and_b32_dpp v52, v140, v28 row_newbcast:8 row_mask:0xf bank_mask:0xf
    v_and_b32_dpp v53, v140, v29 row_newbcast:8 row_mask:0xf bank_mask:0xf
    v_and_b32_dpp v54, v140, v30 row_newbcast:8 row_mask:0xf bank_mask:0xf
    v_and_b32_dpp v55, v140, v31 row_newbcast:8 row_mask:0xf bank_mask:0xf
    buffer_load_dwordx4 v[172:175], v9, s[32:35], s58 offen offset:2048
    v_add_f32_dpp v142, v142, v142 quad_perm:[1,0,3,2] row_mask:0xf bank_mask:0xf
    s_nop 1
    v_add_f32_dpp v142, v142, v142 quad_perm:[2,3,0,1] row_mask:0xf bank_mask:0xf
    s_nop 1
    v_add_f32_dpp v142, v142, v142 row_half_mirror row_mask:0xf bank_mask:0xf
    v_add_f32_dpp v143, v143, v143 quad_perm:[1,0,3,2] row_mask:0xf bank_mask:0xf
    s_nop 1
    v_add_f32_dpp v143, v143, v143 quad_perm:[2,3,0,1] row_mask:0xf bank_mask:0xf
    s_nop 1
    v_add_f32_dpp v143, v143, v143 row_half_mirror row_mask:0xf bank_mask:0xf
    v_cvt_pk_bf16_f32 v142, 0, v142
    v_cvt_pk_bf16_f32 v143, 0, v143
    v_mul_f32 v10, s60, v142
    v_exp_f32 v10, -v10
    s_nop 0
    v_add_f32 v10, 1.0, v10
    v_rcp_f32 v10, v10
    s_nop 0
    v_mul_f32 v142, v142, v10
    v_cvt_pk_bf16_f32 v142, 0, v142
    v_mul_f32 v142, v142, v143
    v_cvt_pk_bf16_f32 v142, v142, v142
    s_nop 1
    v_and_b32_dpp v56, v142, v28 row_newbcast:0 row_mask:0xf bank_mask:0xf
    v_and_b32_dpp v57, v142, v29 row_newbcast:0 row_mask:0xf bank_mask:0xf
    v_and_b32_dpp v58, v142, v30 row_newbcast:0 row_mask:0xf bank_mask:0xf
    v_and_b32_dpp v59, v142, v31 row_newbcast:0 row_mask:0xf bank_mask:0xf
    v_and_b32_dpp v60, v142, v28 row_newbcast:8 row_mask:0xf bank_mask:0xf
    v_and_b32_dpp v61, v142, v29 row_newbcast:8 row_mask:0xf bank_mask:0xf
    v_and_b32_dpp v62, v142, v30 row_newbcast:8 row_mask:0xf bank_mask:0xf
    v_and_b32_dpp v63, v142, v31 row_newbcast:8 row_mask:0xf bank_mask:0xf
    buffer_load_dwordx4 v[164:167], v5, s[12:15], s56 offen offset:2048 nt
    v_fma_f32 v104, v104, s60, -v14
    v_exp_f32 v104, v104
    s_nop 0
    v_add_f32 v15, v15, v104
    v_cvt_pk_bf16_f32 v104, v104, v104
    v_fma_f32 v105, v105, s60, -v14
    v_exp_f32 v105, v105
    s_nop 0
    v_add_f32 v15, v15, v105
    v_cvt_pk_bf16_f32 v105, v105, v105
    v_and_b32_dpp v44, v104, v28 row_newbcast:0 row_mask:0xf bank_mask:0xf
    v_and_b32_dpp v45, v104, v29 row_newbcast:0 row_mask:0xf bank_mask:0xf
    v_and_b32_dpp v46, v104, v30 row_newbcast:0 row_mask:0xf bank_mask:0xf
    v_and_b32_dpp v47, v104, v31 row_newbcast:0 row_mask:0xf bank_mask:0xf
    s_waitcnt vmcnt(19)
    s_nop 0
    v_mfma_f32_16x16x32_bf16 v[80:83], v[44:47], a[144:147], 0
    v_and_b32_dpp v40, v104, v28 row_newbcast:4 row_mask:0xf bank_mask:0xf
    v_and_b32_dpp v41, v104, v29 row_newbcast:4 row_mask:0xf bank_mask:0xf
    v_and_b32_dpp v42, v104, v30 row_newbcast:4 row_mask:0xf bank_mask:0xf
    v_and_b32_dpp v43, v104, v31 row_newbcast:4 row_mask:0xf bank_mask:0xf
    s_waitcnt vmcnt(18)
    s_nop 0
    v_mfma_f32_16x16x32_bf16 v[80:83], v[40:43], a[112:115], v[80:83]
    buffer_load_dwordx4 v[180:183], v9, s[32:35], s58 offen offset:2304
    v_and_b32_dpp v44, v104, v28 row_newbcast:8 row_mask:0xf bank_mask:0xf
    v_and_b32_dpp v45, v104, v29 row_newbcast:8 row_mask:0xf bank_mask:0xf
    v_and_b32_dpp v46, v104, v30 row_newbcast:8 row_mask:0xf bank_mask:0xf
    v_and_b32_dpp v47, v104, v31 row_newbcast:8 row_mask:0xf bank_mask:0xf
    s_waitcnt vmcnt(17)
    s_nop 0
    v_mfma_f32_16x16x32_bf16 v[80:83], v[44:47], a[136:139], v[80:83]
    buffer_load_dwordx4 v[196:199], v5, s[12:15], s56 offen offset:3072 nt
    s_add_u32 s58, s55, 2560
    buffer_load_dwordx4 v[204:207], v9, s[32:35], s58 offen offset:0
    v_and_b32_dpp v40, v104, v28 row_newbcast:12 row_mask:0xf bank_mask:0xf
    v_and_b32_dpp v41, v104, v29 row_newbcast:12 row_mask:0xf bank_mask:0xf
    v_and_b32_dpp v42, v104, v30 row_newbcast:12 row_mask:0xf bank_mask:0xf
    v_and_b32_dpp v43, v104, v31 row_newbcast:12 row_mask:0xf bank_mask:0xf
    s_waitcnt vmcnt(17)
    s_nop 0
    v_mfma_f32_16x16x32_bf16 v[80:83], v[40:43], a[168:171], v[80:83]
    s_add_u32 s56, s51, 49152
    buffer_load_dwordx4 v[188:191], v5, s[12:15], s56 offen offset:0 nt
    buffer_load_dwordx4 v[212:215], v9, s[32:35], s58 offen offset:256
    v_fma_f32 v106, v106, s60, -v14
    v_exp_f32 v106, v106
    s_nop 0
    v_add_f32 v15, v15, v106
    v_cvt_pk_bf16_f32 v106, v106, v106
    v_fma_f32 v107, v107, s60, -v14
    v_exp_f32 v107, v107
    s_nop 0
    v_add_f32 v15, v15, v107
    v_cvt_pk_bf16_f32 v107, v107, v107
    v_and_b32_dpp v44, v105, v28 row_newbcast:0 row_mask:0xf bank_mask:0xf
    v_and_b32_dpp v45, v105, v29 row_newbcast:0 row_mask:0xf bank_mask:0xf
    v_and_b32_dpp v46, v105, v30 row_newbcast:0 row_mask:0xf bank_mask:0xf
    v_and_b32_dpp v47, v105, v31 row_newbcast:0 row_mask:0xf bank_mask:0xf
    s_waitcnt vmcnt(17)
    s_nop 0
    v_mfma_f32_16x16x32_bf16 v[80:83], v[44:47], a[160:163], v[80:83]
    buffer_load_dwordx4 a[0:3], v5, s[12:15], s56 offen offset:1024 nt
    buffer_load_dwordx4 a[20:23], v9, s[32:35], s58 offen offset:512
    v_and_b32_dpp v40, v105, v28 row_newbcast:4 row_mask:0xf bank_mask:0xf
    v_and_b32_dpp v41, v105, v29 row_newbcast:4 row_mask:0xf bank_mask:0xf
    v_and_b32_dpp v42, v105, v30 row_newbcast:4 row_mask:0xf bank_mask:0xf
    v_and_b32_dpp v43, v105, v31 row_newbcast:4 row_mask:0xf bank_mask:0xf
    s_waitcnt vmcnt(17)
    s_nop 0
    v_mfma_f32_16x16x32_bf16 v[80:83], v[40:43], a[192:195], v[80:83]
    buffer_load_dwordx4 v[220:223], v5, s[12:15], s56 offen offset:2048 nt
    v_mfma_f32_16x16x32_bf16 v[84:87], v[48:51], a[120:123], 0
    v_mfma_f32_16x16x32_bf16 v[88:91], v[48:51], a[152:155], 0
    v_mfma_f32_16x16x32_bf16 v[92:95], v[48:51], a[184:187], 0
    v_mfma_f32_16x16x32_bf16 v[96:99], v[48:51], a[176:179], 0
    s_waitcnt vmcnt(17)
    v_mfma_f32_16x16x32_bf16 v[100:103], v[48:51], a[200:203], 0
    buffer_load_dwordx4 a[4:7], v9, s[32:35], s58 offen offset:768
    v_and_b32_dpp v44, v105, v28 row_newbcast:8 row_mask:0xf bank_mask:0xf
    v_and_b32_dpp v45, v105, v29 row_newbcast:8 row_mask:0xf bank_mask:0xf
    v_and_b32_dpp v46, v105, v30 row_newbcast:8 row_mask:0xf bank_mask:0xf
    v_and_b32_dpp v47, v105, v31 row_newbcast:8 row_mask:0xf bank_mask:0xf
    s_waitcnt vmcnt(17)
    s_nop 0
    v_mfma_f32_16x16x32_bf16 v[80:83], v[44:47], a[208:211], v[80:83]
    buffer_load_dwordx4 a[12:15], v5, s[12:15], s56 offen offset:3072 nt
    buffer_load_dwordx4 a[28:31], v9, s[32:35], s58 offen offset:1024
    v_and_b32_dpp v40, v105, v28 row_newbcast:12 row_mask:0xf bank_mask:0xf
    v_and_b32_dpp v41, v105, v29 row_newbcast:12 row_mask:0xf bank_mask:0xf
    v_and_b32_dpp v42, v105, v30 row_newbcast:12 row_mask:0xf bank_mask:0xf
    v_and_b32_dpp v43, v105, v31 row_newbcast:12 row_mask:0xf bank_mask:0xf
    s_waitcnt vmcnt(17)
    s_nop 0
    v_mfma_f32_16x16x32_bf16 v[80:83], v[40:43], a[216:219], v[80:83]
    s_add_u32 s56, s51, 65536
    buffer_load_dwordx4 a[36:39], v5, s[12:15], s56 offen offset:0 nt
    buffer_load_dwordx4 a[60:63], v9, s[32:35], s58 offen offset:1280
    v_fma_f32 v108, v108, s60, -v14
    v_exp_f32 v108, v108
    s_nop 0
    v_add_f32 v15, v15, v108
    v_cvt_pk_bf16_f32 v108, v108, v108
    v_fma_f32 v109, v109, s60, -v14
    v_exp_f32 v109, v109
    s_nop 0
    v_add_f32 v15, v15, v109
    v_cvt_pk_bf16_f32 v109, v109, v109
    v_and_b32_dpp v44, v106, v28 row_newbcast:0 row_mask:0xf bank_mask:0xf
    v_and_b32_dpp v45, v106, v29 row_newbcast:0 row_mask:0xf bank_mask:0xf
    v_and_b32_dpp v46, v106, v30 row_newbcast:0 row_mask:0xf bank_mask:0xf
    v_and_b32_dpp v47, v106, v31 row_newbcast:0 row_mask:0xf bank_mask:0xf
    s_waitcnt vmcnt(17)
    s_nop 0
    v_mfma_f32_16x16x32_bf16 v[80:83], v[44:47], a[240:243], v[80:83]
    buffer_load_dwordx4 a[44:47], v5, s[12:15], s56 offen offset:1024 nt
    buffer_load_dwordx4 a[52:55], v9, s[32:35], s58 offen offset:1536
    v_and_b32_dpp v40, v106, v28 row_newbcast:4 row_mask:0xf bank_mask:0xf
    v_and_b32_dpp v41, v106, v29 row_newbcast:4 row_mask:0xf bank_mask:0xf
    v_and_b32_dpp v42, v106, v30 row_newbcast:4 row_mask:0xf bank_mask:0xf
    v_and_b32_dpp v43, v106, v31 row_newbcast:4 row_mask:0xf bank_mask:0xf
    s_waitcnt vmcnt(17)
    s_nop 0
    v_mfma_f32_16x16x32_bf16 v[80:83], v[40:43], a[248:251], v[80:83]
    buffer_load_dwordx4 a[68:71], v5, s[12:15], s56 offen offset:2048 nt
    buffer_load_dwordx4 a[84:87], v9, s[32:35], s58 offen offset:1792
    v_and_b32_dpp v44, v106, v28 row_newbcast:8 row_mask:0xf bank_mask:0xf
    v_and_b32_dpp v45, v106, v29 row_newbcast:8 row_mask:0xf bank_mask:0xf
    v_and_b32_dpp v46, v106, v30 row_newbcast:8 row_mask:0xf bank_mask:0xf
    v_and_b32_dpp v47, v106, v31 row_newbcast:8 row_mask:0xf bank_mask:0xf
    s_waitcnt vmcnt(17)
    s_nop 0
    v_mfma_f32_16x16x32_bf16 v[80:83], v[44:47], v[164:167], v[80:83]
    buffer_load_dwordx4 a[76:79], v5, s[12:15], s56 offen offset:3072 nt
    v_mfma_f32_16x16x32_bf16 v[84:87], v[52:55], a[232:235], v[84:87]
    v_mfma_f32_16x16x32_bf16 v[88:91], v[52:55], a[224:227], v[88:91]
    v_mfma_f32_16x16x32_bf16 v[92:95], v[52:55], v[156:159], v[92:95]
    v_mfma_f32_16x16x32_bf16 v[96:99], v[52:55], v[172:175], v[96:99]
    s_waitcnt vmcnt(17)
    v_mfma_f32_16x16x32_bf16 v[100:103], v[52:55], v[180:183], v[100:103]
    buffer_load_dwordx4 a[100:103], v9, s[32:35], s58 offen offset:2048
    v_and_b32_dpp v40, v106, v28 row_newbcast:12 row_mask:0xf bank_mask:0xf
    v_and_b32_dpp v41, v106, v29 row_newbcast:12 row_mask:0xf bank_mask:0xf
    v_and_b32_dpp v42, v106, v30 row_newbcast:12 row_mask:0xf bank_mask:0xf
    v_and_b32_dpp v43, v106, v31 row_newbcast:12 row_mask:0xf bank_mask:0xf
    s_waitcnt vmcnt(17)
    s_nop 0
    v_mfma_f32_16x16x32_bf16 v[80:83], v[40:43], v[196:199], v[80:83]
    s_add_u32 s56, s51, 81920
    buffer_load_dwordx4 a[92:95], v5, s[12:15], s56 offen offset:0 nt
    buffer_load_dwordx4 a[108:111], v9, s[32:35], s58 offen offset:2304
    v_fma_f32 v110, v110, s60, -v14
    v_exp_f32 v110, v110
    s_nop 0
    v_add_f32 v15, v15, v110
    v_cvt_pk_bf16_f32 v110, v110, v110
    v_fma_f32 v111, v111, s60, -v14
    v_exp_f32 v111, v111
    s_nop 0
    v_add_f32 v15, v15, v111
    v_cvt_pk_bf16_f32 v111, v111, v111
    v_and_b32_dpp v44, v107, v28 row_newbcast:0 row_mask:0xf bank_mask:0xf
    v_and_b32_dpp v45, v107, v29 row_newbcast:0 row_mask:0xf bank_mask:0xf
    v_and_b32_dpp v46, v107, v30 row_newbcast:0 row_mask:0xf bank_mask:0xf
    v_and_b32_dpp v47, v107, v31 row_newbcast:0 row_mask:0xf bank_mask:0xf
    s_waitcnt vmcnt(17)
    s_nop 0
    v_mfma_f32_16x16x32_bf16 v[80:83], v[44:47], v[188:191], v[80:83]
    buffer_load_dwordx4 a[116:119], v5, s[12:15], s56 offen offset:1024 nt
    s_add_u32 s59, s54, 0
    buffer_load_dwordx4 a[132:135], v8, s[20:23], s59 offen offset:0
    v_and_b32_dpp v40, v107, v28 row_newbcast:4 row_mask:0xf bank_mask:0xf
    v_and_b32_dpp v41, v107, v29 row_newbcast:4 row_mask:0xf bank_mask:0xf
    v_and_b32_dpp v42, v107, v30 row_newbcast:4 row_mask:0xf bank_mask:0xf
    v_and_b32_dpp v43, v107, v31 row_newbcast:4 row_mask:0xf bank_mask:0xf
    s_waitcnt vmcnt(17)
    s_nop 0
    v_mfma_f32_16x16x32_bf16 v[80:83], v[40:43], a[0:3], v[80:83]
    buffer_load_dwordx4 a[124:127], v5, s[12:15], s56 offen offset:2048 nt
    buffer_load_dwordx4 a[140:143], v5, s[12:15], s56 offen offset:3072 nt
    v_and_b32_dpp v44, v107, v28 row_newbcast:8 row_mask:0xf bank_mask:0xf
    v_and_b32_dpp v45, v107, v29 row_newbcast:8 row_mask:0xf bank_mask:0xf
    v_and_b32_dpp v46, v107, v30 row_newbcast:8 row_mask:0xf bank_mask:0xf
    v_and_b32_dpp v47, v107, v31 row_newbcast:8 row_mask:0xf bank_mask:0xf
    s_waitcnt vmcnt(17)
    s_nop 0
    v_mfma_f32_16x16x32_bf16 v[80:83], v[44:47], v[220:223], v[80:83]
    buffer_load_dwordx4 a[164:167], v8, s[20:23], s59 offen offset:256
    s_add_u32 s56, s51, 98304
    buffer_load_dwordx4 a[180:183], v5, s[12:15], s56 offen offset:0 nt
    v_and_b32_dpp v40, v107, v28 row_newbcast:12 row_mask:0xf bank_mask:0xf
    v_and_b32_dpp v41, v107, v29 row_newbcast:12 row_mask:0xf bank_mask:0xf
    v_and_b32_dpp v42, v107, v30 row_newbcast:12 row_mask:0xf bank_mask:0xf
    v_and_b32_dpp v43, v107, v31 row_newbcast:12 row_mask:0xf bank_mask:0xf
    s_waitcnt vmcnt(17)
    s_nop 0
    v_mfma_f32_16x16x32_bf16 v[80:83], v[40:43], a[12:15], v[80:83]
    buffer_load_dwordx4 a[148:151], v5, s[12:15], s56 offen offset:1024 nt
    v_mfma_f32_16x16x32_bf16 v[84:87], v[56:59], v[204:207], v[84:87]
    v_mfma_f32_16x16x32_bf16 v[88:91], v[56:59], v[212:215], v[88:91]
    v_mfma_f32_16x16x32_bf16 v[92:95], v[56:59], a[20:23], v[92:95]
    v_mfma_f32_16x16x32_bf16 v[96:99], v[56:59], a[4:7], v[96:99]
    s_waitcnt vmcnt(17)
    v_mfma_f32_16x16x32_bf16 v[100:103], v[56:59], a[28:31], v[100:103]
    buffer_load_dwordx4 a[156:159], v8, s[20:23], s59 offen offset:512
    v_fma_f32 v112, v112, s60, -v14
    v_exp_f32 v112, v112
    s_nop 0
    v_add_f32 v15, v15, v112
    v_cvt_pk_bf16_f32 v112, v112, v112
    v_fma_f32 v113, v113, s60, -v14
    v_exp_f32 v113, v113
    s_nop 0
    v_add_f32 v15, v15, v113
    v_cvt_pk_bf16_f32 v113, v113, v113
    v_and_b32_dpp v44, v108, v28 row_newbcast:0 row_mask:0xf bank_mask:0xf
    v_and_b32_dpp v45, v108, v29 row_newbcast:0 row_mask:0xf bank_mask:0xf
    v_and_b32_dpp v46, v108, v30 row_newbcast:0 row_mask:0xf bank_mask:0xf
    v_and_b32_dpp v47, v108, v31 row_newbcast:0 row_mask:0xf bank_mask:0xf
    s_waitcnt vmcnt(17)
    s_nop 0
    v_mfma_f32_16x16x32_bf16 v[80:83], v[44:47], a[36:39], v[80:83]
    buffer_load_dwordx4 a[172:175], v5, s[12:15], s56 offen offset:2048 nt
    buffer_load_dwordx4 a[188:191], v5, s[12:15], s56 offen offset:3072 nt
    v_and_b32_dpp v40, v108, v28 row_newbcast:4 row_mask:0xf bank_mask:0xf
    v_and_b32_dpp v41, v108, v29 row_newbcast:4 row_mask:0xf bank_mask:0xf
    v_and_b32_dpp v42, v108, v30 row_newbcast:4 row_mask:0xf bank_mask:0xf
    v_and_b32_dpp v43, v108, v31 row_newbcast:4 row_mask:0xf bank_mask:0xf
    s_waitcnt vmcnt(17)
    s_nop 0
    v_mfma_f32_16x16x32_bf16 v[80:83], v[40:43], a[44:47], v[80:83]
    buffer_load_dwordx4 a[204:207], v8, s[20:23], s59 offen offset:768
    s_add_u32 s56, s51, 114688
    buffer_load_dwordx4 a[220:223], v5, s[12:15], s56 offen offset:0 nt
    v_and_b32_dpp v44, v108, v28 row_newbcast:8 row_mask:0xf bank_mask:0xf
    v_and_b32_dpp v45, v108, v29 row_newbcast:8 row_mask:0xf bank_mask:0xf
    v_and_b32_dpp v46, v108, v30 row_newbcast:8 row_mask:0xf bank_mask:0xf
    v_and_b32_dpp v47, v108, v31 row_newbcast:8 row_mask:0xf bank_mask:0xf
    s_waitcnt vmcnt(17)
    s_nop 0
    v_mfma_f32_16x16x32_bf16 v[80:83], v[44:47], a[68:71], v[80:83]
    buffer_load_dwordx4 a[196:199], v8, s[20:23], s59 offen offset:1024
    buffer_load_dwordx4 a[212:215], v5, s[12:15], s56 offen offset:1024 nt
    v_and_b32_dpp v40, v108, v28 row_newbcast:12 row_mask:0xf bank_mask:0xf
    v_and_b32_dpp v41, v108, v29 row_newbcast:12 row_mask:0xf bank_mask:0xf
    v_and_b32_dpp v42, v108, v30 row_newbcast:12 row_mask:0xf bank_mask:0xf
    v_and_b32_dpp v43, v108, v31 row_newbcast:12 row_mask:0xf bank_mask:0xf
    s_waitcnt vmcnt(17)
    s_nop 0
    v_mfma_f32_16x16x32_bf16 v[80:83], v[40:43], a[76:79], v[80:83]
    buffer_load_dwordx4 a[228:231], v5, s[12:15], s56 offen offset:2048 nt
    buffer_load_dwordx4 a[236:239], v8, s[20:23], s59 offen offset:1280
    v_fma_f32 v114, v114, s60, -v14
    v_exp_f32 v114, v114
    s_nop 0
    v_add_f32 v15, v15, v114
    v_cvt_pk_bf16_f32 v114, v114, v114
    v_fma_f32 v115, v115, s60, -v14
    v_exp_f32 v115, v115
    s_nop 0
    v_add_f32 v15, v15, v115
    v_cvt_pk_bf16_f32 v115, v115, v115
    v_and_b32_dpp v44, v109, v28 row_newbcast:0 row_mask:0xf bank_mask:0xf
    v_and_b32_dpp v45, v109, v29 row_newbcast:0 row_mask:0xf bank_mask:0xf
    v_and_b32_dpp v46, v109, v30 row_newbcast:0 row_mask:0xf bank_mask:0xf
    v_and_b32_dpp v47, v109, v31 row_newbcast:0 row_mask:0xf bank_mask:0xf
    s_waitcnt vmcnt(17)
    s_nop 0
    v_mfma_f32_16x16x32_bf16 v[80:83], v[44:47], a[92:95], v[80:83]
    buffer_load_dwordx4 a[244:247], v5, s[12:15], s56 offen offset:3072 nt
    v_mfma_f32_16x16x32_bf16 v[84:87], v[60:63], a[60:63], v[84:87]
    v_mfma_f32_16x16x32_bf16 v[88:91], v[60:63], a[52:55], v[88:91]
    v_mfma_f32_16x16x32_bf16 v[92:95], v[60:63], a[84:87], v[92:95]
    v_mfma_f32_16x16x32_bf16 v[96:99], v[60:63], a[100:103], v[96:99]
    s_waitcnt vmcnt(17)
    v_mfma_f32_16x16x32_bf16 v[100:103], v[60:63], a[108:111], v[100:103]
    s_add_u32 s56, s51, 131072
    buffer_load_dwordx4 v[160:163], v5, s[12:15], s56 offen offset:0 nt
    v_and_b32_dpp v40, v109, v28 row_newbcast:4 row_mask:0xf bank_mask:0xf
    v_and_b32_dpp v41, v109, v29 row_newbcast:4 row_mask:0xf bank_mask:0xf
    v_and_b32_dpp v42, v109, v30 row_newbcast:4 row_mask:0xf bank_mask:0xf
    v_and_b32_dpp v43, v109, v31 row_newbcast:4 row_mask:0xf bank_mask:0xf
    s_waitcnt vmcnt(17)
    s_nop 0
    v_mfma_f32_16x16x32_bf16 v[80:83], v[40:43], a[116:119], v[80:83]
    buffer_load_dwordx4 a[252:255], v8, s[20:23], s59 offen offset:1536
    buffer_load_dwordx4 v[168:171], v5, s[12:15], s56 offen offset:1024 nt
    v_and_b32_dpp v44, v109, v28 row_newbcast:8 row_mask:0xf bank_mask:0xf
    v_and_b32_dpp v45, v109, v29 row_newbcast:8 row_mask:0xf bank_mask:0xf
    v_and_b32_dpp v46, v109, v30 row_newbcast:8 row_mask:0xf bank_mask:0xf
    v_and_b32_dpp v47, v109, v31 row_newbcast:8 row_mask:0xf bank_mask:0xf
    s_waitcnt vmcnt(17)
    s_nop 0
    v_mfma_f32_16x16x32_bf16 v[80:83], v[44:47], a[124:127], v[80:83]
    buffer_load_dwordx4 v[176:179], v8, s[20:23], s59 offen offset:1792
    v_and_b32_dpp v40, v109, v28 row_newbcast:12 row_mask:0xf bank_mask:0xf
    v_and_b32_dpp v41, v109, v29 row_newbcast:12 row_mask:0xf bank_mask:0xf
    v_and_b32_dpp v42, v109, v30 row_newbcast:12 row_mask:0xf bank_mask:0xf
    v_and_b32_dpp v43, v109, v31 row_newbcast:12 row_mask:0xf bank_mask:0xf
    s_waitcnt vmcnt(17)
    s_nop 0
    v_mfma_f32_16x16x32_bf16 v[80:83], v[40:43], a[140:143], v[80:83]
    buffer_load_dwordx4 v[192:195], v5, s[12:15], s56 offen offset:2048 nt
    buffer_load_dwordx4 v[184:187], v5, s[12:15], s56 offen offset:3072 nt
    v_fma_f32 v116, v116, s60, -v14
    v_exp_f32 v116, v116
    s_nop 0
    v_add_f32 v15, v15, v116
    v_cvt_pk_bf16_f32 v116, v116, v116
    v_fma_f32 v117, v117, s60, -v14
    v_exp_f32 v117, v117
    s_nop 0
    v_add_f32 v15, v15, v117
    v_cvt_pk_bf16_f32 v117, v117, v117
    v_and_b32_dpp v44, v110, v28 row_newbcast:0 row_mask:0xf bank_mask:0xf
    v_and_b32_dpp v45, v110, v29 row_newbcast:0 row_mask:0xf bank_mask:0xf
    v_and_b32_dpp v46, v110, v30 row_newbcast:0 row_mask:0xf bank_mask:0xf
    v_and_b32_dpp v47, v110, v31 row_newbcast:0 row_mask:0xf bank_mask:0xf
    s_waitcnt vmcnt(17)
    s_nop 0
    v_mfma_f32_16x16x32_bf16 v[80:83], v[44:47], a[180:183], v[80:83]
    buffer_load_dwordx4 v[208:211], v8, s[20:23], s59 offen offset:2048
    v_and_b32_dpp v40, v110, v28 row_newbcast:4 row_mask:0xf bank_mask:0xf
    v_and_b32_dpp v41, v110, v29 row_newbcast:4 row_mask:0xf bank_mask:0xf
    v_and_b32_dpp v42, v110, v30 row_newbcast:4 row_mask:0xf bank_mask:0xf
    v_and_b32_dpp v43, v110, v31 row_newbcast:4 row_mask:0xf bank_mask:0xf
    s_waitcnt vmcnt(17)
    s_nop 0
    v_mfma_f32_16x16x32_bf16 v[80:83], v[40:43], a[148:151], v[80:83]
    s_add_u32 s56, s51, 147456
    buffer_load_dwordx4 v[200:203], v5, s[12:15], s56 offen offset:0 nt
    buffer_load_dwordx4 v[216:219], v5, s[12:15], s56 offen offset:1024 nt
    v_and_b32_dpp v44, v110, v28 row_newbcast:8 row_mask:0xf bank_mask:0xf
    v_and_b32_dpp v45, v110, v29 row_newbcast:8 row_mask:0xf bank_mask:0xf
    v_and_b32_dpp v46, v110, v30 row_newbcast:8 row_mask:0xf bank_mask:0xf
    v_and_b32_dpp v47, v110, v31 row_newbcast:8 row_mask:0xf bank_mask:0xf
    s_waitcnt vmcnt(17)
    s_nop 0
    v_mfma_f32_16x16x32_bf16 v[80:83], v[44:47], a[172:175], v[80:83]
    buffer_load_dwordx4 v[228:231], v8, s[20:23], s59 offen offset:2304
    v_and_b32_dpp v40, v110, v28 row_newbcast:12 row_mask:0xf bank_mask:0xf
    v_and_b32_dpp v41, v110, v29 row_newbcast:12 row_mask:0xf bank_mask:0xf
    v_and_b32_dpp v42, v110, v30 row_newbcast:12 row_mask:0xf bank_mask:0xf
    v_and_b32_dpp v43, v110, v31 row_newbcast:12 row_mask:0xf bank_mask:0xf
    s_waitcnt vmcnt(17)
    s_nop 0
    v_mfma_f32_16x16x32_bf16 v[80:83], v[40:43], a[188:191], v[80:83]
    buffer_load_dwordx4 v[232:235], v5, s[12:15], s56 offen offset:2048 nt
    s_add_u32 s59, s54, 2560
    buffer_load_dwordx4 v[224:227], v8, s[20:23], s59 offen offset:0
    v_fma_f32 v118, v118, s60, -v14
    v_exp_f32 v118, v118
    s_nop 0
    v_add_f32 v15, v15, v118
    v_cvt_pk_bf16_f32 v118, v118, v118
    v_fma_f32 v119, v119, s60, -v14
    v_exp_f32 v119, v119
    s_nop 0
    v_add_f32 v15, v15, v119
    v_cvt_pk_bf16_f32 v119, v119, v119
    v_and_b32_dpp v44, v111, v28 row_newbcast:0 row_mask:0xf bank_mask:0xf
    v_and_b32_dpp v45, v111, v29 row_newbcast:0 row_mask:0xf bank_mask:0xf
    v_and_b32_dpp v46, v111, v30 row_newbcast:0 row_mask:0xf bank_mask:0xf
    v_and_b32_dpp v47, v111, v31 row_newbcast:0 row_mask:0xf bank_mask:0xf
    s_waitcnt vmcnt(17)
    s_nop 0
    v_mfma_f32_16x16x32_bf16 v[80:83], v[44:47], a[220:223], v[80:83]
    buffer_load_dwordx4 v[236:239], v5, s[12:15], s56 offen offset:3072 nt
    s_add_u32 s56, s51, 163840
    buffer_load_dwordx4 v[244:247], v5, s[12:15], s56 offen offset:0 nt
    v_and_b32_dpp v40, v111, v28 row_newbcast:4 row_mask:0xf bank_mask:0xf
    v_and_b32_dpp v41, v111, v29 row_newbcast:4 row_mask:0xf bank_mask:0xf
    v_and_b32_dpp v42, v111, v30 row_newbcast:4 row_mask:0xf bank_mask:0xf
    v_and_b32_dpp v43, v111, v31 row_newbcast:4 row_mask:0xf bank_mask:0xf
    s_waitcnt vmcnt(17)
    s_nop 0
    v_mfma_f32_16x16x32_bf16 v[80:83], v[40:43], a[212:215], v[80:83]
    buffer_load_dwordx4 a[24:27], v8, s[20:23], s59 offen offset:256
    v_and_b32_dpp v44, v111, v28 row_newbcast:8 row_mask:0xf bank_mask:0xf
    v_and_b32_dpp v45, v111, v29 row_newbcast:8 row_mask:0xf bank_mask:0xf
    v_and_b32_dpp v46, v111, v30 row_newbcast:8 row_mask:0xf bank_mask:0xf
    v_and_b32_dpp v47, v111, v31 row_newbcast:8 row_mask:0xf bank_mask:0xf
    s_waitcnt vmcnt(17)
    s_nop 0
    v_mfma_f32_16x16x32_bf16 v[80:83], v[44:47], a[228:231], v[80:83]
    buffer_load_dwordx4 v[240:243], v5, s[12:15], s56 offen offset:1024 nt
    buffer_load_dwordx4 v[248:251], v5, s[12:15], s56 offen offset:2048 nt
    v_and_b32_dpp v40, v111, v28 row_newbcast:12 row_mask:0xf bank_mask:0xf
    v_and_b32_dpp v41, v111, v29 row_newbcast:12 row_mask:0xf bank_mask:0xf
    v_and_b32_dpp v42, v111, v30 row_newbcast:12 row_mask:0xf bank_mask:0xf
    v_and_b32_dpp v43, v111, v31 row_newbcast:12 row_mask:0xf bank_mask:0xf
    s_waitcnt vmcnt(17)
    s_nop 0
    v_mfma_f32_16x16x32_bf16 v[80:83], v[40:43], a[244:247], v[80:83]
    buffer_load_dwordx4 v[252:255], v8, s[20:23], s59 offen offset:512
    v_fma_f32 v120, v120, s60, -v14
    v_exp_f32 v120, v120
    s_nop 0
    v_add_f32 v15, v15, v120
    v_cvt_pk_bf16_f32 v120, v120, v120
    v_fma_f32 v121, v121, s60, -v14
    v_exp_f32 v121, v121
    s_nop 0
    v_add_f32 v15, v15, v121
    v_cvt_pk_bf16_f32 v121, v121, v121
    v_and_b32_dpp v44, v112, v28 row_newbcast:0 row_mask:0xf bank_mask:0xf
    v_and_b32_dpp v45, v112, v29 row_newbcast:0 row_mask:0xf bank_mask:0xf
    v_and_b32_dpp v46, v112, v30 row_newbcast:0 row_mask:0xf bank_mask:0xf
    v_and_b32_dpp v47, v112, v31 row_newbcast:0 row_mask:0xf bank_mask:0xf
    s_waitcnt vmcnt(17)
    s_nop 0
    v_mfma_f32_16x16x32_bf16 v[80:83], v[44:47], v[160:163], v[80:83]
    buffer_load_dwordx4 a[8:11], v5, s[12:15], s56 offen offset:3072 nt
    s_add_u32 s56, s51, 180224
    buffer_load_dwordx4 a[16:19], v5, s[12:15], s56 offen offset:0 nt
    v_and_b32_dpp v40, v112, v28 row_newbcast:4 row_mask:0xf bank_mask:0xf
    v_and_b32_dpp v41, v112, v29 row_newbcast:4 row_mask:0xf bank_mask:0xf
    v_and_b32_dpp v42, v112, v30 row_newbcast:4 row_mask:0xf bank_mask:0xf
    v_and_b32_dpp v43, v112, v31 row_newbcast:4 row_mask:0xf bank_mask:0xf
    s_waitcnt vmcnt(17)
    s_nop 0
    v_mfma_f32_16x16x32_bf16 v[80:83], v[40:43], v[168:171], v[80:83]
    buffer_load_dwordx4 a[48:51], v8, s[20:23], s59 offen offset:768
    buffer_load_dwordx4 a[32:35], v5, s[12:15], s56 offen offset:1024 nt
    v_and_b32_dpp v44, v112, v28 row_newbcast:8 row_mask:0xf bank_mask:0xf
    v_and_b32_dpp v45, v112, v29 row_newbcast:8 row_mask:0xf bank_mask:0xf
    v_and_b32_dpp v46, v112, v30 row_newbcast:8 row_mask:0xf bank_mask:0xf
    v_and_b32_dpp v47, v112, v31 row_newbcast:8 row_mask:0xf bank_mask:0xf
    s_waitcnt vmcnt(17)
    s_nop 0
    v_mfma_f32_16x16x32_bf16 v[80:83], v[44:47], v[192:195], v[80:83]
    buffer_load_dwordx4 a[40:43], v8, s[20:23], s59 offen offset:1024
    v_and_b32_dpp v40, v112, v28 row_newbcast:12 row_mask:0xf bank_mask:0xf
    v_and_b32_dpp v41, v112, v29 row_newbcast:12 row_mask:0xf bank_mask:0xf
    v_and_b32_dpp v42, v112, v30 row_newbcast:12 row_mask:0xf bank_mask:0xf
    v_and_b32_dpp v43, v112, v31 row_newbcast:12 row_mask:0xf bank_mask:0xf
    s_waitcnt vmcnt(17)
    s_nop 0
    v_mfma_f32_16x16x32_bf16 v[80:83], v[40:43], v[184:187], v[80:83]
    buffer_load_dwordx4 a[64:67], v5, s[12:15], s56 offen offset:2048 nt
    buffer_load_dwordx4 a[72:75], v5, s[12:15], s56 offen offset:3072 nt
    v_fma_f32 v122, v122, s60, -v14
    v_exp_f32 v122, v122
    s_nop 0
    v_add_f32 v15, v15, v122
    v_cvt_pk_bf16_f32 v122, v122, v122
    v_fma_f32 v123, v123, s60, -v14
    v_exp_f32 v123, v123
    s_nop 0
    v_add_f32 v15, v15, v123
    v_cvt_pk_bf16_f32 v123, v123, v123
    v_and_b32_dpp v44, v113, v28 row_newbcast:0 row_mask:0xf bank_mask:0xf
    v_and_b32_dpp v45, v113, v29 row_newbcast:0 row_mask:0xf bank_mask:0xf
    v_and_b32_dpp v46, v113, v30 row_newbcast:0 row_mask:0xf bank_mask:0xf
    v_and_b32_dpp v47, v113, v31 row_newbcast:0 row_mask:0xf bank_mask:0xf
    s_waitcnt vmcnt(17)
    s_nop 0
    v_mfma_f32_16x16x32_bf16 v[80:83], v[44:47], v[200:203], v[80:83]
    buffer_load_dwordx4 a[56:59], v8, s[20:23], s59 offen offset:1280
    v_and_b32_dpp v40, v113, v28 row_newbcast:4 row_mask:0xf bank_mask:0xf
    v_and_b32_dpp v41, v113, v29 row_newbcast:4 row_mask:0xf bank_mask:0xf
    v_and_b32_dpp v42, v113, v30 row_newbcast:4 row_mask:0xf bank_mask:0xf
    v_and_b32_dpp v43, v113, v31 row_newbcast:4 row_mask:0xf bank_mask:0xf
    s_waitcnt vmcnt(17)
    s_nop 0
    v_mfma_f32_16x16x32_bf16 v[80:83], v[40:43], v[216:219], v[80:83]
    s_add_u32 s56, s51, 196608
    buffer_load_dwordx4 a[96:99], v5, s[12:15], s56 offen offset:0 nt
    buffer_load_dwordx4 a[80:83], v5, s[12:15], s56 offen offset:1024 nt
    v_and_b32_dpp v44, v113, v28 row_newbcast:8 row_mask:0xf bank_mask:0xf
    v_and_b32_dpp v45, v113, v29 row_newbcast:8 row_mask:0xf bank_mask:0xf
    v_and_b32_dpp v46, v113, v30 row_newbcast:8 row_mask:0xf bank_mask:0xf
    v_and_b32_dpp v47, v113, v31 row_newbcast:8 row_mask:0xf bank_mask:0xf
    s_waitcnt vmcnt(17)
    s_nop 0
    v_mfma_f32_16x16x32_bf16 v[80:83], v[44:47], v[232:235], v[80:83]
    buffer_load_dwordx4 a[88:91], v8, s[20:23], s59 offen offset:1536
    buffer_load_dwordx4 a[104:107], v5, s[12:15], s56 offen offset:2048 nt
    v_and_b32_dpp v40, v113, v28 row_newbcast:12 row_mask:0xf bank_mask:0xf
    v_and_b32_dpp v41, v113, v29 row_newbcast:12 row_mask:0xf bank_mask:0xf
    v_and_b32_dpp v42, v113, v30 row_newbcast:12 row_mask:0xf bank_mask:0xf
    v_and_b32_dpp v43, v113, v31 row_newbcast:12 row_mask:0xf bank_mask:0xf
    s_waitcnt vmcnt(17)
    s_nop 0
    v_mfma_f32_16x16x32_bf16 v[80:83], v[40:43], v[236:239], v[80:83]
    buffer_load_dwordx4 a[128:131], v8, s[20:23], s59 offen offset:1792
    v_fma_f32 v124, v124, s60, -v14
    v_exp_f32 v124, v124
    s_nop 0
    v_add_f32 v15, v15, v124
    v_cvt_pk_bf16_f32 v124, v124, v124
    v_fma_f32 v125, v125, s60, -v14
    v_exp_f32 v125, v125
    s_nop 0
    v_add_f32 v15, v15, v125
    v_cvt_pk_bf16_f32 v125, v125, v125
    v_and_b32_dpp v44, v114, v28 row_newbcast:0 row_mask:0xf bank_mask:0xf
    v_and_b32_dpp v45, v114, v29 row_newbcast:0 row_mask:0xf bank_mask:0xf
    v_and_b32_dpp v46, v114, v30 row_newbcast:0 row_mask:0xf bank_mask:0xf
    v_and_b32_dpp v47, v114, v31 row_newbcast:0 row_mask:0xf bank_mask:0xf
    s_waitcnt vmcnt(17)
    s_nop 0
    v_mfma_f32_16x16x32_bf16 v[80:83], v[44:47], v[244:247], v[80:83]
    buffer_load_dwordx4 a[144:147], v5, s[12:15], s56 offen offset:3072 nt
    s_add_u32 s56, s51, 212992
    buffer_load_dwordx4 a[112:115], v5, s[12:15], s56 offen offset:0 nt
    v_and_b32_dpp v40, v114, v28 row_newbcast:4 row_mask:0xf bank_mask:0xf
    v_and_b32_dpp v41, v114, v29 row_newbcast:4 row_mask:0xf bank_mask:0xf
    v_and_b32_dpp v42, v114, v30 row_newbcast:4 row_mask:0xf bank_mask:0xf
    v_and_b32_dpp v43, v114, v31 row_newbcast:4 row_mask:0xf bank_mask:0xf
    s_waitcnt vmcnt(17)
    s_nop 0
    v_mfma_f32_16x16x32_bf16 v[80:83], v[40:43], v[240:243], v[80:83]
    buffer_load_dwordx4 a[136:139], v8, s[20:23], s59 offen offset:2048
    v_and_b32_dpp v44, v114, v28 row_newbcast:8 row_mask:0xf bank_mask:0xf
    v_and_b32_dpp v45, v114, v29 row_newbcast:8 row_mask:0xf bank_mask:0xf
    v_and_b32_dpp v46, v114, v30 row_newbcast:8 row_mask:0xf bank_mask:0xf
    v_and_b32_dpp v47, v114, v31 row_newbcast:8 row_mask:0xf bank_mask:0xf
    s_waitcnt vmcnt(17)
    s_nop 0
    v_mfma_f32_16x16x32_bf16 v[80:83], v[44:47], v[248:251], v[80:83]
    buffer_load_dwordx4 a[168:171], v5, s[12:15], s56 offen offset:1024 nt
    buffer_load_dwordx4 a[160:163], v5, s[12:15], s56 offen offset:2048 nt
    v_and_b32_dpp v40, v114, v28 row_newbcast:12 row_mask:0xf bank_mask:0xf
    v_and_b32_dpp v41, v114, v29 row_newbcast:12 row_mask:0xf bank_mask:0xf
    v_and_b32_dpp v42, v114, v30 row_newbcast:12 row_mask:0xf bank_mask:0xf
    v_and_b32_dpp v43, v114, v31 row_newbcast:12 row_mask:0xf bank_mask:0xf
    s_waitcnt vmcnt(17)
    s_nop 0
    v_mfma_f32_16x16x32_bf16 v[80:83], v[40:43], a[8:11], v[80:83]
    buffer_load_dwordx4 a[192:195], v8, s[20:23], s59 offen offset:2304
    v_fma_f32 v126, v126, s60, -v14
    v_exp_f32 v126, v126
    s_nop 0
    v_add_f32 v15, v15, v126
    v_cvt_pk_bf16_f32 v126, v126, v126
    v_fma_f32 v127, v127, s60, -v14
    v_exp_f32 v127, v127
    s_nop 0
    v_add_f32 v15, v15, v127
    v_cvt_pk_bf16_f32 v127, v127, v127
    v_and_b32_dpp v44, v115, v28 row_newbcast:0 row_mask:0xf bank_mask:0xf
    v_and_b32_dpp v45, v115, v29 row_newbcast:0 row_mask:0xf bank_mask:0xf
    v_and_b32_dpp v46, v115, v30 row_newbcast:0 row_mask:0xf bank_mask:0xf
    v_and_b32_dpp v47, v115, v31 row_newbcast:0 row_mask:0xf bank_mask:0xf
    s_waitcnt vmcnt(17)
    s_nop 0
    v_mfma_f32_16x16x32_bf16 v[80:83], v[44:47], a[16:19], v[80:83]
    buffer_load_dwordx4 a[120:123], v5, s[12:15], s56 offen offset:3072 nt
    s_add_u32 s59, s54, 5120
    buffer_load_dwordx4 a[152:155], v8, s[20:23], s59 offen offset:0
    v_and_b32_dpp v40, v115, v28 row_newbcast:4 row_mask:0xf bank_mask:0xf
    v_and_b32_dpp v41, v115, v29 row_newbcast:4 row_mask:0xf bank_mask:0xf
    v_and_b32_dpp v42, v115, v30 row_newbcast:4 row_mask:0xf bank_mask:0xf
    v_and_b32_dpp v43, v115, v31 row_newbcast:4 row_mask:0xf bank_mask:0xf
    s_waitcnt vmcnt(17)
    s_nop 0
    v_mfma_f32_16x16x32_bf16 v[80:83], v[40:43], a[32:35], v[80:83]
    s_add_u32 s56, s51, 229376
    buffer_load_dwordx4 a[184:187], v5, s[12:15], s56 offen offset:0 nt
    buffer_load_dwordx4 a[176:179], v5, s[12:15], s56 offen offset:1024 nt
    v_and_b32_dpp v44, v115, v28 row_newbcast:8 row_mask:0xf bank_mask:0xf
    v_and_b32_dpp v45, v115, v29 row_newbcast:8 row_mask:0xf bank_mask:0xf
    v_and_b32_dpp v46, v115, v30 row_newbcast:8 row_mask:0xf bank_mask:0xf
    v_and_b32_dpp v47, v115, v31 row_newbcast:8 row_mask:0xf bank_mask:0xf
    s_waitcnt vmcnt(17)
    s_nop 0
    v_mfma_f32_16x16x32_bf16 v[80:83], v[44:47], a[64:67], v[80:83]
    buffer_load_dwordx4 a[200:203], v8, s[20:23], s59 offen offset:256
    v_and_b32_dpp v40, v115, v28 row_newbcast:12 row_mask:0xf bank_mask:0xf
    v_and_b32_dpp v41, v115, v29 row_newbcast:12 row_mask:0xf bank_mask:0xf
    v_and_b32_dpp v42, v115, v30 row_newbcast:12 row_mask:0xf bank_mask:0xf
    v_and_b32_dpp v43, v115, v31 row_newbcast:12 row_mask:0xf bank_mask:0xf
    s_waitcnt vmcnt(17)
    s_nop 0
    v_mfma_f32_16x16x32_bf16 v[80:83], v[40:43], a[72:75], v[80:83]
    buffer_load_dwordx4 a[208:211], v5, s[12:15], s56 offen offset:2048 nt
    buffer_load_dwordx4 a[216:219], v5, s[12:15], s56 offen offset:3072 nt
    v_fma_f32 v128, v128, s60, -v14
    v_exp_f32 v128, v128
    s_nop 0
    v_add_f32 v15, v15, v128
    v_cvt_pk_bf16_f32 v128, v128, v128
    v_fma_f32 v129, v129, s60, -v14
    v_exp_f32 v129, v129
    s_nop 0
    v_add_f32 v15, v15, v129
    v_cvt_pk_bf16_f32 v129, v129, v129
    v_and_b32_dpp v44, v116, v28 row_newbcast:0 row_mask:0xf bank_mask:0xf
    v_and_b32_dpp v45, v116, v29 row_newbcast:0 row_mask:0xf bank_mask:0xf
    v_and_b32_dpp v46, v116, v30 row_newbcast:0 row_mask:0xf bank_mask:0xf
    v_and_b32_dpp v47, v116, v31 row_newbcast:0 row_mask:0xf bank_mask:0xf
    s_waitcnt vmcnt(17)
    s_nop 0
    v_mfma_f32_16x16x32_bf16 v[80:83], v[44:47], a[96:99], v[80:83]
    buffer_load_dwordx4 a[240:243], v8, s[20:23], s59 offen offset:512
    v_and_b32_dpp v40, v116, v28 row_newbcast:4 row_mask:0xf bank_mask:0xf
    v_and_b32_dpp v41, v116, v29 row_newbcast:4 row_mask:0xf bank_mask:0xf
    v_and_b32_dpp v42, v116, v30 row_newbcast:4 row_mask:0xf bank_mask:0xf
    v_and_b32_dpp v43, v116, v31 row_newbcast:4 row_mask:0xf bank_mask:0xf
    s_waitcnt vmcnt(17)
    s_nop 0
    v_mfma_f32_16x16x32_bf16 v[80:83], v[40:43], a[80:83], v[80:83]
    s_add_u32 s56, s51, 245760
    buffer_load_dwordx4 a[248:251], v5, s[12:15], s56 offen offset:0 nt
    buffer_load_dwordx4 v[164:167], v5, s[12:15], s56 offen offset:1024 nt
    v_and_b32_dpp v44, v116, v28 row_newbcast:8 row_mask:0xf bank_mask:0xf
    v_and_b32_dpp v45, v116, v29 row_newbcast:8 row_mask:0xf bank_mask:0xf
    v_and_b32_dpp v46, v116, v30 row_newbcast:8 row_mask:0xf bank_mask:0xf
    v_and_b32_dpp v47, v116, v31 row_newbcast:8 row_mask:0xf bank_mask:0xf
    s_waitcnt vmcnt(17)
    s_nop 0
    v_mfma_f32_16x16x32_bf16 v[80:83], v[44:47], a[104:107], v[80:83]
    buffer_load_dwordx4 a[232:235], v8, s[20:23], s59 offen offset:768
    buffer_load_dwordx4 a[224:227], v5, s[12:15], s56 offen offset:2048 nt
    v_and_b32_dpp v40, v116, v28 row_newbcast:12 row_mask:0xf bank_mask:0xf
    v_and_b32_dpp v41, v116, v29 row_newbcast:12 row_mask:0xf bank_mask:0xf
    v_and_b32_dpp v42, v116, v30 row_newbcast:12 row_mask:0xf bank_mask:0xf
    v_and_b32_dpp v43, v116, v31 row_newbcast:12 row_mask:0xf bank_mask:0xf
    s_waitcnt vmcnt(17)
    s_nop 0
    v_mfma_f32_16x16x32_bf16 v[80:83], v[40:43], a[144:147], v[80:83]
    buffer_load_dwordx4 v[156:159], v8, s[20:23], s59 offen offset:1024
    v_fma_f32 v130, v130, s60, -v14
    v_exp_f32 v130, v130
    s_nop 0
    v_add_f32 v15, v15, v130
    v_cvt_pk_bf16_f32 v130, v130, v130
    v_fma_f32 v131, v131, s60, -v14
    v_exp_f32 v131, v131
    s_nop 0
    v_add_f32 v15, v15, v131
    v_cvt_pk_bf16_f32 v131, v131, v131
    v_and_b32_dpp v44, v117, v28 row_newbcast:0 row_mask:0xf bank_mask:0xf
    v_and_b32_dpp v45, v117, v29 row_newbcast:0 row_mask:0xf bank_mask:0xf
    v_and_b32_dpp v46, v117, v30 row_newbcast:0 row_mask:0xf bank_mask:0xf
    v_and_b32_dpp v47, v117, v31 row_newbcast:0 row_mask:0xf bank_mask:0xf
    s_waitcnt vmcnt(17)
    s_nop 0
    v_mfma_f32_16x16x32_bf16 v[80:83], v[44:47], a[112:115], v[80:83]
    buffer_load_dwordx4 v[172:175], v5, s[12:15], s56 offen offset:3072 nt
    s_add_u32 s56, s51, 262144
    buffer_load_dwordx4 v[180:183], v5, s[12:15], s56 offen offset:0 nt
    v_and_b32_dpp v40, v117, v28 row_newbcast:4 row_mask:0xf bank_mask:0xf
    v_and_b32_dpp v41, v117, v29 row_newbcast:4 row_mask:0xf bank_mask:0xf
    v_and_b32_dpp v42, v117, v30 row_newbcast:4 row_mask:0xf bank_mask:0xf
    v_and_b32_dpp v43, v117, v31 row_newbcast:4 row_mask:0xf bank_mask:0xf
    s_waitcnt vmcnt(17)
    s_nop 0
    v_mfma_f32_16x16x32_bf16 v[80:83], v[40:43], a[168:171], v[80:83]
    buffer_load_dwordx4 v[196:199], v8, s[20:23], s59 offen offset:1280
    v_and_b32_dpp v44, v117, v28 row_newbcast:8 row_mask:0xf bank_mask:0xf
    v_and_b32_dpp v45, v117, v29 row_newbcast:8 row_mask:0xf bank_mask:0xf
    v_and_b32_dpp v46, v117, v30 row_newbcast:8 row_mask:0xf bank_mask:0xf
    v_and_b32_dpp v47, v117, v31 row_newbcast:8 row_mask:0xf bank_mask:0xf
    s_waitcnt vmcnt(17)
    s_nop 0
    v_mfma_f32_16x16x32_bf16 v[80:83], v[44:47], a[160:163], v[80:83]
    buffer_load_dwordx4 v[188:191], v5, s[12:15], s56 offen offset:1024 nt
    buffer_load_dwordx4 a[0:3], v5, s[12:15], s56 offen offset:2048 nt
    v_and_b32_dpp v40, v117, v28 row_newbcast:12 row_mask:0xf bank_mask:0xf
    v_and_b32_dpp v41, v117, v29 row_newbcast:12 row_mask:0xf bank_mask:0xf
    v_and_b32_dpp v42, v117, v30 row_newbcast:12 row_mask:0xf bank_mask:0xf
    v_and_b32_dpp v43, v117, v31 row_newbcast:12 row_mask:0xf bank_mask:0xf
    s_waitcnt vmcnt(17)
    s_nop 0
    v_mfma_f32_16x16x32_bf16 v[80:83], v[40:43], a[120:123], v[80:83]
    buffer_load_dwordx4 v[220:223], v8, s[20:23], s59 offen offset:1536
    buffer_load_dwordx4 a[12:15], v5, s[12:15], s56 offen offset:3072 nt
    v_add_f32_dpp v15, v15, v15 row_ror:4 row_mask:0xf bank_mask:0xf
    s_nop 1
    v_add_f32_dpp v15, v15, v15 row_ror:8 row_mask:0xf bank_mask:0xf
    ds_write_b32 v20, v15 offset:8256
    s_lshl_b32 s88, s48, 6
    s_lshl_b32 s3, s47, 1
    s_add_u32 s88, s88, s3
    s_add_u32 s88, s88, s49
    s_mul_i32 s61, s88, 2560
    s_mul_i32 s3, s46, 640
    s_add_u32 s61, s61, s3
    s_lshl_b32 s62, s88, 6
    s_add_u32 s62, s62, 655360
    s_lshl_b32 s63, s50, 1
    s_add_u32 s63, s63, s49
    s_lshl_b32 s64, s63, 5
    s_add_u32 s64, s64, s68
    s_mul_i32 s65, s48, 163840
    s_lshl_b32 s3, s63, 6
    s_add_u32 s65, s65, s3
    s_and_b32 s92, s44, 0xfff
    s_bfe_u32 s93, s44, 0xc000c
    s_and_b32 s94, s45, 0xfff
    s_bfe_u32 s95, s45, 0xc000c
    v_lshlrev_b32 v17, 1, v3
    buffer_load_ushort v18, v17, s[4:7], s64 offen
    buffer_load_dwordx4 v[204:207], v8, s[20:23], s59 offen offset:1792
    v_and_b32_dpp v44, v118, v28 row_newbcast:0 row_mask:0xf bank_mask:0xf
    v_and_b32_dpp v45, v118, v29 row_newbcast:0 row_mask:0xf bank_mask:0xf
    v_and_b32_dpp v46, v118, v30 row_newbcast:0 row_mask:0xf bank_mask:0xf
    v_and_b32_dpp v47, v118, v31 row_newbcast:0 row_mask:0xf bank_mask:0xf
    s_waitcnt vmcnt(19)
    s_nop 0
    v_mfma_f32_16x16x32_bf16 v[80:83], v[44:47], a[184:187], v[80:83]
    v_and_b32_dpp v40, v118, v28 row_newbcast:4 row_mask:0xf bank_mask:0xf
    v_and_b32_dpp v41, v118, v29 row_newbcast:4 row_mask:0xf bank_mask:0xf
    v_and_b32_dpp v42, v118, v30 row_newbcast:4 row_mask:0xf bank_mask:0xf
    v_and_b32_dpp v43, v118, v31 row_newbcast:4 row_mask:0xf bank_mask:0xf
    s_waitcnt vmcnt(18)
    s_nop 0
    v_mfma_f32_16x16x32_bf16 v[80:83], v[40:43], a[176:179], v[80:83]
    s_add_u32 s56, s51, 278528
    buffer_load_dwordx4 v[212:215], v5, s[12:15], s56 offen offset:0 nt
    buffer_load_dwordx4 a[20:23], v5, s[12:15], s56 offen offset:1024 nt
    v_and_b32_dpp v44, v118, v28 row_newbcast:8 row_mask:0xf bank_mask:0xf
    v_and_b32_dpp v45, v118, v29 row_newbcast:8 row_mask:0xf bank_mask:0xf
    v_and_b32_dpp v46, v118, v30 row_newbcast:8 row_mask:0xf bank_mask:0xf
    v_and_b32_dpp v47, v118, v31 row_newbcast:8 row_mask:0xf bank_mask:0xf
    s_waitcnt vmcnt(18)
    s_nop 0
    v_mfma_f32_16x16x32_bf16 v[80:83], v[44:47], a[208:211], v[80:83]
    buffer_load_dwordx4 a[4:7], v8, s[20:23], s59 offen offset:2048
    v_and_b32_dpp v40, v118, v28 row_newbcast:12 row_mask:0xf bank_mask:0xf
    v_and_b32_dpp v41, v118, v29 row_newbcast:12 row_mask:0xf bank_mask:0xf
    v_and_b32_dpp v42, v118, v30 row_newbcast:12 row_mask:0xf bank_mask:0xf
    v_and_b32_dpp v43, v118, v31 row_newbcast:12 row_mask:0xf bank_mask:0xf
    s_waitcnt vmcnt(18)
    s_nop 0
    v_mfma_f32_16x16x32_bf16 v[80:83], v[40:43], a[216:219], v[80:83]
    buffer_load_dwordx4 a[28:31], v5, s[12:15], s56 offen offset:2048 nt
    buffer_load_dwordx4 a[36:39], v5, s[12:15], s56 offen offset:3072 nt
    v_and_b32_dpp v44, v119, v28 row_newbcast:0 row_mask:0xf bank_mask:0xf
    v_and_b32_dpp v45, v119, v29 row_newbcast:0 row_mask:0xf bank_mask:0xf
    v_and_b32_dpp v46, v119, v30 row_newbcast:0 row_mask:0xf bank_mask:0xf
    v_and_b32_dpp v47, v119, v31 row_newbcast:0 row_mask:0xf bank_mask:0xf
    s_waitcnt vmcnt(18)
    s_nop 0
    v_mfma_f32_16x16x32_bf16 v[80:83], v[44:47], a[248:251], v[80:83]
    buffer_load_dwordx4 a[44:47], v8, s[20:23], s59 offen offset:2304
    v_and_b32_dpp v40, v119, v28 row_newbcast:4 row_mask:0xf bank_mask:0xf
    v_and_b32_dpp v41, v119, v29 row_newbcast:4 row_mask:0xf bank_mask:0xf
    v_and_b32_dpp v42, v119, v30 row_newbcast:4 row_mask:0xf bank_mask:0xf
    v_and_b32_dpp v43, v119, v31 row_newbcast:4 row_mask:0xf bank_mask:0xf
    s_waitcnt vmcnt(18)
    s_nop 0
    v_mfma_f32_16x16x32_bf16 v[80:83], v[40:43], v[164:167], v[80:83]
    s_add_u32 s56, s51, 294912
    buffer_load_dwordx4 a[68:71], v5, s[12:15], s56 offen offset:0 nt
    s_add_u32 s59, s54, 7680
    buffer_load_dwordx4 a[76:79], v8, s[20:23], s59 offen offset:0
    v_and_b32_dpp v44, v119, v28 row_newbcast:8 row_mask:0xf bank_mask:0xf
    v_and_b32_dpp v45, v119, v29 row_newbcast:8 row_mask:0xf bank_mask:0xf
    v_and_b32_dpp v46, v119, v30 row_newbcast:8 row_mask:0xf bank_mask:0xf
    v_and_b32_dpp v47, v119, v31 row_newbcast:8 row_mask:0xf bank_mask:0xf
    s_waitcnt vmcnt(18)
    s_nop 0
    v_mfma_f32_16x16x32_bf16 v[80:83], v[44:47], a[224:227], v[80:83]
    buffer_load_dwordx4 a[92:95], v5, s[12:15], s56 offen offset:1024 nt
    buffer_load_dwordx4 a[60:63], v5, s[12:15], s56 offen offset:2048 nt
    v_and_b32_dpp v40, v119, v28 row_newbcast:12 row_mask:0xf bank_mask:0xf
    v_and_b32_dpp v41, v119, v29 row_newbcast:12 row_mask:0xf bank_mask:0xf
    v_and_b32_dpp v42, v119, v30 row_newbcast:12 row_mask:0xf bank_mask:0xf
    v_and_b32_dpp v43, v119, v31 row_newbcast:12 row_mask:0xf bank_mask:0xf
    s_waitcnt vmcnt(18)
    s_nop 0
    v_mfma_f32_16x16x32_bf16 v[80:83], v[40:43], v[172:175], v[80:83]
    buffer_load_dwordx4 a[52:55], v8, s[20:23], s59 offen offset:256
    s_waitcnt lgkmcnt(0)
    s_barrier
    ds_read_b32 v15, v12 offset:8256
    v_mov_b32 v140, v13
    v_mov_b32 v142, s44
    v_mov_b32 v143, s45
    v_mov_b32 v144, 0xfff
    s_waitcnt lgkmcnt(0)
    v_add_f32_dpp v15, v15, v15 quad_perm:[1,0,3,2] row_mask:0xf bank_mask:0xf
    s_nop 1
    v_add_f32_dpp v15, v15, v15 quad_perm:[2,3,0,1] row_mask:0xf bank_mask:0xf
    s_nop 1
    v_add_f32_dpp v15, v15, v15 row_half_mirror row_mask:0xf bank_mask:0xf
    s_nop 1
    v_add_f32_dpp v15, v15, v15 row_mirror row_mask:0xf bank_mask:0xf
    s_cmp_lg_u32 s46, 0
    s_cbranch_scc1 L_pubml_a
    v_mov_b32 v141, v15
    s_mov_b64 exec, 1
    buffer_store_dwordx4 v[140:143], off, s[36:39], s62 sc1
    s_mov_b64 exec, -1
L_pubml_a:
    s_xor_b32 s62, s62, 64
    v_and_b32_dpp v44, v120, v28 row_newbcast:0 row_mask:0xf bank_mask:0xf
    v_and_b32_dpp v45, v120, v29 row_newbcast:0 row_mask:0xf bank_mask:0xf
    v_and_b32_dpp v46, v120, v30 row_newbcast:0 row_mask:0xf bank_mask:0xf
    v_and_b32_dpp v47, v120, v31 row_newbcast:0 row_mask:0xf bank_mask:0xf
    s_waitcnt vmcnt(18)
    s_nop 0
    v_mfma_f32_16x16x32_bf16 v[80:83], v[44:47], v[180:183], v[80:83]
    buffer_load_dwordx4 a[84:87], v5, s[12:15], s56 offen offset:3072 nt
    s_add_u32 s56, s51, 311296
    buffer_load_dwordx4 a[100:103], v5, s[12:15], s56 offen offset:0 nt
    v_and_b32_dpp v40, v120, v28 row_newbcast:4 row_mask:0xf bank_mask:0xf
    v_and_b32_dpp v41, v120, v29 row_newbcast:4 row_mask:0xf bank_mask:0xf
    v_and_b32_dpp v42, v120, v30 row_newbcast:4 row_mask:0xf bank_mask:0xf
    v_and_b32_dpp v43, v120, v31 row_newbcast:4 row_mask:0xf bank_mask:0xf
    s_waitcnt vmcnt(18)
    s_nop 0
    v_mfma_f32_16x16x32_bf16 v[80:83], v[40:43], v[188:191], v[80:83]
    buffer_load_dwordx4 a[108:111], v8, s[20:23], s59 offen offset:512
    v_and_b32_dpp v44, v120, v28 row_newbcast:8 row_mask:0xf bank_mask:0xf
    v_and_b32_dpp v45, v120, v29 row_newbcast:8 row_mask:0xf bank_mask:0xf
    v_and_b32_dpp v46, v120, v30 row_newbcast:8 row_mask:0xf bank_mask:0xf
    v_and_b32_dpp v47, v120, v31 row_newbcast:8 row_mask:0xf bank_mask:0xf
    s_waitcnt vmcnt(18)
    s_nop 0
    v_mfma_f32_16x16x32_bf16 v[80:83], v[44:47], a[0:3], v[80:83]
    buffer_load_dwordx4 a[116:119], v5, s[12:15], s56 offen offset:1024 nt
    buffer_load_dwordx4 a[124:127], v5, s[12:15], s56 offen offset:2048 nt
    v_and_b32_dpp v40, v120, v28 row_newbcast:12 row_mask:0xf bank_mask:0xf
    v_and_b32_dpp v41, v120, v29 row_newbcast:12 row_mask:0xf bank_mask:0xf
    v_and_b32_dpp v42, v120, v30 row_newbcast:12 row_mask:0xf bank_mask:0xf
    v_and_b32_dpp v43, v120, v31 row_newbcast:12 row_mask:0xf bank_mask:0xf
    s_waitcnt vmcnt(18)
    s_nop 0
    v_mfma_f32_16x16x32_bf16 v[80:83], v[40:43], a[12:15], v[80:83]
    buffer_load_dwordx4 a[140:143], v8, s[20:23], s59 offen offset:768
    buffer_load_dwordx4 a[180:183], v5, s[12:15], s56 offen offset:3072 nt
    v_lshrrev_b32 v10, 2, v0
    v_mul_u32_u24 v24, 2560, v10
    v_and_b32 v10, 3, v0
    v_lshl_add_u32 v24, v10, 4, v24
    v_lshrrev_b32 v25, 4, v0
    v_lshlrev_b32 v25, 6, v25
    v_lshl_add_u32 v25, v10, 4, v25
    v_lshlrev_b32 v26, 8, v2
    v_lshl_add_u32 v26, v3, 2, v26
    v_add_u32 v26, 10496, v26
    v_and_b32 v21, 31, v1
    v_lshlrev_b32 v21, 4, v21
    s_mul_i32 s3, s46, 2560
    v_add_u32 v21, s3, v21
    s_mul_i32 s3, s46, 40
    v_add_u32 v23, s3, v1
    v_lshrrev_b32 v22, 5, v23
    v_lshlrev_b32 v22, 9, v22
    v_and_b32 v10, 1, v23
    v_lshl_add_u32 v22, v10, 8, v22
    v_bfe_u32 v10, v23, 1, 4
    v_lshl_add_u32 v22, v10, 4, v22
    v_and_b32_dpp v44, v121, v28 row_newbcast:0 row_mask:0xf bank_mask:0xf
    v_and_b32_dpp v45, v121, v29 row_newbcast:0 row_mask:0xf bank_mask:0xf
    v_and_b32_dpp v46, v121, v30 row_newbcast:0 row_mask:0xf bank_mask:0xf
    v_and_b32_dpp v47, v121, v31 row_newbcast:0 row_mask:0xf bank_mask:0xf
    s_waitcnt vmcnt(17)
    s_nop 0
    v_mfma_f32_16x16x32_bf16 v[80:83], v[44:47], v[212:215], v[80:83]
    buffer_load_dwordx4 a[148:151], v8, s[20:23], s59 offen offset:1024
    v_and_b32_dpp v40, v121, v28 row_newbcast:4 row_mask:0xf bank_mask:0xf
    v_and_b32_dpp v41, v121, v29 row_newbcast:4 row_mask:0xf bank_mask:0xf
    v_and_b32_dpp v42, v121, v30 row_newbcast:4 row_mask:0xf bank_mask:0xf
    v_and_b32_dpp v43, v121, v31 row_newbcast:4 row_mask:0xf bank_mask:0xf
    s_waitcnt vmcnt(17)
    s_nop 0
    v_mfma_f32_16x16x32_bf16 v[80:83], v[40:43], a[20:23], v[80:83]
    s_add_u32 s56, s51, 327680
    buffer_load_dwordx4 a[172:175], v5, s[12:15], s56 offen offset:0 nt
    buffer_load_dwordx4 a[188:191], v5, s[12:15], s56 offen offset:1024 nt
    v_and_b32_dpp v44, v121, v28 row_newbcast:8 row_mask:0xf bank_mask:0xf
    v_and_b32_dpp v45, v121, v29 row_newbcast:8 row_mask:0xf bank_mask:0xf
    v_and_b32_dpp v46, v121, v30 row_newbcast:8 row_mask:0xf bank_mask:0xf
    v_and_b32_dpp v47, v121, v31 row_newbcast:8 row_mask:0xf bank_mask:0xf
    s_waitcnt vmcnt(17)
    s_nop 0
    v_mfma_f32_16x16x32_bf16 v[80:83], v[44:47], a[28:31], v[80:83]
    buffer_load_dwordx4 a[220:223], v8, s[20:23], s59 offen offset:1280
    v_and_b32_dpp v40, v121, v28 row_newbcast:12 row_mask:0xf bank_mask:0xf
    v_and_b32_dpp v41, v121, v29 row_newbcast:12 row_mask:0xf bank_mask:0xf
    v_and_b32_dpp v42, v121, v30 row_newbcast:12 row_mask:0xf bank_mask:0xf
    v_and_b32_dpp v43, v121, v31 row_newbcast:12 row_mask:0xf bank_mask:0xf
    s_waitcnt vmcnt(17)
    s_nop 0
    v_mfma_f32_16x16x32_bf16 v[80:83], v[40:43], a[36:39], v[80:83]
    buffer_load_dwordx4 a[212:215], v5, s[12:15], s56 offen offset:2048 nt
    buffer_load_dwordx4 a[228:231], v5, s[12:15], s56 offen offset:3072 nt
    v_lshlrev_b32 v10, 5, v3
    v_lshl_add_u32 v10, v2, 4, v10
    s_lshl_b32 s3, s46, 9
    v_add_u32 v10, s3, v10
    v_lshrrev_b32 v11, 3, v3
    v_lshlrev_b32 v11, 10, v11
    v_lshl_add_u32 v11, v2, 5, v11
    v_and_b32 v12, 7, v3
    v_lshl_add_u32 v11, v12, 2, v11
    s_lshl_b32 s3, s46, 7
    s_add_u32 s3, s3, 8448
    v_add_u32 v11, s3, v11
    v_and_b32_dpp v44, v122, v28 row_newbcast:0 row_mask:0xf bank_mask:0xf
    v_and_b32_dpp v45, v122, v29 row_newbcast:0 row_mask:0xf bank_mask:0xf
    v_and_b32_dpp v46, v122, v30 row_newbcast:0 row_mask:0xf bank_mask:0xf
    v_and_b32_dpp v47, v122, v31 row_newbcast:0 row_mask:0xf bank_mask:0xf
    s_waitcnt vmcnt(17)
    s_nop 0
    v_mfma_f32_16x16x32_bf16 v[80:83], v[44:47], a[68:71], v[80:83]
    buffer_load_dwordx4 a[244:247], v8, s[20:23], s59 offen offset:1536
    s_add_u32 s56, s51, 344064
    buffer_load_dwordx4 v[160:163], v5, s[12:15], s56 offen offset:0 nt
    v_and_b32_dpp v40, v122, v28 row_newbcast:4 row_mask:0xf bank_mask:0xf
    v_and_b32_dpp v41, v122, v29 row_newbcast:4 row_mask:0xf bank_mask:0xf
    v_and_b32_dpp v42, v122, v30 row_newbcast:4 row_mask:0xf bank_mask:0xf
    v_and_b32_dpp v43, v122, v31 row_newbcast:4 row_mask:0xf bank_mask:0xf
    s_waitcnt vmcnt(17)
    s_nop 0
    v_mfma_f32_16x16x32_bf16 v[80:83], v[40:43], a[92:95], v[80:83]
    buffer_load_dwordx4 v[168:171], v8, s[20:23], s59 offen offset:1792
    v_and_b32_dpp v44, v122, v28 row_newbcast:8 row_mask:0xf bank_mask:0xf
    v_and_b32_dpp v45, v122, v29 row_newbcast:8 row_mask:0xf bank_mask:0xf
    v_and_b32_dpp v46, v122, v30 row_newbcast:8 row_mask:0xf bank_mask:0xf
    v_and_b32_dpp v47, v122, v31 row_newbcast:8 row_mask:0xf bank_mask:0xf
    s_waitcnt vmcnt(17)
    s_nop 0
    v_mfma_f32_16x16x32_bf16 v[80:83], v[44:47], a[60:63], v[80:83]
    buffer_load_dwordx4 v[192:195], v5, s[12:15], s56 offen offset:1024 nt
    buffer_load_dwordx4 v[184:187], v5, s[12:15], s56 offen offset:2048 nt
    v_and_b32_dpp v40, v122, v28 row_newbcast:12 row_mask:0xf bank_mask:0xf
    v_and_b32_dpp v41, v122, v29 row_newbcast:12 row_mask:0xf bank_mask:0xf
    v_and_b32_dpp v42, v122, v30 row_newbcast:12 row_mask:0xf bank_mask:0xf
    v_and_b32_dpp v43, v122, v31 row_newbcast:12 row_mask:0xf bank_mask:0xf
    s_waitcnt vmcnt(17)
    s_nop 0
    v_mfma_f32_16x16x32_bf16 v[80:83], v[40:43], a[84:87], v[80:83]
    buffer_load_dwordx4 v[200:203], v8, s[20:23], s59 offen offset:2048
    v_and_b32_dpp v44, v123, v28 row_newbcast:0 row_mask:0xf bank_mask:0xf
    v_and_b32_dpp v45, v123, v29 row_newbcast:0 row_mask:0xf bank_mask:0xf
    v_and_b32_dpp v46, v123, v30 row_newbcast:0 row_mask:0xf bank_mask:0xf
    v_and_b32_dpp v47, v123, v31 row_newbcast:0 row_mask:0xf bank_mask:0xf
    s_waitcnt vmcnt(17)
    s_nop 0
    v_mfma_f32_16x16x32_bf16 v[80:83], v[44:47], a[100:103], v[80:83]
    buffer_load_dwordx4 v[216:219], v5, s[12:15], s56 offen offset:3072 nt
    s_add_u32 s56, s51, 360448
    buffer_load_dwordx4 v[232:235], v5, s[12:15], s56 offen offset:0 nt
    v_and_b32_dpp v40, v123, v28 row_newbcast:4 row_mask:0xf bank_mask:0xf
    v_and_b32_dpp v41, v123, v29 row_newbcast:4 row_mask:0xf bank_mask:0xf
    v_and_b32_dpp v42, v123, v30 row_newbcast:4 row_mask:0xf bank_mask:0xf
    v_and_b32_dpp v43, v123, v31 row_newbcast:4 row_mask:0xf bank_mask:0xf
    s_waitcnt vmcnt(17)
    s_nop 0
    v_mfma_f32_16x16x32_bf16 v[80:83], v[40:43], a[116:119], v[80:83]
    buffer_load_dwordx4 v[236:239], v8, s[20:23], s59 offen offset:2304
    v_and_b32_dpp v44, v123, v28 row_newbcast:8 row_mask:0xf bank_mask:0xf
    v_and_b32_dpp v45, v123, v29 row_newbcast:8 row_mask:0xf bank_mask:0xf
    v_and_b32_dpp v46, v123, v30 row_newbcast:8 row_mask:0xf bank_mask:0xf
    v_and_b32_dpp v47, v123, v31 row_newbcast:8 row_mask:0xf bank_mask:0xf
    s_waitcnt vmcnt(17)
    s_nop 0
    v_mfma_f32_16x16x32_bf16 v[80:83], v[44:47], a[124:127], v[80:83]
    buffer_load_dwordx4 v[244:247], v5, s[12:15], s56 offen offset:1024 nt
    buffer_load_dwordx4 v[240:243], v5, s[12:15], s56 offen offset:2048 nt
    v_and_b32_dpp v40, v123, v28 row_newbcast:12 row_mask:0xf bank_mask:0xf
    v_and_b32_dpp v41, v123, v29 row_newbcast:12 row_mask:0xf bank_mask:0xf
    v_and_b32_dpp v42, v123, v30 row_newbcast:12 row_mask:0xf bank_mask:0xf
    v_and_b32_dpp v43, v123, v31 row_newbcast:12 row_mask:0xf bank_mask:0xf
    s_waitcnt vmcnt(17)
    s_nop 0
    v_mfma_f32_16x16x32_bf16 v[80:83], v[40:43], a[180:183], v[80:83]
    buffer_load_dwordx4 v[248:251], v5, s[12:15], s56 offen offset:3072 nt
    s_add_u32 s56, s51, 376832
    buffer_load_dwordx4 a[8:11], v5, s[12:15], s56 offen offset:0 nt
    v_and_b32_dpp v44, v124, v28 row_newbcast:0 row_mask:0xf bank_mask:0xf
    v_and_b32_dpp v45, v124, v29 row_newbcast:0 row_mask:0xf bank_mask:0xf
    v_and_b32_dpp v46, v124, v30 row_newbcast:0 row_mask:0xf bank_mask:0xf
    v_and_b32_dpp v47, v124, v31 row_newbcast:0 row_mask:0xf bank_mask:0xf
    s_waitcnt vmcnt(17)
    s_nop 0
    v_mfma_f32_16x16x32_bf16 v[80:83], v[44:47], a[172:175], v[80:83]
    buffer_load_dwordx4 a[16:19], v5, s[12:15], s56 offen offset:1024 nt
    v_and_b32_dpp v40, v124, v28 row_newbcast:4 row_mask:0xf bank_mask:0xf
    v_and_b32_dpp v41, v124, v29 row_newbcast:4 row_mask:0xf bank_mask:0xf
    v_and_b32_dpp v42, v124, v30 row_newbcast:4 row_mask:0xf bank_mask:0xf
    v_and_b32_dpp v43, v124, v31 row_newbcast:4 row_mask:0xf bank_mask:0xf
    s_waitcnt vmcnt(17)
    s_nop 0
    v_mfma_f32_16x16x32_bf16 v[80:83], v[40:43], a[188:191], v[80:83]
    buffer_load_dwordx4 a[32:35], v5, s[12:15], s56 offen offset:2048 nt
    buffer_load_dwordx4 a[64:67], v5, s[12:15], s56 offen offset:3072 nt
    v_and_b32_dpp v44, v124, v28 row_newbcast:8 row_mask:0xf bank_mask:0xf
    v_and_b32_dpp v45, v124, v29 row_newbcast:8 row_mask:0xf bank_mask:0xf
    v_and_b32_dpp v46, v124, v30 row_newbcast:8 row_mask:0xf bank_mask:0xf
    v_and_b32_dpp v47, v124, v31 row_newbcast:8 row_mask:0xf bank_mask:0xf
    s_waitcnt vmcnt(17)
    s_nop 0
    v_mfma_f32_16x16x32_bf16 v[80:83], v[44:47], a[212:215], v[80:83]
    s_add_u32 s56, s51, 393216
    buffer_load_dwordx4 a[72:75], v5, s[12:15], s56 offen offset:0 nt
    v_and_b32_dpp v40, v124, v28 row_newbcast:12 row_mask:0xf bank_mask:0xf
    v_and_b32_dpp v41, v124, v29 row_newbcast:12 row_mask:0xf bank_mask:0xf
    v_and_b32_dpp v42, v124, v30 row_newbcast:12 row_mask:0xf bank_mask:0xf
    v_and_b32_dpp v43, v124, v31 row_newbcast:12 row_mask:0xf bank_mask:0xf
    s_waitcnt vmcnt(17)
    s_nop 0
    v_mfma_f32_16x16x32_bf16 v[80:83], v[40:43], a[228:231], v[80:83]
    buffer_load_dwordx4 a[96:99], v5, s[12:15], s56 offen offset:1024 nt
    buffer_load_dwordx4 a[80:83], v5, s[12:15], s56 offen offset:2048 nt
    buffer_load_dwordx4 v[36:39], off, s[36:39], s62 sc1
    v_and_b32_dpp v44, v125, v28 row_newbcast:0 row_mask:0xf bank_mask:0xf
    v_and_b32_dpp v45, v125, v29 row_newbcast:0 row_mask:0xf bank_mask:0xf
    v_and_b32_dpp v46, v125, v30 row_newbcast:0 row_mask:0xf bank_mask:0xf
    v_and_b32_dpp v47, v125, v31 row_newbcast:0 row_mask:0xf bank_mask:0xf
    s_waitcnt vmcnt(18)
    s_nop 0
    v_mfma_f32_16x16x32_bf16 v[80:83], v[44:47], v[160:163], v[80:83]
    buffer_load_dwordx4 a[104:107], v5, s[12:15], s56 offen offset:3072 nt
    s_add_u32 s56, s51, 409600
    buffer_load_dwordx4 a[144:147], v5, s[12:15], s56 offen offset:0 nt
    v_and_b32_dpp v40, v125, v28 row_newbcast:4 row_mask:0xf bank_mask:0xf
    v_and_b32_dpp v41, v125, v29 row_newbcast:4 row_mask:0xf bank_mask:0xf
    v_and_b32_dpp v42, v125, v30 row_newbcast:4 row_mask:0xf bank_mask:0xf
    v_and_b32_dpp v43, v125, v31 row_newbcast:4 row_mask:0xf bank_mask:0xf
    s_waitcnt vmcnt(18)
    s_nop 0
    v_mfma_f32_16x16x32_bf16 v[80:83], v[40:43], v[192:195], v[80:83]
    buffer_load_dwordx4 a[112:115], v5, s[12:15], s56 offen offset:1024 nt
    v_and_b32_dpp v44, v125, v28 row_newbcast:8 row_mask:0xf bank_mask:0xf
    v_and_b32_dpp v45, v125, v29 row_newbcast:8 row_mask:0xf bank_mask:0xf
    v_and_b32_dpp v46, v125, v30 row_newbcast:8 row_mask:0xf bank_mask:0xf
    v_and_b32_dpp v47, v125, v31 row_newbcast:8 row_mask:0xf bank_mask:0xf
    s_waitcnt vmcnt(18)
    s_nop 0
    v_mfma_f32_16x16x32_bf16 v[80:83], v[44:47], v[184:187], v[80:83]
    buffer_load_dwordx4 a[168:171], v5, s[12:15], s56 offen offset:2048 nt
    buffer_load_dwordx4 a[160:163], v5, s[12:15], s56 offen offset:3072 nt
    v_and_b32_dpp v40, v125, v28 row_newbcast:12 row_mask:0xf bank_mask:0xf
    v_and_b32_dpp v41, v125, v29 row_newbcast:12 row_mask:0xf bank_mask:0xf
    v_and_b32_dpp v42, v125, v30 row_newbcast:12 row_mask:0xf bank_mask:0xf
    v_and_b32_dpp v43, v125, v31 row_newbcast:12 row_mask:0xf bank_mask:0xf
    s_waitcnt vmcnt(18)
    s_nop 0
    v_mfma_f32_16x16x32_bf16 v[80:83], v[40:43], v[216:219], v[80:83]
    s_add_u32 s56, s51, 425984
    buffer_load_dwordx4 a[120:123], v5, s[12:15], s56 offen offset:0 nt
    v_and_b32_dpp v44, v126, v28 row_newbcast:0 row_mask:0xf bank_mask:0xf
    v_and_b32_dpp v45, v126, v29 row_newbcast:0 row_mask:0xf bank_mask:0xf
    v_and_b32_dpp v46, v126, v30 row_newbcast:0 row_mask:0xf bank_mask:0xf
    v_and_b32_dpp v47, v126, v31 row_newbcast:0 row_mask:0xf bank_mask:0xf
    s_waitcnt vmcnt(18)
    s_nop 0
    v_mfma_f32_16x16x32_bf16 v[80:83], v[44:47], v[232:235], v[80:83]
    buffer_load_dwordx4 a[184:187], v5, s[12:15], s56 offen offset:1024 nt
    buffer_load_dwordx4 a[176:179], v5, s[12:15], s56 offen offset:2048 nt
    v_and_b32_dpp v40, v126, v28 row_newbcast:4 row_mask:0xf bank_mask:0xf
    v_and_b32_dpp v41, v126, v29 row_newbcast:4 row_mask:0xf bank_mask:0xf
    v_and_b32_dpp v42, v126, v30 row_newbcast:4 row_mask:0xf bank_mask:0xf
    v_and_b32_dpp v43, v126, v31 row_newbcast:4 row_mask:0xf bank_mask:0xf
    s_waitcnt vmcnt(18)
    s_nop 0
    v_mfma_f32_16x16x32_bf16 v[80:83], v[40:43], v[244:247], v[80:83]
    buffer_load_dwordx4 a[208:211], v5, s[12:15], s56 offen offset:3072 nt
    v_and_b32_dpp v44, v126, v28 row_newbcast:8 row_mask:0xf bank_mask:0xf
    v_and_b32_dpp v45, v126, v29 row_newbcast:8 row_mask:0xf bank_mask:0xf
    v_and_b32_dpp v46, v126, v30 row_newbcast:8 row_mask:0xf bank_mask:0xf
    v_and_b32_dpp v47, v126, v31 row_newbcast:8 row_mask:0xf bank_mask:0xf
    s_waitcnt vmcnt(18)
    s_nop 0
    v_mfma_f32_16x16x32_bf16 v[80:83], v[44:47], v[240:243], v[80:83]
    s_add_u32 s56, s51, 442368
    buffer_load_dwordx4 a[216:219], v5, s[12:15], s56 offen offset:0 nt
    v_and_b32_dpp v40, v126, v28 row_newbcast:12 row_mask:0xf bank_mask:0xf
    v_and_b32_dpp v41, v126, v29 row_newbcast:12 row_mask:0xf bank_mask:0xf
    v_and_b32_dpp v42, v126, v30 row_newbcast:12 row_mask:0xf bank_mask:0xf
    v_and_b32_dpp v43, v126, v31 row_newbcast:12 row_mask:0xf bank_mask:0xf
    s_waitcnt vmcnt(18)
    s_nop 0
    v_mfma_f32_16x16x32_bf16 v[80:83], v[40:43], v[248:251], v[80:83]
    buffer_load_dwordx4 a[248:251], v5, s[12:15], s56 offen offset:1024 nt
    v_and_b32_dpp v44, v127, v28 row_newbcast:0 row_mask:0xf bank_mask:0xf
    v_and_b32_dpp v45, v127, v29 row_newbcast:0 row_mask:0xf bank_mask:0xf
    v_and_b32_dpp v46, v127, v30 row_newbcast:0 row_mask:0xf bank_mask:0xf
    v_and_b32_dpp v47, v127, v31 row_newbcast:0 row_mask:0xf bank_mask:0xf
    s_waitcnt vmcnt(18)
    s_nop 0
    v_mfma_f32_16x16x32_bf16 v[80:83], v[44:47], a[8:11], v[80:83]
    buffer_load_dwordx4 v[164:167], v5, s[12:15], s56 offen offset:2048 nt
    v_and_b32_dpp v40, v127, v28 row_newbcast:4 row_mask:0xf bank_mask:0xf
    v_and_b32_dpp v41, v127, v29 row_newbcast:4 row_mask:0xf bank_mask:0xf
    v_and_b32_dpp v42, v127, v30 row_newbcast:4 row_mask:0xf bank_mask:0xf
    v_and_b32_dpp v43, v127, v31 row_newbcast:4 row_mask:0xf bank_mask:0xf
    s_waitcnt vmcnt(18)
    s_nop 0
    v_mfma_f32_16x16x32_bf16 v[80:83], v[40:43], a[16:19], v[80:83]
    buffer_load_dwordx4 a[224:227], v5, s[12:15], s56 offen offset:3072 nt
    v_and_b32_dpp v44, v127, v28 row_newbcast:8 row_mask:0xf bank_mask:0xf
    v_and_b32_dpp v45, v127, v29 row_newbcast:8 row_mask:0xf bank_mask:0xf
    v_and_b32_dpp v46, v127, v30 row_newbcast:8 row_mask:0xf bank_mask:0xf
    v_and_b32_dpp v47, v127, v31 row_newbcast:8 row_mask:0xf bank_mask:0xf
    s_waitcnt vmcnt(18)
    s_nop 0
    v_mfma_f32_16x16x32_bf16 v[80:83], v[44:47], a[32:35], v[80:83]
    v_and_b32_dpp v40, v127, v28 row_newbcast:12 row_mask:0xf bank_mask:0xf
    v_and_b32_dpp v41, v127, v29 row_newbcast:12 row_mask:0xf bank_mask:0xf
    v_and_b32_dpp v42, v127, v30 row_newbcast:12 row_mask:0xf bank_mask:0xf
    v_and_b32_dpp v43, v127, v31 row_newbcast:12 row_mask:0xf bank_mask:0xf
    s_waitcnt vmcnt(17)
    s_nop 0
    v_mfma_f32_16x16x32_bf16 v[80:83], v[40:43], a[64:67], v[80:83]
    v_and_b32_dpp v44, v128, v28 row_newbcast:0 row_mask:0xf bank_mask:0xf
    v_and_b32_dpp v45, v128, v29 row_newbcast:0 row_mask:0xf bank_mask:0xf
    v_and_b32_dpp v46, v128, v30 row_newbcast:0 row_mask:0xf bank_mask:0xf
    v_and_b32_dpp v47, v128, v31 row_newbcast:0 row_mask:0xf bank_mask:0xf
    s_waitcnt vmcnt(16)
    s_nop 0
    v_mfma_f32_16x16x32_bf16 v[80:83], v[44:47], a[72:75], v[80:83]
    v_and_b32_dpp v40, v128, v28 row_newbcast:4 row_mask:0xf bank_mask:0xf
    v_and_b32_dpp v41, v128, v29 row_newbcast:4 row_mask:0xf bank_mask:0xf
    v_and_b32_dpp v42, v128, v30 row_newbcast:4 row_mask:0xf bank_mask:0xf
    v_and_b32_dpp v43, v128, v31 row_newbcast:4 row_mask:0xf bank_mask:0xf
    s_waitcnt vmcnt(15)
    s_nop 0
    v_mfma_f32_16x16x32_bf16 v[80:83], v[40:43], a[96:99], v[80:83]
    v_and_b32_dpp v44, v128, v28 row_newbcast:8 row_mask:0xf bank_mask:0xf
    v_and_b32_dpp v45, v128, v29 row_newbcast:8 row_mask:0xf bank_mask:0xf
    v_and_b32_dpp v46, v128, v30 row_newbcast:8 row_mask:0xf bank_mask:0xf
    v_and_b32_dpp v47, v128, v31 row_newbcast:8 row_mask:0xf bank_mask:0xf
    s_waitcnt vmcnt(14)
    s_nop 0
    v_mfma_f32_16x16x32_bf16 v[80:83], v[44:47], a[80:83], v[80:83]
    v_and_b32_dpp v40, v128, v28 row_newbcast:12 row_mask:0xf bank_mask:0xf
    v_and_b32_dpp v41, v128, v29 row_newbcast:12 row_mask:0xf bank_mask:0xf
    v_and_b32_dpp v42, v128, v30 row_newbcast:12 row_mask:0xf bank_mask:0xf
    v_and_b32_dpp v43, v128, v31 row_newbcast:12 row_mask:0xf bank_mask:0xf
    s_waitcnt vmcnt(12)
    s_nop 0
    v_mfma_f32_16x16x32_bf16 v[80:83], v[40:43], a[104:107], v[80:83]
    v_and_b32_dpp v44, v129, v28 row_newbcast:0 row_mask:0xf bank_mask:0xf
    v_and_b32_dpp v45, v129, v29 row_newbcast:0 row_mask:0xf bank_mask:0xf
    v_and_b32_dpp v46, v129, v30 row_newbcast:0 row_mask:0xf bank_mask:0xf
    v_and_b32_dpp v47, v129, v31 row_newbcast:0 row_mask:0xf bank_mask:0xf
    s_waitcnt vmcnt(11)
    s_nop 0
    v_mfma_f32_16x16x32_bf16 v[80:83], v[44:47], a[144:147], v[80:83]
    v_and_b32_dpp v40, v129, v28 row_newbcast:4 row_mask:0xf bank_mask:0xf
    v_and_b32_dpp v41, v129, v29 row_newbcast:4 row_mask:0xf bank_mask:0xf
    v_and_b32_dpp v42, v129, v30 row_newbcast:4 row_mask:0xf bank_mask:0xf
    v_and_b32_dpp v43, v129, v31 row_newbcast:4 row_mask:0xf bank_mask:0xf
    s_waitcnt vmcnt(10)
    s_nop 0
    v_mfma_f32_16x16x32_bf16 v[80:83], v[40:43], a[112:115], v[80:83]
    v_and_b32_dpp v44, v129, v28 row_newbcast:8 row_mask:0xf bank_mask:0xf
    v_and_b32_dpp v45, v129, v29 row_newbcast:8 row_mask:0xf bank_mask:0xf
    v_and_b32_dpp v46, v129, v30 row_newbcast:8 row_mask:0xf bank_mask:0xf
    v_and_b32_dpp v47, v129, v31 row_newbcast:8 row_mask:0xf bank_mask:0xf
    s_waitcnt vmcnt(9)
    s_nop 0
    v_mfma_f32_16x16x32_bf16 v[80:83], v[44:47], a[168:171], v[80:83]
    v_and_b32_dpp v40, v129, v28 row_newbcast:12 row_mask:0xf bank_mask:0xf
    v_and_b32_dpp v41, v129, v29 row_newbcast:12 row_mask:0xf bank_mask:0xf
    v_and_b32_dpp v42, v129, v30 row_newbcast:12 row_mask:0xf bank_mask:0xf
    v_and_b32_dpp v43, v129, v31 row_newbcast:12 row_mask:0xf bank_mask:0xf
    s_waitcnt vmcnt(8)
    s_nop 0
    v_mfma_f32_16x16x32_bf16 v[80:83], v[40:43], a[160:163], v[80:83]
    v_and_b32_dpp v44, v130, v28 row_newbcast:0 row_mask:0xf bank_mask:0xf
    v_and_b32_dpp v45, v130, v29 row_newbcast:0 row_mask:0xf bank_mask:0xf
    v_and_b32_dpp v46, v130, v30 row_newbcast:0 row_mask:0xf bank_mask:0xf
    v_and_b32_dpp v47, v130, v31 row_newbcast:0 row_mask:0xf bank_mask:0xf
    s_waitcnt vmcnt(7)
    s_nop 0
    v_mfma_f32_16x16x32_bf16 v[80:83], v[44:47], a[120:123], v[80:83]
    v_and_b32_dpp v40, v130, v28 row_newbcast:4 row_mask:0xf bank_mask:0xf
    v_and_b32_dpp v41, v130, v29 row_newbcast:4 row_mask:0xf bank_mask:0xf
    v_and_b32_dpp v42, v130, v30 row_newbcast:4 row_mask:0xf bank_mask:0xf
    v_and_b32_dpp v43, v130, v31 row_newbcast:4 row_mask:0xf bank_mask:0xf
    s_waitcnt vmcnt(6)
    s_nop 0
    v_mfma_f32_16x16x32_bf16 v[80:83], v[40:43], a[184:187], v[80:83]
    v_and_b32_dpp v44, v130, v28 row_newbcast:8 row_mask:0xf bank_mask:0xf
    v_and_b32_dpp v45, v130, v29 row_newbcast:8 row_mask:0xf bank_mask:0xf
    v_and_b32_dpp v46, v130, v30 row_newbcast:8 row_mask:0xf bank_mask:0xf
    v_and_b32_dpp v47, v130, v31 row_newbcast:8 row_mask:0xf bank_mask:0xf
    s_waitcnt vmcnt(5)
    s_nop 0
    v_mfma_f32_16x16x32_bf16 v[80:83], v[44:47], a[176:179], v[80:83]
    v_and_b32_dpp v40, v130, v28 row_newbcast:12 row_mask:0xf bank_mask:0xf
    v_and_b32_dpp v41, v130, v29 row_newbcast:12 row_mask:0xf bank_mask:0xf
    v_and_b32_dpp v42, v130, v30 row_newbcast:12 row_mask:0xf bank_mask:0xf
    v_and_b32_dpp v43, v130, v31 row_newbcast:12 row_mask:0xf bank_mask:0xf
    s_waitcnt vmcnt(4)
    s_nop 0
    v_mfma_f32_16x16x32_bf16 v[80:83], v[40:43], a[208:211], v[80:83]
    v_cmp_ne_u64 vcc, s[44:45], v[38:39]
    s_mov_b32 s66, 0
    s_cmp_eq_u64 vcc, 0
    s_cbranch_scc1 L_mlok_a
L_mlwait_a:
    buffer_load_dwordx4 v[36:39], off, s[36:39], s62 sc1
    s_add_u32 s66, s66, 1
    s_waitcnt vmcnt(0)
    v_cmp_ne_u64 vcc, s[44:45], v[38:39]
    s_cmp_gt_u32 s66, 0x200000
    s_cbranch_scc1 L_mlok_a
    s_cmp_lg_u64 vcc, 0
    s_cbranch_scc1 L_mlwait_a
L_mlok_a:
    v_max_f32 v16, v36, v13
    v_sub_f32 v36, v36, v16
    v_sub_f32 v38, v13, v16
    v_mul_f32 v36, s60, v36
    v_mul_f32 v38, s60, v38
    v_exp_f32 v36, v36
    v_exp_f32 v38, v38
    v_mul_f32 v16, v36, v37
    v_fmac_f32 v16, v38, v15
    v_rcp_f32 v16, v16
    v_lshlrev_b32 v18, 16, v18
    v_mul_f32 v16, v16, v38
    v_and_b32_dpp v44, v131, v28 row_newbcast:0 row_mask:0xf bank_mask:0xf
    v_and_b32_dpp v45, v131, v29 row_newbcast:0 row_mask:0xf bank_mask:0xf
    v_and_b32_dpp v46, v131, v30 row_newbcast:0 row_mask:0xf bank_mask:0xf
    v_and_b32_dpp v47, v131, v31 row_newbcast:0 row_mask:0xf bank_mask:0xf
    s_waitcnt vmcnt(3)
    s_nop 0
    v_mfma_f32_16x16x32_bf16 v[80:83], v[44:47], a[216:219], v[80:83]
    v_and_b32_dpp v40, v131, v28 row_newbcast:4 row_mask:0xf bank_mask:0xf
    v_and_b32_dpp v41, v131, v29 row_newbcast:4 row_mask:0xf bank_mask:0xf
    v_and_b32_dpp v42, v131, v30 row_newbcast:4 row_mask:0xf bank_mask:0xf
    v_and_b32_dpp v43, v131, v31 row_newbcast:4 row_mask:0xf bank_mask:0xf
    s_waitcnt vmcnt(2)
    s_nop 0
    v_mfma_f32_16x16x32_bf16 v[80:83], v[40:43], a[248:251], v[80:83]
    v_and_b32_dpp v44, v131, v28 row_newbcast:8 row_mask:0xf bank_mask:0xf
    v_and_b32_dpp v45, v131, v29 row_newbcast:8 row_mask:0xf bank_mask:0xf
    v_and_b32_dpp v46, v131, v30 row_newbcast:8 row_mask:0xf bank_mask:0xf
    v_and_b32_dpp v47, v131, v31 row_newbcast:8 row_mask:0xf bank_mask:0xf
    s_waitcnt vmcnt(1)
    s_nop 0
    v_mfma_f32_16x16x32_bf16 v[80:83], v[44:47], v[164:167], v[80:83]
    v_and_b32_dpp v40, v131, v28 row_newbcast:12 row_mask:0xf bank_mask:0xf
    v_and_b32_dpp v41, v131, v29 row_newbcast:12 row_mask:0xf bank_mask:0xf
    v_and_b32_dpp v42, v131, v30 row_newbcast:12 row_mask:0xf bank_mask:0xf
    v_and_b32_dpp v43, v131, v31 row_newbcast:12 row_mask:0xf bank_mask:0xf
    s_waitcnt vmcnt(0)
    s_nop 0
    v_mfma_f32_16x16x32_bf16 v[80:83], v[40:43], a[224:227], v[80:83]
    s_mov_b32 exec_hi, 0
    s_nop 6
    ds_write_b128 v10, v[80:83] offset:8448
    s_mov_b32 exec_hi, -1
    s_waitcnt lgkmcnt(0)
    s_barrier
    ds_read2_b32 v[36:37], v11 offset0:0 offset1:128
    s_waitcnt lgkmcnt(0)
    v_add_f32 v36, v36, v37
    v_mul_f32 v36, v36, v16
    s_nop 1
    v_add_f32_dpp v36, v36, v36 row_ror:8 row_mask:0xf bank_mask:0xf
    v_cvt_pk_bf16_f32 v36, v36, v36
    s_nop 1
    v_and_b32_dpp v104, v36, v28 row_newbcast:0 row_mask:0xf bank_mask:0xf
    v_and_b32_dpp v105, v36, v29 row_newbcast:0 row_mask:0xf bank_mask:0xf
    v_and_b32_dpp v106, v36, v30 row_newbcast:0 row_mask:0xf bank_mask:0xf
    v_and_b32_dpp v107, v36, v31 row_newbcast:0 row_mask:0xf bank_mask:0xf
    s_nop 1
    v_mfma_f32_16x16x32_bf16 v[84:87], v[104:107], a[132:135], v[84:87]
    v_and_b32_dpp v108, v36, v28 row_newbcast:1 row_mask:0xf bank_mask:0xf
    v_and_b32_dpp v109, v36, v29 row_newbcast:1 row_mask:0xf bank_mask:0xf
    v_mfma_f32_16x16x32_bf16 v[88:91], v[104:107], a[164:167], v[88:91]
    v_and_b32_dpp v110, v36, v30 row_newbcast:1 row_mask:0xf bank_mask:0xf
    v_and_b32_dpp v111, v36, v31 row_newbcast:1 row_mask:0xf bank_mask:0xf
    v_mfma_f32_16x16x32_bf16 v[92:95], v[104:107], a[156:159], v[92:95]
    s_nop 0
    v_mfma_f32_16x16x32_bf16 v[84:87], v[108:111], a[236:239], v[84:87]
    v_and_b32_dpp v112, v36, v28 row_newbcast:2 row_mask:0xf bank_mask:0xf
    v_and_b32_dpp v113, v36, v29 row_newbcast:2 row_mask:0xf bank_mask:0xf
    v_mfma_f32_16x16x32_bf16 v[88:91], v[108:111], a[252:255], v[88:91]
    v_and_b32_dpp v114, v36, v30 row_newbcast:2 row_mask:0xf bank_mask:0xf
    v_and_b32_dpp v115, v36, v31 row_newbcast:2 row_mask:0xf bank_mask:0xf
    v_mfma_f32_16x16x32_bf16 v[92:95], v[108:111], v[176:179], v[92:95]
    s_nop 0
    v_mfma_f32_16x16x32_bf16 v[84:87], v[112:115], v[224:227], v[84:87]
    v_and_b32_dpp v116, v36, v28 row_newbcast:3 row_mask:0xf bank_mask:0xf
    v_and_b32_dpp v117, v36, v29 row_newbcast:3 row_mask:0xf bank_mask:0xf
    v_mfma_f32_16x16x32_bf16 v[88:91], v[112:115], a[24:27], v[88:91]
    v_and_b32_dpp v118, v36, v30 row_newbcast:3 row_mask:0xf bank_mask:0xf
    v_and_b32_dpp v119, v36, v31 row_newbcast:3 row_mask:0xf bank_mask:0xf
    v_mfma_f32_16x16x32_bf16 v[92:95], v[112:115], v[252:255], v[92:95]
    s_nop 0
    v_mfma_f32_16x16x32_bf16 v[84:87], v[116:119], a[56:59], v[84:87]
    v_and_b32_dpp v120, v36, v28 row_newbcast:4 row_mask:0xf bank_mask:0xf
    v_and_b32_dpp v121, v36, v29 row_newbcast:4 row_mask:0xf bank_mask:0xf
    v_mfma_f32_16x16x32_bf16 v[88:91], v[116:119], a[88:91], v[88:91]
    v_and_b32_dpp v122, v36, v30 row_newbcast:4 row_mask:0xf bank_mask:0xf
    v_and_b32_dpp v123, v36, v31 row_newbcast:4 row_mask:0xf bank_mask:0xf
    v_mfma_f32_16x16x32_bf16 v[92:95], v[116:119], a[128:131], v[92:95]
    s_nop 0
    v_mfma_f32_16x16x32_bf16 v[84:87], v[120:123], a[152:155], v[84:87]
    v_and_b32_dpp v124, v36, v28 row_newbcast:5 row_mask:0xf bank_mask:0xf
    v_and_b32_dpp v125, v36, v29 row_newbcast:5 row_mask:0xf bank_mask:0xf
    v_mfma_f32_16x16x32_bf16 v[88:91], v[120:123], a[200:203], v[88:91]
    v_and_b32_dpp v126, v36, v30 row_newbcast:5 row_mask:0xf bank_mask:0xf
    v_and_b32_dpp v127, v36, v31 row_newbcast:5 row_mask:0xf bank_mask:0xf
    v_mfma_f32_16x16x32_bf16 v[92:95], v[120:123], a[240:243], v[92:95]
    s_nop 0
    v_mfma_f32_16x16x32_bf16 v[84:87], v[124:127], v[196:199], v[84:87]
    v_and_b32_dpp v128, v36, v28 row_newbcast:6 row_mask:0xf bank_mask:0xf
    v_and_b32_dpp v129, v36, v29 row_newbcast:6 row_mask:0xf bank_mask:0xf
    v_mfma_f32_16x16x32_bf16 v[88:91], v[124:127], v[220:223], v[88:91]
    v_and_b32_dpp v130, v36, v30 row_newbcast:6 row_mask:0xf bank_mask:0xf
    v_and_b32_dpp v131, v36, v31 row_newbcast:6 row_mask:0xf bank_mask:0xf
    v_mfma_f32_16x16x32_bf16 v[92:95], v[124:127], v[204:207], v[92:95]
    s_nop 0
    v_mfma_f32_16x16x32_bf16 v[84:87], v[128:131], a[76:79], v[84:87]
    v_and_b32_dpp v132, v36, v28 row_newbcast:7 row_mask:0xf bank_mask:0xf
    v_and_b32_dpp v133, v36, v29 row_newbcast:7 row_mask:0xf bank_mask:0xf
    v_mfma_f32_16x16x32_bf16 v[88:91], v[128:131], a[52:55], v[88:91]
    v_and_b32_dpp v134, v36, v30 row_newbcast:7 row_mask:0xf bank_mask:0xf
    v_and_b32_dpp v135, v36, v31 row_newbcast:7 row_mask:0xf bank_mask:0xf
    v_mfma_f32_16x16x32_bf16 v[92:95], v[128:131], a[108:111], v[92:95]
    s_nop 0
    v_mfma_f32_16x16x32_bf16 v[84:87], v[132:135], a[220:223], v[84:87]
    v_mfma_f32_16x16x32_bf16 v[88:91], v[132:135], a[244:247], v[88:91]
    v_mfma_f32_16x16x32_bf16 v[92:95], v[132:135], v[168:171], v[92:95]
    v_mfma_f32_16x16x32_bf16 v[96:99], v[104:107], a[204:207], v[96:99]
    v_mfma_f32_16x16x32_bf16 v[96:99], v[108:111], v[208:211], v[96:99]
    v_mfma_f32_16x16x32_bf16 v[96:99], v[112:115], a[48:51], v[96:99]
    v_mfma_f32_16x16x32_bf16 v[96:99], v[116:119], a[136:139], v[96:99]
    v_mfma_f32_16x16x32_bf16 v[96:99], v[120:123], a[232:235], v[96:99]
    v_mfma_f32_16x16x32_bf16 v[96:99], v[124:127], a[4:7], v[96:99]
    v_mfma_f32_16x16x32_bf16 v[96:99], v[128:131], a[140:143], v[96:99]
    ds_write_b128 v21, v[84:87] offset:11520
    v_mfma_f32_16x16x32_bf16 v[96:99], v[132:135], v[200:203], v[96:99]
    ds_write_b128 v21, v[88:91] offset:12032
    v_mfma_f32_16x16x32_bf16 v[100:103], v[104:107], a[196:199], v[100:103]
    ds_write_b128 v21, v[92:95] offset:12544
    v_mfma_f32_16x16x32_bf16 v[100:103], v[108:111], v[228:231], v[100:103]
    v_mfma_f32_16x16x32_bf16 v[100:103], v[112:115], a[40:43], v[100:103]
    v_mfma_f32_16x16x32_bf16 v[100:103], v[116:119], a[192:195], v[100:103]
    v_mfma_f32_16x16x32_bf16 v[100:103], v[120:123], v[156:159], v[100:103]
    v_mfma_f32_16x16x32_bf16 v[100:103], v[124:127], a[44:47], v[100:103]
    v_mfma_f32_16x16x32_bf16 v[100:103], v[128:131], a[148:151], v[100:103]
    v_mfma_f32_16x16x32_bf16 v[100:103], v[132:135], v[236:239], v[100:103]
    ds_write_b128 v21, v[96:99] offset:13056
    s_nop 6
    ds_write_b128 v21, v[100:103] offset:13568
    s_mov_b32 exec_hi, 0xff
    s_waitcnt lgkmcnt(0)
    s_barrier
    ds_read_b128 v[104:107], v22 offset:11520
    ds_read_b128 v[108:111], v22 offset:14080
    ds_read_b128 v[112:115], v22 offset:16640
    ds_read_b128 v[116:119], v22 offset:19200
    s_waitcnt lgkmcnt(2)
    v_pk_add_f32 v[104:105], v[104:105], v[108:109]
    v_pk_add_f32 v[106:107], v[106:107], v[110:111]
    s_waitcnt lgkmcnt(0)
    v_pk_add_f32 v[112:113], v[112:113], v[116:117]
    v_pk_add_f32 v[114:115], v[114:115], v[118:119]
    v_pk_add_f32 v[104:105], v[104:105], v[112:113]
    v_pk_add_f32 v[106:107], v[106:107], v[114:115]
    v_add_u32 v104, 0x800, v104
    v_add_u32 v105, 0x800, v105
    v_add_u32 v106, 0x800, v106
    v_add_u32 v107, 0x800, v107
    v_bfi_b32 v104, v144, s92, v104
    v_bfi_b32 v105, v144, s93, v105
    v_bfi_b32 v106, v144, s94, v106
    v_bfi_b32 v107, v144, s95, v107
    buffer_store_dwordx4 v[104:107], v5, s[36:39], s61 offen sc1
    s_mov_b32 exec_hi, -1
    s_cmp_ge_u32 s63, 40
    s_cbranch_scc1 L_fin_done_a
    s_mov_b32 s66, 0
    s_branch L_zload_a
L_zwait_a:
L_zload_a:
    buffer_load_dwordx4 v[84:87], v24, s[36:39], s65 offen sc1
    s_add_u32 s66, s66, 1
    s_waitcnt vmcnt(0)
    v_xor_b32 v84, s92, v84
    v_xor_b32 v85, s93, v85
    v_xor_b32 v86, s94, v86
    v_xor_b32 v87, s95, v87
    v_or3_b32 v88, v84, v85, v86
    v_or_b32 v88, v88, v87
    v_and_b32 v88, v88, v144
    v_cmp_ne_u32 vcc, 0, v88
    s_cmp_gt_u32 s66, 0x200000
    s_cbranch_scc1 L_polled_a
    s_and_b64 exec, exec, vcc
    s_cbranch_scc1 L_zwait_a
L_polled_a:
    s_mov_b64 exec, -1
    v_add_f32_dpp v84, v84, v84 row_ror:4 row_mask:0xf bank_mask:0xf
    v_add_f32_dpp v85, v85, v85 row_ror:4 row_mask:0xf bank_mask:0xf
    v_add_f32_dpp v86, v86, v86 row_ror:4 row_mask:0xf bank_mask:0xf
    v_add_f32_dpp v87, v87, v87 row_ror:4 row_mask:0xf bank_mask:0xf
    v_add_f32_dpp v84, v84, v84 row_ror:8 row_mask:0xf bank_mask:0xf
    v_add_f32_dpp v85, v85, v85 row_ror:8 row_mask:0xf bank_mask:0xf
    v_add_f32_dpp v86, v86, v86 row_ror:8 row_mask:0xf bank_mask:0xf
    v_add_f32_dpp v87, v87, v87 row_ror:8 row_mask:0xf bank_mask:0xf
    ds_write_b128 v25, v[84:87] offset:10496
    s_waitcnt lgkmcnt(0)
    s_barrier
    s_cmp_lg_u32 s46, 0
    s_cbranch_scc1 L_fin_done_a
    ds_read2_b32 v[84:85], v26 offset0:0 offset1:16
    ds_read2_b32 v[86:87], v26 offset0:32 offset1:48
    s_waitcnt lgkmcnt(0)
    v_pk_add_f32 v[84:85], v[84:85], v[86:87]
    v_add_f32 v84, v84, v85
    v_mov_b32 v85, v84
    s_nop 1
    v_permlane32_swap_b32 v84, v85
    v_add_f32 v84, v84, v85
    v_mov_b32 v85, v84
    s_nop 1
    v_permlane16_swap_b32 v84, v85
    v_add_f32 v84, v84, v85
    v_add_f32 v84, v84, v18
    v_cvt_pk_bf16_f32 v84, v84, v84
    s_mov_b64 exec, 0xffff
    buffer_store_short v84, v17, s[40:43], s64 offen
    s_cmp_lg_u32 s63, 0
    s_cbranch_scc1 L_fin_done_a
    s_mov_b64 exec, 1
    buffer_store_dwordx2 v[142:143], off, s[36:39], s67 sc1
L_fin_done_a:
    s_endpgm
L_end:
    s_endpgm
.p2align 6
L_var_b:
    s_add_u32 s56, s51, 196608
    buffer_load_dwordx4 v[252:255], v4, s[8:11], s56 offen offset:0 nt
    buffer_load_dwordx4 a[8:11], v4, s[8:11], s56 offen offset:1024 nt
    v_mov_b32_dpp v10, v34 row_newbcast:1 row_mask:0xf bank_mask:0x3
    v_mov_b32_dpp v10, v34 row_newbcast:9 row_mask:0xf bank_mask:0xc
    v_and_b32 v40, v10, v28
    v_and_b32 v41, v10, v29
    v_and_b32 v42, v10, v30
    v_and_b32 v43, v10, v31
    s_waitcnt vmcnt(19)
    s_nop 0
    v_mfma_f32_16x16x32_bf16 v[64:67], v[40:43], v[180:183], v[64:67]
    s_waitcnt vmcnt(17)
    v_mfma_f32_16x16x32_bf16 v[68:71], v[40:43], v[188:191], v[68:71]
    buffer_load_dwordx4 a[16:19], v4, s[8:11], s56 offen offset:2048 nt
    buffer_load_dwordx4 a[24:27], v4, s[8:11], s56 offen offset:3072 nt
    s_add_u32 s56, s51, 212992
    buffer_load_dwordx4 a[32:35], v4, s[8:11], s56 offen offset:0 nt
    buffer_load_dwordx4 a[40:43], v4, s[8:11], s56 offen offset:1024 nt
    v_mov_b32_dpp v10, v34 row_newbcast:2 row_mask:0xf bank_mask:0x3
    v_mov_b32_dpp v10, v34 row_newbcast:10 row_mask:0xf bank_mask:0xc
    v_and_b32 v44, v10, v28
    v_and_b32 v45, v10, v29
    v_and_b32 v46, v10, v30
    v_and_b32 v47, v10, v31
    s_waitcnt vmcnt(19)
    s_nop 0
    v_mfma_f32_16x16x32_bf16 v[64:67], v[44:47], v[196:199], v[64:67]
    s_waitcnt vmcnt(17)
    v_mfma_f32_16x16x32_bf16 v[68:71], v[44:47], v[204:207], v[68:71]
    buffer_load_dwordx4 a[48:51], v4, s[8:11], s56 offen offset:2048 nt
    buffer_load_dwordx4 a[56:59], v4, s[8:11], s56 offen offset:3072 nt
    s_add_u32 s56, s51, 229376
    buffer_load_dwordx4 a[64:67], v4, s[8:11], s56 offen offset:0 nt
    buffer_load_dwordx4 a[72:75], v4, s[8:11], s56 offen offset:1024 nt
    v_mov_b32_dpp v10, v34 row_newbcast:3 row_mask:0xf bank_mask:0x3
    v_mov_b32_dpp v10, v34 row_newbcast:11 row_mask:0xf bank_mask:0xc
    v_and_b32 v40, v10, v28
    v_and_b32 v41, v10, v29
    v_and_b32 v42, v10, v30
    v_and_b32 v43, v10, v31
    s_waitcnt vmcnt(19)
    s_nop 0
    v_mfma_f32_16x16x32_bf16 v[64:67], v[40:43], v[212:215], v[64:67]
    s_waitcnt vmcnt(17)
    v_mfma_f32_16x16x32_bf16 v[68:71], v[40:43], v[220:223], v[68:71]
    v_lshrrev_b32 v10, 3, v3
    v_lshlrev_b32 v19, 9, v10
    v_and_b32 v10, 7, v3
    v_lshl_add_u32 v19, v10, 5, v19
    v_and_b32 v10, 1, v2
    v_lshl_add_u32 v19, v10, 4, v19
    s_lshl_b32 s3, s46, 10
    v_add_u32 v19, s3, v19
    s_mov_b32 exec_lo, 0x00ff00ff
    s_mov_b32 exec_hi, 0xff00ff00
    ds_write_b128 v19, v[64:67] offset:0
    ds_write_b128 v19, v[68:71] offset:256
    s_mov_b64 exec, -1
    v_lshrrev_b32 v10, 2, v3
    v_lshlrev_b32 v10, 10, v10
    v_lshl_add_u32 v10, v2, 7, v10
    v_and_b32 v11, 3, v3
    v_lshl_add_u32 v10, v11, 5, v10
    buffer_load_dwordx4 a[80:83], v4, s[8:11], s56 offen offset:2048 nt
    s_waitcnt lgkmcnt(0)
    s_barrier
    ds_read_b128 v[140:143], v10 offset:0
    ds_read_b128 v[144:147], v10 offset:16
    ds_read_b128 v[148:151], v10 offset:512
    ds_read_b128 v[152:155], v10 offset:528
    s_add_u32 s44, s44, 0x9e3779b9
    s_add_u32 s45, s45, 0x85ebca6b
    s_waitcnt lgkmcnt(0)
    v_pk_add_f32 v[140:141], v[140:141], v[148:149]
    v_pk_add_f32 v[142:143], v[142:143], v[150:151]
    v_pk_add_f32 v[144:145], v[144:145], v[152:153]
    v_pk_add_f32 v[146:147], v[146:147], v[154:155]
    v_add_f32_dpp v140, v140, v140 row_ror:4 row_mask:0xf bank_mask:0xf
    v_add_f32_dpp v141, v141, v141 row_ror:4 row_mask:0xf bank_mask:0xf
    v_add_f32_dpp v142, v142, v142 row_ror:4 row_mask:0xf bank_mask:0xf
    v_add_f32_dpp v143, v143, v143 row_ror:4 row_mask:0xf bank_mask:0xf
    v_add_f32_dpp v144, v144, v144 row_ror:4 row_mask:0xf bank_mask:0xf
    v_add_f32_dpp v145, v145, v145 row_ror:4 row_mask:0xf bank_mask:0xf
    v_add_f32_dpp v146, v146, v146 row_ror:4 row_mask:0xf bank_mask:0xf
    v_add_f32_dpp v147, v147, v147 row_ror:4 row_mask:0xf bank_mask:0xf
    v_add_f32_dpp v140, v140, v140 row_ror:8 row_mask:0xf bank_mask:0xf
    v_add_f32_dpp v141, v141, v141 row_ror:8 row_mask:0xf bank_mask:0xf
    v_add_f32_dpp v142, v142, v142 row_ror:8 row_mask:0xf bank_mask:0xf
    v_add_f32_dpp v143, v143, v143 row_ror:8 row_mask:0xf bank_mask:0xf
    v_add_f32_dpp v144, v144, v144 row_ror:8 row_mask:0xf bank_mask:0xf
    v_add_f32_dpp v145, v145, v145 row_ror:8 row_mask:0xf bank_mask:0xf
    v_add_f32_dpp v146, v146, v146 row_ror:8 row_mask:0xf bank_mask:0xf
    v_add_f32_dpp v147, v147, v147 row_ror:8 row_mask:0xf bank_mask:0xf
    buffer_load_dwordx4 a[88:91], v4, s[8:11], s56 offen offset:3072 nt
    v_cvt_pk_bf16_f32 v148, v140, v141
    v_cvt_pk_bf16_f32 v149, v142, v143
    v_cvt_pk_bf16_f32 v150, v144, v145
    v_cvt_pk_bf16_f32 v151, v146, v147
    v_mov_b32_dpp v48, v148 quad_perm:[0,1,2,3] row_mask:0xf bank_mask:0x1
    v_mov_b32_dpp v49, v149 quad_perm:[0,1,2,3] row_mask:0xf bank_mask:0x1
    v_mov_b32_dpp v50, v150 quad_perm:[0,1,2,3] row_mask:0xf bank_mask:0x1
    v_mov_b32_dpp v51, v151 quad_perm:[0,1,2,3] row_mask:0xf bank_mask:0x1
    v_mov_b32_dpp v52, v148 quad_perm:[0,1,2,3] row_mask:0xf bank_mask:0x2
    v_mov_b32_dpp v53, v149 quad_perm:[0,1,2,3] row_mask:0xf bank_mask:0x2
    v_mov_b32_dpp v54, v150 quad_perm:[0,1,2,3] row_mask:0xf bank_mask:0x2
    v_mov_b32_dpp v55, v151 quad_perm:[0,1,2,3] row_mask:0xf bank_mask:0x2
    v_mov_b32_dpp v56, v148 quad_perm:[0,1,2,3] row_mask:0xf bank_mask:0x4
    v_mov_b32_dpp v57, v149 quad_perm:[0,1,2,3] row_mask:0xf bank_mask:0x4
    v_mov_b32_dpp v58, v150 quad_perm:[0,1,2,3] row_mask:0xf bank_mask:0x4
    v_mov_b32_dpp v59, v151 quad_perm:[0,1,2,3] row_mask:0xf bank_mask:0x4
    v_mov_b32_dpp v60, v148 quad_perm:[0,1,2,3] row_mask:0xf bank_mask:0x8
    v_mov_b32_dpp v61, v149 quad_perm:[0,1,2,3] row_mask:0xf bank_mask:0x8
    v_mov_b32_dpp v62, v150 quad_perm:[0,1,2,3] row_mask:0xf bank_mask:0x8
    v_mov_b32_dpp v63, v151 quad_perm:[0,1,2,3] row_mask:0xf bank_mask:0x8
    v_mfma_f32_16x16x32_bf16 v[72:75], a[0:3], v[48:51], 0
    v_mfma_f32_16x16x32_bf16 v[72:75], a[4:7], v[52:55], v[72:75]
    v_mfma_f32_16x16x32_bf16 v[72:75], a[12:15], v[56:59], v[72:75]
    v_mfma_f32_16x16x32_bf16 v[72:75], a[20:23], v[60:63], v[72:75]
    s_add_u32 s56, s51, 245760
    buffer_load_dwordx4 a[96:99], v4, s[8:11], s56 offen offset:0 nt
    v_mfma_f32_16x16x32_bf16 v[76:79], a[28:31], v[48:51], 0
    v_mfma_f32_16x16x32_bf16 v[76:79], a[36:39], v[52:55], v[76:79]
    v_mfma_f32_16x16x32_bf16 v[76:79], a[44:47], v[56:59], v[76:79]
    v_mfma_f32_16x16x32_bf16 v[76:79], a[52:55], v[60:63], v[76:79]
    s_nop 1
    v_mov_b32_dpp v104, v72 quad_perm:[0,0,0,0] row_mask:0xf bank_mask:0xf
    v_add_f32_dpp v104, v73, v104 quad_perm:[1,1,1,1] row_mask:0xf bank_mask:0xf
    v_add_f32_dpp v104, v74, v104 quad_perm:[2,2,2,2] row_mask:0xf bank_mask:0xf
    v_add_f32_dpp v104, v75, v104 quad_perm:[3,3,3,3] row_mask:0xf bank_mask:0xf
    v_cvt_pk_bf16_f32 v104, 0, v104
    v_mul_f32 v104, 0x3db504f3, v104
    v_cvt_pk_bf16_f32 v104, 0, v104
    v_max_f32 v13, v13, v104
    v_mfma_f32_16x16x32_bf16 v[72:75], a[60:63], v[48:51], 0
    v_mfma_f32_16x16x32_bf16 v[72:75], a[68:71], v[52:55], v[72:75]
    v_mfma_f32_16x16x32_bf16 v[72:75], a[76:79], v[56:59], v[72:75]
    v_mfma_f32_16x16x32_bf16 v[72:75], a[84:87], v[60:63], v[72:75]
    v_mov_b32_dpp v105, v76 quad_perm:[0,0,0,0] row_mask:0xf bank_mask:0xf
    v_add_f32_dpp v105, v77, v105 quad_perm:[1,1,1,1] row_mask:0xf bank_mask:0xf
    v_add_f32_dpp v105, v78, v105 quad_perm:[2,2,2,2] row_mask:0xf bank_mask:0xf
    v_add_f32_dpp v105, v79, v105 quad_perm:[3,3,3,3] row_mask:0xf bank_mask:0xf
    v_cvt_pk_bf16_f32 v105, 0, v105
    v_mul_f32 v105, 0x3db504f3, v105
    v_cvt_pk_bf16_f32 v105, 0, v105
    v_max_f32 v13, v13, v105
    buffer_load_dwordx4 a[104:107], v4, s[8:11], s56 offen offset:1024 nt
    v_mfma_f32_16x16x32_bf16 v[76:79], a[92:95], v[48:51], 0
    v_mfma_f32_16x16x32_bf16 v[76:79], a[100:103], v[52:55], v[76:79]
    v_mfma_f32_16x16x32_bf16 v[76:79], a[108:111], v[56:59], v[76:79]
    v_mfma_f32_16x16x32_bf16 v[76:79], a[116:119], v[60:63], v[76:79]
    v_mov_b32_dpp v106, v72 quad_perm:[0,0,0,0] row_mask:0xf bank_mask:0xf
    v_add_f32_dpp v106, v73, v106 quad_perm:[1,1,1,1] row_mask:0xf bank_mask:0xf
    v_add_f32_dpp v106, v74, v106 quad_perm:[2,2,2,2] row_mask:0xf bank_mask:0xf
    v_add_f32_dpp v106, v75, v106 quad_perm:[3,3,3,3] row_mask:0xf bank_mask:0xf
    v_cvt_pk_bf16_f32 v106, 0, v106
    v_mul_f32 v106, 0x3db504f3, v106
    v_cvt_pk_bf16_f32 v106, 0, v106
    v_max_f32 v13, v13, v106
    v_mfma_f32_16x16x32_bf16 v[72:75], a[124:127], v[48:51], 0
    v_mfma_f32_16x16x32_bf16 v[72:75], a[132:135], v[52:55], v[72:75]
    v_mfma_f32_16x16x32_bf16 v[72:75], a[140:143], v[56:59], v[72:75]
    v_mfma_f32_16x16x32_bf16 v[72:75], a[148:151], v[60:63], v[72:75]
    v_mov_b32_dpp v107, v76 quad_perm:[0,0,0,0] row_mask:0xf bank_mask:0xf
    v_add_f32_dpp v107, v77, v107 quad_perm:[1,1,1,1] row_mask:0xf bank_mask:0xf
    v_add_f32_dpp v107, v78, v107 quad_perm:[2,2,2,2] row_mask:0xf bank_mask:0xf
    v_add_f32_dpp v107, v79, v107 quad_perm:[3,3,3,3] row_mask:0xf bank_mask:0xf
    v_cvt_pk_bf16_f32 v107, 0, v107
    v_mul_f32 v107, 0x3db504f3, v107
    v_cvt_pk_bf16_f32 v107, 0, v107
    v_max_f32 v13, v13, v107
    buffer_load_dwordx4 a[112:115], v4, s[8:11], s56 offen offset:2048 nt
    v_mfma_f32_16x16x32_bf16 v[76:79], a[156:159], v[48:51], 0
    v_mfma_f32_16x16x32_bf16 v[76:79], a[164:167], v[52:55], v[76:79]
    v_mfma_f32_16x16x32_bf16 v[76:79], a[172:175], v[56:59], v[76:79]
    v_mfma_f32_16x16x32_bf16 v[76:79], a[180:183], v[60:63], v[76:79]
    v_mov_b32_dpp v108, v72 quad_perm:[0,0,0,0] row_mask:0xf bank_mask:0xf
    v_add_f32_dpp v108, v73, v108 quad_perm:[1,1,1,1] row_mask:0xf bank_mask:0xf
    v_add_f32_dpp v108, v74, v108 quad_perm:[2,2,2,2] row_mask:0xf bank_mask:0xf
    v_add_f32_dpp v108, v75, v108 quad_perm:[3,3,3,3] row_mask:0xf bank_mask:0xf
    v_cvt_pk_bf16_f32 v108, 0, v108
    v_mul_f32 v108, 0x3db504f3, v108
    v_cvt_pk_bf16_f32 v108, 0, v108
    v_max_f32 v13, v13, v108
    v_mfma_f32_16x16x32_bf16 v[72:75], a[188:191], v[48:51], 0
    v_mfma_f32_16x16x32_bf16 v[72:75], a[196:199], v[52:55], v[72:75]
    v_mfma_f32_16x16x32_bf16 v[72:75], a[204:207], v[56:59], v[72:75]
    v_mfma_f32_16x16x32_bf16 v[72:75], a[212:215], v[60:63], v[72:75]
    v_mov_b32_dpp v109, v76 quad_perm:[0,0,0,0] row_mask:0xf bank_mask:0xf
    v_add_f32_dpp v109, v77, v109 quad_perm:[1,1,1,1] row_mask:0xf bank_mask:0xf
    v_add_f32_dpp v109, v78, v109 quad_perm:[2,2,2,2] row_mask:0xf bank_mask:0xf
    v_add_f32_dpp v109, v79, v109 quad_perm:[3,3,3,3] row_mask:0xf bank_mask:0xf
    v_cvt_pk_bf16_f32 v109, 0, v109
    v_mul_f32 v109, 0x3db504f3, v109
    v_cvt_pk_bf16_f32 v109, 0, v109
    v_max_f32 v13, v13, v109
    buffer_load_dwordx4 a[120:123], v4, s[8:11], s56 offen offset:3072 nt
    v_mfma_f32_16x16x32_bf16 v[76:79], a[220:223], v[48:51], 0
    v_mfma_f32_16x16x32_bf16 v[76:79], a[228:231], v[52:55], v[76:79]
    v_mfma_f32_16x16x32_bf16 v[76:79], a[236:239], v[56:59], v[76:79]
    v_mfma_f32_16x16x32_bf16 v[76:79], a[244:247], v[60:63], v[76:79]
    v_mov_b32_dpp v110, v72 quad_perm:[0,0,0,0] row_mask:0xf bank_mask:0xf
    v_add_f32_dpp v110, v73, v110 quad_perm:[1,1,1,1] row_mask:0xf bank_mask:0xf
    v_add_f32_dpp v110, v74, v110 quad_perm:[2,2,2,2] row_mask:0xf bank_mask:0xf
    v_add_f32_dpp v110, v75, v110 quad_perm:[3,3,3,3] row_mask:0xf bank_mask:0xf
    v_cvt_pk_bf16_f32 v110, 0, v110
    v_mul_f32 v110, 0x3db504f3, v110
    v_cvt_pk_bf16_f32 v110, 0, v110
    v_max_f32 v13, v13, v110
    v_mfma_f32_16x16x32_bf16 v[72:75], a[252:255], v[48:51], 0
    v_mfma_f32_16x16x32_bf16 v[72:75], v[160:163], v[52:55], v[72:75]
    v_mfma_f32_16x16x32_bf16 v[72:75], v[168:171], v[56:59], v[72:75]
    v_mfma_f32_16x16x32_bf16 v[72:75], v[176:179], v[60:63], v[72:75]
    v_mov_b32_dpp v111, v76 quad_perm:[0,0,0,0] row_mask:0xf bank_mask:0xf
    v_add_f32_dpp v111, v77, v111 quad_perm:[1,1,1,1] row_mask:0xf bank_mask:0xf
    v_add_f32_dpp v111, v78, v111 quad_perm:[2,2,2,2] row_mask:0xf bank_mask:0xf
    v_add_f32_dpp v111, v79, v111 quad_perm:[3,3,3,3] row_mask:0xf bank_mask:0xf
    v_cvt_pk_bf16_f32 v111, 0, v111
    v_mul_f32 v111, 0x3db504f3, v111
    v_cvt_pk_bf16_f32 v111, 0, v111
    v_max_f32 v13, v13, v111
    s_add_u32 s59, s54, 0
    buffer_load_dwordx4 a[128:131], v8, s[20:23], s59 offen offset:0
    v_mfma_f32_16x16x32_bf16 v[76:79], v[184:187], v[48:51], 0
    v_mfma_f32_16x16x32_bf16 v[76:79], v[192:195], v[52:55], v[76:79]
    v_mfma_f32_16x16x32_bf16 v[76:79], v[200:203], v[56:59], v[76:79]
    v_mfma_f32_16x16x32_bf16 v[76:79], v[208:211], v[60:63], v[76:79]
    v_mov_b32_dpp v112, v72 quad_perm:[0,0,0,0] row_mask:0xf bank_mask:0xf
    v_add_f32_dpp v112, v73, v112 quad_perm:[1,1,1,1] row_mask:0xf bank_mask:0xf
    v_add_f32_dpp v112, v74, v112 quad_perm:[2,2,2,2] row_mask:0xf bank_mask:0xf
    v_add_f32_dpp v112, v75, v112 quad_perm:[3,3,3,3] row_mask:0xf bank_mask:0xf
    v_cvt_pk_bf16_f32 v112, 0, v112
    v_mul_f32 v112, 0x3db504f3, v112
    v_cvt_pk_bf16_f32 v112, 0, v112
    v_max_f32 v13, v13, v112
    v_mfma_f32_16x16x32_bf16 v[72:75], v[216:219], v[48:51], 0
    s_waitcnt vmcnt(23)
    v_mfma_f32_16x16x32_bf16 v[72:75], v[224:227], v[52:55], v[72:75]
    s_waitcnt vmcnt(22)
    v_mfma_f32_16x16x32_bf16 v[72:75], v[228:231], v[56:59], v[72:75]
    s_waitcnt vmcnt(21)
    v_mfma_f32_16x16x32_bf16 v[72:75], v[232:235], v[60:63], v[72:75]
    v_mov_b32_dpp v113, v76 quad_perm:[0,0,0,0] row_mask:0xf bank_mask:0xf
    v_add_f32_dpp v113, v77, v113 quad_perm:[1,1,1,1] row_mask:0xf bank_mask:0xf
    v_add_f32_dpp v113, v78, v113 quad_perm:[2,2,2,2] row_mask:0xf bank_mask:0xf
    v_add_f32_dpp v113, v79, v113 quad_perm:[3,3,3,3] row_mask:0xf bank_mask:0xf
    v_cvt_pk_bf16_f32 v113, 0, v113
    v_mul_f32 v113, 0x3db504f3, v113
    v_cvt_pk_bf16_f32 v113, 0, v113
    v_max_f32 v13, v13, v113
    s_add_u32 s56, s51, 262144
    buffer_load_dwordx4 a[136:139], v4, s[8:11], s56 offen offset:0 nt
    s_waitcnt vmcnt(21)
    v_mfma_f32_16x16x32_bf16 v[76:79], v[236:239], v[48:51], 0
    s_waitcnt vmcnt(20)
    v_mfma_f32_16x16x32_bf16 v[76:79], v[240:243], v[52:55], v[76:79]
    s_waitcnt vmcnt(19)
    v_mfma_f32_16x16x32_bf16 v[76:79], v[244:247], v[56:59], v[76:79]
    s_waitcnt vmcnt(18)
    v_mfma_f32_16x16x32_bf16 v[76:79], v[248:251], v[60:63], v[76:79]
    v_mov_b32_dpp v114, v72 quad_perm:[0,0,0,0] row_mask:0xf bank_mask:0xf
    v_add_f32_dpp v114, v73, v114 quad_perm:[1,1,1,1] row_mask:0xf bank_mask:0xf
    v_add_f32_dpp v114, v74, v114 quad_perm:[2,2,2,2] row_mask:0xf bank_mask:0xf
    v_add_f32_dpp v114, v75, v114 quad_perm:[3,3,3,3] row_mask:0xf bank_mask:0xf
    v_cvt_pk_bf16_f32 v114, 0, v114
    v_mul_f32 v114, 0x3db504f3, v114
    v_cvt_pk_bf16_f32 v114, 0, v114
    v_max_f32 v13, v13, v114
    buffer_load_dwordx4 a[144:147], v4, s[8:11], s56 offen offset:1024 nt
    buffer_load_dwordx4 a[152:155], v4, s[8:11], s56 offen offset:2048 nt
    buffer_load_dwordx4 a[160:163], v4, s[8:11], s56 offen offset:3072 nt
    s_waitcnt vmcnt(20)
    v_mfma_f32_16x16x32_bf16 v[72:75], v[252:255], v[48:51], 0
    s_waitcnt vmcnt(19)
    v_mfma_f32_16x16x32_bf16 v[72:75], a[8:11], v[52:55], v[72:75]
    s_waitcnt vmcnt(18)
    v_mfma_f32_16x16x32_bf16 v[72:75], a[16:19], v[56:59], v[72:75]
    s_waitcnt vmcnt(17)
    v_mfma_f32_16x16x32_bf16 v[72:75], a[24:27], v[60:63], v[72:75]
    v_mov_b32_dpp v115, v76 quad_perm:[0,0,0,0] row_mask:0xf bank_mask:0xf
    v_add_f32_dpp v115, v77, v115 quad_perm:[1,1,1,1] row_mask:0xf bank_mask:0xf
    v_add_f32_dpp v115, v78, v115 quad_perm:[2,2,2,2] row_mask:0xf bank_mask:0xf
    v_add_f32_dpp v115, v79, v115 quad_perm:[3,3,3,3] row_mask:0xf bank_mask:0xf
    v_cvt_pk_bf16_f32 v115, 0, v115
    v_mul_f32 v115, 0x3db504f3, v115
    v_cvt_pk_bf16_f32 v115, 0, v115
    v_max_f32 v13, v13, v115
    s_add_u32 s56, s51, 278528
    buffer_load_dwordx4 a[168:171], v4, s[8:11], s56 offen offset:0 nt
    buffer_load_dwordx4 a[176:179], v4, s[8:11], s56 offen offset:1024 nt
    buffer_load_dwordx4 a[184:187], v8, s[20:23], s59 offen offset:256
    buffer_load_dwordx4 a[192:195], v4, s[8:11], s56 offen offset:2048 nt
    s_waitcnt vmcnt(20)
    v_mfma_f32_16x16x32_bf16 v[76:79], a[32:35], v[48:51], 0
    s_waitcnt vmcnt(19)
    v_mfma_f32_16x16x32_bf16 v[76:79], a[40:43], v[52:55], v[76:79]
    s_waitcnt vmcnt(18)
    v_mfma_f32_16x16x32_bf16 v[76:79], a[48:51], v[56:59], v[76:79]
    s_waitcnt vmcnt(17)
    v_mfma_f32_16x16x32_bf16 v[76:79], a[56:59], v[60:63], v[76:79]
    v_mov_b32_dpp v116, v72 quad_perm:[0,0,0,0] row_mask:0xf bank_mask:0xf
    v_add_f32_dpp v116, v73, v116 quad_perm:[1,1,1,1] row_mask:0xf bank_mask:0xf
    v_add_f32_dpp v116, v74, v116 quad_perm:[2,2,2,2] row_mask:0xf bank_mask:0xf
    v_add_f32_dpp v116, v75, v116 quad_perm:[3,3,3,3] row_mask:0xf bank_mask:0xf
    v_cvt_pk_bf16_f32 v116, 0, v116
    v_mul_f32 v116, 0x3db504f3, v116
    v_cvt_pk_bf16_f32 v116, 0, v116
    v_max_f32 v13, v13, v116
    buffer_load_dwordx4 a[200:203], v4, s[8:11], s56 offen offset:3072 nt
    s_add_u32 s56, s51, 294912
    buffer_load_dwordx4 a[208:211], v4, s[8:11], s56 offen offset:0 nt
    buffer_load_dwordx4 a[216:219], v4, s[8:11], s56 offen offset:1024 nt
    buffer_load_dwordx4 a[224:227], v4, s[8:11], s56 offen offset:2048 nt
    s_waitcnt vmcnt(20)
    v_mfma_f32_16x16x32_bf16 v[72:75], a[64:67], v[48:51], 0
    s_waitcnt vmcnt(19)
    v_mfma_f32_16x16x32_bf16 v[72:75], a[72:75], v[52:55], v[72:75]
    s_waitcnt vmcnt(18)
    v_mfma_f32_16x16x32_bf16 v[72:75], a[80:83], v[56:59], v[72:75]
    s_waitcnt vmcnt(17)
    v_mfma_f32_16x16x32_bf16 v[72:75], a[88:91], v[60:63], v[72:75]
    v_mov_b32_dpp v117, v76 quad_perm:[0,0,0,0] row_mask:0xf bank_mask:0xf
    v_add_f32_dpp v117, v77, v117 quad_perm:[1,1,1,1] row_mask:0xf bank_mask:0xf
    v_add_f32_dpp v117, v78, v117 quad_perm:[2,2,2,2] row_mask:0xf bank_mask:0xf
    v_add_f32_dpp v117, v79, v117 quad_perm:[3,3,3,3] row_mask:0xf bank_mask:0xf
    v_cvt_pk_bf16_f32 v117, 0, v117
    v_mul_f32 v117, 0x3db504f3, v117
    v_cvt_pk_bf16_f32 v117, 0, v117
    v_max_f32 v13, v13, v117
    buffer_load_dwordx4 a[232:235], v8, s[20:23], s59 offen offset:512
    buffer_load_dwordx4 a[240:243], v4, s[8:11], s56 offen offset:3072 nt
    s_add_u32 s56, s51, 311296
    buffer_load_dwordx4 a[248:251], v4, s[8:11], s56 offen offset:0 nt
    buffer_load_dwordx4 v[156:159], v4, s[8:11], s56 offen offset:1024 nt
    s_waitcnt vmcnt(20)
    v_mfma_f32_16x16x32_bf16 v[76:79], a[96:99], v[48:51], 0
    s_waitcnt vmcnt(19)
    v_mfma_f32_16x16x32_bf16 v[76:79], a[104:107], v[52:55], v[76:79]
    s_waitcnt vmcnt(18)
    v_mfma_f32_16x16x32_bf16 v[76:79], a[112:115], v[56:59], v[76:79]
    s_waitcnt vmcnt(17)
    v_mfma_f32_16x16x32_bf16 v[76:79], a[120:123], v[60:63], v[76:79]
    v_mov_b32_dpp v118, v72 quad_perm:[0,0,0,0] row_mask:0xf bank_mask:0xf
    v_add_f32_dpp v118, v73, v118 quad_perm:[1,1,1,1] row_mask:0xf bank_mask:0xf
    v_add_f32_dpp v118, v74, v118 quad_perm:[2,2,2,2] row_mask:0xf bank_mask:0xf
    v_add_f32_dpp v118, v75, v118 quad_perm:[3,3,3,3] row_mask:0xf bank_mask:0xf
    v_cvt_pk_bf16_f32 v118, 0, v118
    v_mul_f32 v118, 0x3db504f3, v118
    v_cvt_pk_bf16_f32 v118, 0, v118
    v_max_f32 v13, v13, v118
    buffer_load_dwordx4 v[164:167], v4, s[8:11], s56 offen offset:2048 nt
    buffer_load_dwordx4 v[172:175], v4, s[8:11], s56 offen offset:3072 nt
    buffer_load_dwordx4 v[180:183], v8, s[20:23], s59 offen offset:768
    s_add_u32 s56, s51, 327680
    buffer_load_dwordx4 v[188:191], v4, s[8:11], s56 offen offset:0 nt
    buffer_load_dwordx4 v[196:199], v4, s[8:11], s56 offen offset:1024 nt
    s_waitcnt vmcnt(20)
    v_mfma_f32_16x16x32_bf16 v[72:75], a[136:139], v[48:51], 0
    s_waitcnt vmcnt(19)
    v_mfma_f32_16x16x32_bf16 v[72:75], a[144:147], v[52:55], v[72:75]
    s_waitcnt vmcnt(18)
    v_mfma_f32_16x16x32_bf16 v[72:75], a[152:155], v[56:59], v[72:75]
    s_waitcnt vmcnt(17)
    v_mfma_f32_16x16x32_bf16 v[72:75], a[160:163], v[60:63], v[72:75]
    v_mov_b32_dpp v119, v76 quad_perm:[0,0,0,0] row_mask:0xf bank_mask:0xf
    v_add_f32_dpp v119, v77, v119 quad_perm:[1,1,1,1] row_mask:0xf bank_mask:0xf
    v_add_f32_dpp v119, v78, v119 quad_perm:[2,2,2,2] row_mask:0xf bank_mask:0xf
    v_add_f32_dpp v119, v79, v119 quad_perm:[3,3,3,3] row_mask:0xf bank_mask:0xf
    v_cvt_pk_bf16_f32 v119, 0, v119
    v_mul_f32 v119, 0x3db504f3, v119
    v_cvt_pk_bf16_f32 v119, 0, v119
    v_max_f32 v13, v13, v119
    buffer_load_dwordx4 v[204:207], v4, s[8:11], s56 offen offset:2048 nt
    buffer_load_dwordx4 v[212:215], v4, s[8:11], s56 offen offset:3072 nt
    s_add_u32 s56, s51, 344064
    buffer_load_dwordx4 v[220:223], v4, s[8:11], s56 offen offset:0 nt
    buffer_load_dwordx4 a[0:3], v8, s[20:23], s59 offen offset:1024
    buffer_load_dwordx4 a[4:7], v4, s[8:11], s56 offen offset:1024 nt
    s_waitcnt vmcnt(21)
    v_mfma_f32_16x16x32_bf16 v[76:79], a[168:171], v[48:51], 0
    s_waitcnt vmcnt(20)
    v_mfma_f32_16x16x32_bf16 v[76:79], a[176:179], v[52:55], v[76:79]
    s_waitcnt vmcnt(18)
    v_mfma_f32_16x16x32_bf16 v[76:79], a[192:195], v[56:59], v[76:79]
    s_waitcnt vmcnt(17)
    v_mfma_f32_16x16x32_bf16 v[76:79], a[200:203], v[60:63], v[76:79]
    v_mov_b32_dpp v120, v72 quad_perm:[0,0,0,0] row_mask:0xf bank_mask:0xf
    v_add_f32_dpp v120, v73, v120 quad_perm:[1,1,1,1] row_mask:0xf bank_mask:0xf
    v_add_f32_dpp v120, v74, v120 quad_perm:[2,2,2,2] row_mask:0xf bank_mask:0xf
    v_add_f32_dpp v120, v75, v120 quad_perm:[3,3,3,3] row_mask:0xf bank_mask:0xf
    v_cvt_pk_bf16_f32 v120, 0, v120
    v_mul_f32 v120, 0x3db504f3, v120
    v_cvt_pk_bf16_f32 v120, 0, v120
    v_max_f32 v13, v13, v120
    buffer_load_dwordx4 a[12:15], v4, s[8:11], s56 offen offset:2048 nt
    buffer_load_dwordx4 a[20:23], v4, s[8:11], s56 offen offset:3072 nt
    s_add_u32 s56, s51, 360448
    buffer_load_dwordx4 a[28:31], v4, s[8:11], s56 offen offset:0 nt
    buffer_load_dwordx4 a[36:39], v4, s[8:11], s56 offen offset:1024 nt
    buffer_load_dwordx4 a[44:47], v8, s[20:23], s59 offen offset:1280
    s_waitcnt vmcnt(21)
    v_mfma_f32_16x16x32_bf16 v[72:75], a[208:211], v[48:51], 0
    s_waitcnt vmcnt(20)
    v_mfma_f32_16x16x32_bf16 v[72:75], a[216:219], v[52:55], v[72:75]
    s_waitcnt vmcnt(19)
    v_mfma_f32_16x16x32_bf16 v[72:75], a[224:227], v[56:59], v[72:75]
    s_waitcnt vmcnt(17)
    v_mfma_f32_16x16x32_bf16 v[72:75], a[240:243], v[60:63], v[72:75]
    v_mov_b32_dpp v121, v76 quad_perm:[0,0,0,0] row_mask:0xf bank_mask:0xf
    v_add_f32_dpp v121, v77, v121 quad_perm:[1,1,1,1] row_mask:0xf bank_mask:0xf
    v_add_f32_dpp v121, v78, v121 quad_perm:[2,2,2,2] row_mask:0xf bank_mask:0xf
    v_add_f32_dpp v121, v79, v121 quad_perm:[3,3,3,3] row_mask:0xf bank_mask:0xf
    v_cvt_pk_bf16_f32 v121, 0, v121
    v_mul_f32 v121, 0x3db504f3, v121
    v_cvt_pk_bf16_f32 v121, 0, v121
    v_max_f32 v13, v13, v121
    buffer_load_dwordx4 a[52:55], v4, s[8:11], s56 offen offset:2048 nt
    buffer_load_dwordx4 a[60:63], v4, s[8:11], s56 offen offset:3072 nt
    s_add_u32 s56, s51, 376832
    buffer_load_dwordx4 a[68:71], v4, s[8:11], s56 offen offset:0 nt
    buffer_load_dwordx4 a[76:79], v4, s[8:11], s56 offen offset:1024 nt
    s_waitcnt vmcnt(20)
    v_mfma_f32_16x16x32_bf16 v[76:79], a[248:251], v[48:51], 0
    s_waitcnt vmcnt(19)
    v_mfma_f32_16x16x32_bf16 v[76:79], v[156:159], v[52:55], v[76:79]
    s_waitcnt vmcnt(18)
    v_mfma_f32_16x16x32_bf16 v[76:79], v[164:167], v[56:59], v[76:79]
    s_waitcnt vmcnt(17)
    v_mfma_f32_16x16x32_bf16 v[76:79], v[172:175], v[60:63], v[76:79]
    v_mov_b32_dpp v122, v72 quad_perm:[0,0,0,0] row_mask:0xf bank_mask:0xf
    v_add_f32_dpp v122, v73, v122 quad_perm:[1,1,1,1] row_mask:0xf bank_mask:0xf
    v_add_f32_dpp v122, v74, v122 quad_perm:[2,2,2,2] row_mask:0xf bank_mask:0xf
    v_add_f32_dpp v122, v75, v122 quad_perm:[3,3,3,3] row_mask:0xf bank_mask:0xf
    v_cvt_pk_bf16_f32 v122, 0, v122
    v_mul_f32 v122, 0x3db504f3, v122
    v_cvt_pk_bf16_f32 v122, 0, v122
    v_max_f32 v13, v13, v122
    buffer_load_dwordx4 a[84:87], v4, s[8:11], s56 offen offset:2048 nt
    buffer_load_dwordx4 a[92:95], v8, s[20:23], s59 offen offset:1536
    buffer_load_dwordx4 a[100:103], v4, s[8:11], s56 offen offset:3072 nt
    s_add_u32 s56, s51, 393216
    buffer_load_dwordx4 a[108:111], v4, s[8:11], s56 offen offset:0 nt
    buffer_load_dwordx4 a[116:119], v4, s[8:11], s56 offen offset:1024 nt
    s_waitcnt vmcnt(20)
    v_mfma_f32_16x16x32_bf16 v[72:75], v[188:191], v[48:51], 0
    s_waitcnt vmcnt(19)
    v_mfma_f32_16x16x32_bf16 v[72:75], v[196:199], v[52:55], v[72:75]
    s_waitcnt vmcnt(18)
    v_mfma_f32_16x16x32_bf16 v[72:75], v[204:207], v[56:59], v[72:75]
    s_waitcnt vmcnt(17)
    v_mfma_f32_16x16x32_bf16 v[72:75], v[212:215], v[60:63], v[72:75]
    v_mov_b32_dpp v123, v76 quad_perm:[0,0,0,0] row_mask:0xf bank_mask:0xf
    v_add_f32_dpp v123, v77, v123 quad_perm:[1,1,1,1] row_mask:0xf bank_mask:0xf
    v_add_f32_dpp v123, v78, v123 quad_perm:[2,2,2,2] row_mask:0xf bank_mask:0xf
    v_add_f32_dpp v123, v79, v123 quad_perm:[3,3,3,3] row_mask:0xf bank_mask:0xf
    v_cvt_pk_bf16_f32 v123, 0, v123
    v_mul_f32 v123, 0x3db504f3, v123
    v_cvt_pk_bf16_f32 v123, 0, v123
    v_max_f32 v13, v13, v123
    buffer_load_dwordx4 a[124:127], v4, s[8:11], s56 offen offset:2048 nt
    buffer_load_dwordx4 a[132:135], v4, s[8:11], s56 offen offset:3072 nt
    buffer_load_dwordx4 a[140:143], v8, s[20:23], s59 offen offset:1792
    s_add_u32 s56, s51, 409600
    buffer_load_dwordx4 a[148:151], v4, s[8:11], s56 offen offset:0 nt
    buffer_load_dwordx4 a[156:159], v4, s[8:11], s56 offen offset:1024 nt
    s_waitcnt vmcnt(21)
    v_mfma_f32_16x16x32_bf16 v[76:79], v[220:223], v[48:51], 0
    s_waitcnt vmcnt(19)
    v_mfma_f32_16x16x32_bf16 v[76:79], a[4:7], v[52:55], v[76:79]
    s_waitcnt vmcnt(18)
    v_mfma_f32_16x16x32_bf16 v[76:79], a[12:15], v[56:59], v[76:79]
    s_waitcnt vmcnt(17)
    v_mfma_f32_16x16x32_bf16 v[76:79], a[20:23], v[60:63], v[76:79]
    v_mov_b32_dpp v124, v72 quad_perm:[0,0,0,0] row_mask:0xf bank_mask:0xf
    v_add_f32_dpp v124, v73, v124 quad_perm:[1,1,1,1] row_mask:0xf bank_mask:0xf
    v_add_f32_dpp v124, v74, v124 quad_perm:[2,2,2,2] row_mask:0xf bank_mask:0xf
    v_add_f32_dpp v124, v75, v124 quad_perm:[3,3,3,3] row_mask:0xf bank_mask:0xf
    v_cvt_pk_bf16_f32 v124, 0, v124
    v_mul_f32 v124, 0x3db504f3, v124
    v_cvt_pk_bf16_f32 v124, 0, v124
    v_max_f32 v13, v13, v124
    buffer_load_dwordx4 a[164:167], v4, s[8:11], s56 offen offset:2048 nt
    buffer_load_dwordx4 a[172:175], v4, s[8:11], s56 offen offset:3072 nt
    s_add_u32 s56, s51, 425984
    buffer_load_dwordx4 a[180:183], v4, s[8:11], s56 offen offset:0 nt
    buffer_load_dwordx4 a[188:191], v8, s[20:23], s59 offen offset:2048
    buffer_load_dwordx4 a[196:199], v4, s[8:11], s56 offen offset:1024 nt
    s_waitcnt vmcnt(21)
    v_mfma_f32_16x16x32_bf16 v[72:75], a[28:31], v[48:51], 0
    s_waitcnt vmcnt(20)
    v_mfma_f32_16x16x32_bf16 v[72:75], a[36:39], v[52:55], v[72:75]
    s_waitcnt vmcnt(18)
    v_mfma_f32_16x16x32_bf16 v[72:75], a[52:55], v[56:59], v[72:75]
    s_waitcnt vmcnt(17)
    v_mfma_f32_16x16x32_bf16 v[72:75], a[60:63], v[60:63], v[72:75]
    v_mov_b32_dpp v125, v76 quad_perm:[0,0,0,0] row_mask:0xf bank_mask:0xf
    v_add_f32_dpp v125, v77, v125 quad_perm:[1,1,1,1] row_mask:0xf bank_mask:0xf
    v_add_f32_dpp v125, v78, v125 quad_perm:[2,2,2,2] row_mask:0xf bank_mask:0xf
    v_add_f32_dpp v125, v79, v125 quad_perm:[3,3,3,3] row_mask:0xf bank_mask:0xf
    v_cvt_pk_bf16_f32 v125, 0, v125
    v_mul_f32 v125, 0x3db504f3, v125
    v_cvt_pk_bf16_f32 v125, 0, v125
    v_max_f32 v13, v13, v125
    buffer_load_dwordx4 a[204:207], v4, s[8:11], s56 offen offset:2048 nt
    buffer_load_dwordx4 a[212:215], v4, s[8:11], s56 offen offset:3072 nt
    s_add_u32 s56, s51, 442368
    buffer_load_dwordx4 a[220:223], v4, s[8:11], s56 offen offset:0 nt
    buffer_load_dwordx4 a[228:231], v4, s[8:11], s56 offen offset:1024 nt
    buffer_load_dwordx4 a[236:239], v8, s[20:23], s59 offen offset:2304
    s_waitcnt vmcnt(21)
    v_mfma_f32_16x16x32_bf16 v[76:79], a[68:71], v[48:51], 0
    s_waitcnt vmcnt(20)
    v_mfma_f32_16x16x32_bf16 v[76:79], a[76:79], v[52:55], v[76:79]
    s_waitcnt vmcnt(19)
    v_mfma_f32_16x16x32_bf16 v[76:79], a[84:87], v[56:59], v[76:79]
    s_waitcnt vmcnt(17)
    v_mfma_f32_16x16x32_bf16 v[76:79], a[100:103], v[60:63], v[76:79]
    v_mov_b32_dpp v126, v72 quad_perm:[0,0,0,0] row_mask:0xf bank_mask:0xf
    v_add_f32_dpp v126, v73, v126 quad_perm:[1,1,1,1] row_mask:0xf bank_mask:0xf
    v_add_f32_dpp v126, v74, v126 quad_perm:[2,2,2,2] row_mask:0xf bank_mask:0xf
    v_add_f32_dpp v126, v75, v126 quad_perm:[3,3,3,3] row_mask:0xf bank_mask:0xf
    v_cvt_pk_bf16_f32 v126, 0, v126
    v_mul_f32 v126, 0x3db504f3, v126
    v_cvt_pk_bf16_f32 v126, 0, v126
    v_max_f32 v13, v13, v126
    buffer_load_dwordx4 a[244:247], v4, s[8:11], s56 offen offset:2048 nt
    buffer_load_dwordx4 a[252:255], v4, s[8:11], s56 offen offset:3072 nt
    s_add_u32 s56, s51, 458752
    buffer_load_dwordx4 v[160:163], v4, s[8:11], s56 offen offset:0 nt
    buffer_load_dwordx4 v[168:171], v4, s[8:11], s56 offen offset:1024 nt
    s_waitcnt vmcnt(20)
    v_mfma_f32_16x16x32_bf16 v[72:75], a[108:111], v[48:51], 0
    s_waitcnt vmcnt(19)
    v_mfma_f32_16x16x32_bf16 v[72:75], a[116:119], v[52:55], v[72:75]
    s_waitcnt vmcnt(18)
    v_mfma_f32_16x16x32_bf16 v[72:75], a[124:127], v[56:59], v[72:75]
    s_waitcnt vmcnt(17)
    v_mfma_f32_16x16x32_bf16 v[72:75], a[132:135], v[60:63], v[72:75]
    v_mov_b32_dpp v127, v76 quad_perm:[0,0,0,0] row_mask:0xf bank_mask:0xf
    v_add_f32_dpp v127, v77, v127 quad_perm:[1,1,1,1] row_mask:0xf bank_mask:0xf
    v_add_f32_dpp v127, v78, v127 quad_perm:[2,2,2,2] row_mask:0xf bank_mask:0xf
    v_add_f32_dpp v127, v79, v127 quad_perm:[3,3,3,3] row_mask:0xf bank_mask:0xf
    v_cvt_pk_bf16_f32 v127, 0, v127
    v_mul_f32 v127, 0x3db504f3, v127
    v_cvt_pk_bf16_f32 v127, 0, v127
    v_max_f32 v13, v13, v127
    buffer_load_dwordx4 v[176:179], v4, s[8:11], s56 offen offset:2048 nt
    s_add_u32 s59, s54, 2560
    buffer_load_dwordx4 v[184:187], v8, s[20:23], s59 offen offset:0
    buffer_load_dwordx4 v[192:195], v4, s[8:11], s56 offen offset:3072 nt
    s_add_u32 s56, s51, 475136
    buffer_load_dwordx4 v[200:203], v4, s[8:11], s56 offen offset:0 nt
    buffer_load_dwordx4 v[208:211], v4, s[8:11], s56 offen offset:1024 nt
    s_waitcnt vmcnt(20)
    v_mfma_f32_16x16x32_bf16 v[76:79], a[148:151], v[48:51], 0
    s_waitcnt vmcnt(19)
    v_mfma_f32_16x16x32_bf16 v[76:79], a[156:159], v[52:55], v[76:79]
    s_waitcnt vmcnt(18)
    v_mfma_f32_16x16x32_bf16 v[76:79], a[164:167], v[56:59], v[76:79]
    s_waitcnt vmcnt(17)
    v_mfma_f32_16x16x32_bf16 v[76:79], a[172:175], v[60:63], v[76:79]
    v_mov_b32_dpp v128, v72 quad_perm:[0,0,0,0] row_mask:0xf bank_mask:0xf
    v_add_f32_dpp v128, v73, v128 quad_perm:[1,1,1,1] row_mask:0xf bank_mask:0xf
    v_add_f32_dpp v128, v74, v128 quad_perm:[2,2,2,2] row_mask:0xf bank_mask:0xf
    v_add_f32_dpp v128, v75, v128 quad_perm:[3,3,3,3] row_mask:0xf bank_mask:0xf
    v_cvt_pk_bf16_f32 v128, 0, v128
    v_mul_f32 v128, 0x3db504f3, v128
    v_cvt_pk_bf16_f32 v128, 0, v128
    v_max_f32 v13, v13, v128
    buffer_load_dwordx4 v[216:219], v4, s[8:11], s56 offen offset:2048 nt
    buffer_load_dwordx4 v[224:227], v4, s[8:11], s56 offen offset:3072 nt
    buffer_load_dwordx4 v[228:231], v8, s[20:23], s59 offen offset:256
    s_add_u32 s56, s51, 491520
    buffer_load_dwordx4 v[232:235], v4, s[8:11], s56 offen offset:0 nt
    buffer_load_dwordx4 v[236:239], v4, s[8:11], s56 offen offset:1024 nt
    s_waitcnt vmcnt(21)
    v_mfma_f32_16x16x32_bf16 v[72:75], a[180:183], v[48:51], 0
    s_waitcnt vmcnt(19)
    v_mfma_f32_16x16x32_bf16 v[72:75], a[196:199], v[52:55], v[72:75]
    s_waitcnt vmcnt(18)
    v_mfma_f32_16x16x32_bf16 v[72:75], a[204:207], v[56:59], v[72:75]
    s_waitcnt vmcnt(17)
    v_mfma_f32_16x16x32_bf16 v[72:75], a[212:215], v[60:63], v[72:75]
    v_mov_b32_dpp v129, v76 quad_perm:[0,0,0,0] row_mask:0xf bank_mask:0xf
    v_add_f32_dpp v129, v77, v129 quad_perm:[1,1,1,1] row_mask:0xf bank_mask:0xf
    v_add_f32_dpp v129, v78, v129 quad_perm:[2,2,2,2] row_mask:0xf bank_mask:0xf
    v_add_f32_dpp v129, v79, v129 quad_perm:[3,3,3,3] row_mask:0xf bank_mask:0xf
    v_cvt_pk_bf16_f32 v129, 0, v129
    v_mul_f32 v129, 0x3db504f3, v129
    v_cvt_pk_bf16_f32 v129, 0, v129
    v_max_f32 v13, v13, v129
    buffer_load_dwordx4 v[240:243], v4, s[8:11], s56 offen offset:2048 nt
    buffer_load_dwordx4 v[244:247], v4, s[8:11], s56 offen offset:3072 nt
    s_add_u32 s56, s51, 507904
    buffer_load_dwordx4 v[248:251], v4, s[8:11], s56 offen offset:0 nt
    buffer_load_dwordx4 v[252:255], v8, s[20:23], s59 offen offset:512
    buffer_load_dwordx4 a[8:11], v4, s[8:11], s56 offen offset:1024 nt
    s_waitcnt vmcnt(21)
    v_mfma_f32_16x16x32_bf16 v[76:79], a[220:223], v[48:51], 0
    s_waitcnt vmcnt(20)
    v_mfma_f32_16x16x32_bf16 v[76:79], a[228:231], v[52:55], v[76:79]
    s_waitcnt vmcnt(18)
    v_mfma_f32_16x16x32_bf16 v[76:79], a[244:247], v[56:59], v[76:79]
    s_waitcnt vmcnt(17)
    v_mfma_f32_16x16x32_bf16 v[76:79], a[252:255], v[60:63], v[76:79]
    v_mov_b32_dpp v130, v72 quad_perm:[0,0,0,0] row_mask:0xf bank_mask:0xf
    v_add_f32_dpp v130, v73, v130 quad_perm:[1,1,1,1] row_mask:0xf bank_mask:0xf
    v_add_f32_dpp v130, v74, v130 quad_perm:[2,2,2,2] row_mask:0xf bank_mask:0xf
    v_add_f32_dpp v130, v75, v130 quad_perm:[3,3,3,3] row_mask:0xf bank_mask:0xf
    v_cvt_pk_bf16_f32 v130, 0, v130
    v_mul_f32 v130, 0x3db504f3, v130
    v_cvt_pk_bf16_f32 v130, 0, v130
    v_max_f32 v13, v13, v130
    buffer_load_dwordx4 a[16:19], v4, s[8:11], s56 offen offset:2048 nt
    buffer_load_dwordx4 a[24:27], v4, s[8:11], s56 offen offset:3072 nt
    s_add_u32 s56, s51, 524288
    buffer_load_dwordx4 a[32:35], v4, s[8:11], s56 offen offset:0 nt
    buffer_load_dwordx4 a[40:43], v4, s[8:11], s56 offen offset:1024 nt
    buffer_load_dwordx4 a[48:51], v8, s[20:23], s59 offen offset:768
    s_waitcnt vmcnt(21)
    v_mfma_f32_16x16x32_bf16 v[72:75], v[160:163], v[48:51], 0
    s_waitcnt vmcnt(20)
    v_mfma_f32_16x16x32_bf16 v[72:75], v[168:171], v[52:55], v[72:75]
    s_waitcnt vmcnt(19)
    v_mfma_f32_16x16x32_bf16 v[72:75], v[176:179], v[56:59], v[72:75]
    s_waitcnt vmcnt(17)
    v_mfma_f32_16x16x32_bf16 v[72:75], v[192:195], v[60:63], v[72:75]
    v_mov_b32_dpp v131, v76 quad_perm:[0,0,0,0] row_mask:0xf bank_mask:0xf
    v_add_f32_dpp v131, v77, v131 quad_perm:[1,1,1,1] row_mask:0xf bank_mask:0xf
    v_add_f32_dpp v131, v78, v131 quad_perm:[2,2,2,2] row_mask:0xf bank_mask:0xf
    v_add_f32_dpp v131, v79, v131 quad_perm:[3,3,3,3] row_mask:0xf bank_mask:0xf
    v_cvt_pk_bf16_f32 v131, 0, v131
    v_mul_f32 v131, 0x3db504f3, v131
    v_cvt_pk_bf16_f32 v131, 0, v131
    v_max_f32 v13, v13, v131
    buffer_load_dwordx4 a[56:59], v4, s[8:11], s56 offen offset:2048 nt
    buffer_load_dwordx4 a[64:67], v4, s[8:11], s56 offen offset:3072 nt
    s_add_u32 s56, s51, 540672
    buffer_load_dwordx4 a[72:75], v4, s[8:11], s56 offen offset:0 nt
    buffer_load_dwordx4 a[80:83], v4, s[8:11], s56 offen offset:1024 nt
    s_waitcnt vmcnt(20)
    v_mfma_f32_16x16x32_bf16 v[76:79], v[200:203], v[48:51], 0
    s_waitcnt vmcnt(19)
    v_mfma_f32_16x16x32_bf16 v[76:79], v[208:211], v[52:55], v[76:79]
    s_waitcnt vmcnt(18)
    v_mfma_f32_16x16x32_bf16 v[76:79], v[216:219], v[56:59], v[76:79]
    s_waitcnt vmcnt(17)
    v_mfma_f32_16x16x32_bf16 v[76:79], v[224:227], v[60:63], v[76:79]
    v_mov_b32_dpp v132, v72 quad_perm:[0,0,0,0] row_mask:0xf bank_mask:0xf
    v_add_f32_dpp v132, v73, v132 quad_perm:[1,1,1,1] row_mask:0xf bank_mask:0xf
    v_add_f32_dpp v132, v74, v132 quad_perm:[2,2,2,2] row_mask:0xf bank_mask:0xf
    v_add_f32_dpp v132, v75, v132 quad_perm:[3,3,3,3] row_mask:0xf bank_mask:0xf
    v_cvt_pk_bf16_f32 v132, 0, v132
    v_mul_f32 v132, 0x3db504f3, v132
    v_cvt_pk_bf16_f32 v132, 0, v132
    v_max_f32 v13, v13, v132
    buffer_load_dwordx4 a[88:91], v4, s[8:11], s56 offen offset:2048 nt
    buffer_load_dwordx4 a[96:99], v8, s[20:23], s59 offen offset:1024
    buffer_load_dwordx4 a[104:107], v4, s[8:11], s56 offen offset:3072 nt
    s_add_u32 s56, s51, 557056
    buffer_load_dwordx4 a[112:115], v4, s[8:11], s56 offen offset:0 nt
    buffer_load_dwordx4 a[120:123], v4, s[8:11], s56 offen offset:1024 nt
    s_waitcnt vmcnt(20)
    v_mfma_f32_16x16x32_bf16 v[72:75], v[232:235], v[48:51], 0
    s_waitcnt vmcnt(19)
    v_mfma_f32_16x16x32_bf16 v[72:75], v[236:239], v[52:55], v[72:75]
    s_waitcnt vmcnt(18)
    v_mfma_f32_16x16x32_bf16 v[72:75], v[240:243], v[56:59], v[72:75]
    s_waitcnt vmcnt(17)
    v_mfma_f32_16x16x32_bf16 v[72:75], v[244:247], v[60:63], v[72:75]
    v_mov_b32_dpp v133, v76 quad_perm:[0,0,0,0] row_mask:0xf bank_mask:0xf
    v_add_f32_dpp v133, v77, v133 quad_perm:[1,1,1,1] row_mask:0xf bank_mask:0xf
    v_add_f32_dpp v133, v78, v133 quad_perm:[2,2,2,2] row_mask:0xf bank_mask:0xf
    v_add_f32_dpp v133, v79, v133 quad_perm:[3,3,3,3] row_mask:0xf bank_mask:0xf
    v_cvt_pk_bf16_f32 v133, 0, v133
    v_mul_f32 v133, 0x3db504f3, v133
    v_cvt_pk_bf16_f32 v133, 0, v133
    v_max_f32 v13, v13, v133
    buffer_load_dwordx4 a[136:139], v4, s[8:11], s56 offen offset:2048 nt
    buffer_load_dwordx4 a[144:147], v4, s[8:11], s56 offen offset:3072 nt
    buffer_load_dwordx4 a[152:155], v8, s[20:23], s59 offen offset:1280
    s_add_u32 s56, s51, 573440
    buffer_load_dwordx4 a[160:163], v4, s[8:11], s56 offen offset:0 nt
    buffer_load_dwordx4 a[168:171], v4, s[8:11], s56 offen offset:1024 nt
    s_waitcnt vmcnt(21)
    v_mfma_f32_16x16x32_bf16 v[76:79], v[248:251], v[48:51], 0
    s_waitcnt vmcnt(19)
    v_mfma_f32_16x16x32_bf16 v[76:79], a[8:11], v[52:55], v[76:79]
    s_waitcnt vmcnt(18)
    v_mfma_f32_16x16x32_bf16 v[76:79], a[16:19], v[56:59], v[76:79]
    s_waitcnt vmcnt(17)
    v_mfma_f32_16x16x32_bf16 v[76:79], a[24:27], v[60:63], v[76:79]
    v_mov_b32_dpp v134, v72 quad_perm:[0,0,0,0] row_mask:0xf bank_mask:0xf
    v_add_f32_dpp v134, v73, v134 quad_perm:[1,1,1,1] row_mask:0xf bank_mask:0xf
    v_add_f32_dpp v134, v74, v134 quad_perm:[2,2,2,2] row_mask:0xf bank_mask:0xf
    v_add_f32_dpp v134, v75, v134 quad_perm:[3,3,3,3] row_mask:0xf bank_mask:0xf
    v_cvt_pk_bf16_f32 v134, 0, v134
    v_mul_f32 v134, 0x3db504f3, v134
    v_cvt_pk_bf16_f32 v134, 0, v134
    v_max_f32 v13, v13, v134
    buffer_load_dwordx4 a[176:179], v4, s[8:11], s56 offen offset:2048 nt
    buffer_load_dwordx4 a[192:195], v4, s[8:11], s56 offen offset:3072 nt
    s_add_u32 s56, s51, 0
    buffer_load_dwordx4 a[200:203], v5, s[12:15], s56 offen offset:0 nt
    buffer_load_dwordx4 a[208:211], v8, s[20:23], s59 offen offset:1536
    buffer_load_dwordx4 a[216:219], v5, s[12:15], s56 offen offset:1024 nt
    s_waitcnt vmcnt(21)
    v_mfma_f32_16x16x32_bf16 v[72:75], a[32:35], v[48:51], 0
    s_waitcnt vmcnt(20)
    v_mfma_f32_16x16x32_bf16 v[72:75], a[40:43], v[52:55], v[72:75]
    s_waitcnt vmcnt(18)
    v_mfma_f32_16x16x32_bf16 v[72:75], a[56:59], v[56:59], v[72:75]
    s_waitcnt vmcnt(17)
    v_mfma_f32_16x16x32_bf16 v[72:75], a[64:67], v[60:63], v[72:75]
    v_mov_b32_dpp v135, v76 quad_perm:[0,0,0,0] row_mask:0xf bank_mask:0xf
    v_add_f32_dpp v135, v77, v135 quad_perm:[1,1,1,1] row_mask:0xf bank_mask:0xf
    v_add_f32_dpp v135, v78, v135 quad_perm:[2,2,2,2] row_mask:0xf bank_mask:0xf
    v_add_f32_dpp v135, v79, v135 quad_perm:[3,3,3,3] row_mask:0xf bank_mask:0xf
    v_cvt_pk_bf16_f32 v135, 0, v135
    v_mul_f32 v135, 0x3db504f3, v135
    v_cvt_pk_bf16_f32 v135, 0, v135
    v_max_f32 v13, v13, v135
    buffer_load_dwordx4 a[224:227], v5, s[12:15], s56 offen offset:2048 nt
    buffer_load_dwordx4 a[240:243], v5, s[12:15], s56 offen offset:3072 nt
    s_add_u32 s56, s51, 16384
    buffer_load_dwordx4 a[248:251], v5, s[12:15], s56 offen offset:0 nt
    buffer_load_dwordx4 v[156:159], v5, s[12:15], s56 offen offset:1024 nt
    buffer_load_dwordx4 v[164:167], v8, s[20:23], s59 offen offset:1792
    s_waitcnt vmcnt(21)
    v_mfma_f32_16x16x32_bf16 v[76:79], a[72:75], v[48:51], 0
    s_waitcnt vmcnt(20)
    v_mfma_f32_16x16x32_bf16 v[76:79], a[80:83], v[52:55], v[76:79]
    s_waitcnt vmcnt(19)
    v_mfma_f32_16x16x32_bf16 v[76:79], a[88:91], v[56:59], v[76:79]
    s_waitcnt vmcnt(17)
    v_mfma_f32_16x16x32_bf16 v[76:79], a[104:107], v[60:63], v[76:79]
    v_mov_b32_dpp v136, v72 quad_perm:[0,0,0,0] row_mask:0xf bank_mask:0xf
    v_add_f32_dpp v136, v73, v136 quad_perm:[1,1,1,1] row_mask:0xf bank_mask:0xf
    v_add_f32_dpp v136, v74, v136 quad_perm:[2,2,2,2] row_mask:0xf bank_mask:0xf
    v_add_f32_dpp v136, v75, v136 quad_perm:[3,3,3,3] row_mask:0xf bank_mask:0xf
    v_cvt_pk_bf16_f32 v136, 0, v136
    v_mul_f32 v136, 0x3db504f3, v136
    v_cvt_pk_bf16_f32 v136, 0, v136
    v_max_f32 v13, v13, v136
    buffer_load_dwordx4 v[172:175], v5, s[12:15], s56 offen offset:2048 nt
    buffer_load_dwordx4 v[188:191], v5, s[12:15], s56 offen offset:3072 nt
    s_add_u32 s56, s51, 32768
    buffer_load_dwordx4 v[196:199], v5, s[12:15], s56 offen offset:0 nt
    buffer_load_dwordx4 v[204:207], v5, s[12:15], s56 offen offset:1024 nt
    s_waitcnt vmcnt(20)
    v_mfma_f32_16x16x32_bf16 v[72:75], a[112:115], v[48:51], 0
    s_waitcnt vmcnt(19)
    v_mfma_f32_16x16x32_bf16 v[72:75], a[120:123], v[52:55], v[72:75]
    s_waitcnt vmcnt(18)
    v_mfma_f32_16x16x32_bf16 v[72:75], a[136:139], v[56:59], v[72:75]
    s_waitcnt vmcnt(17)
    v_mfma_f32_16x16x32_bf16 v[72:75], a[144:147], v[60:63], v[72:75]
    v_mov_b32_dpp v137, v76 quad_perm:[0,0,0,0] row_mask:0xf bank_mask:0xf
    v_add_f32_dpp v137, v77, v137 quad_perm:[1,1,1,1] row_mask:0xf bank_mask:0xf
    v_add_f32_dpp v137, v78, v137 quad_perm:[2,2,2,2] row_mask:0xf bank_mask:0xf
    v_add_f32_dpp v137, v79, v137 quad_perm:[3,3,3,3] row_mask:0xf bank_mask:0xf
    v_cvt_pk_bf16_f32 v137, 0, v137
    v_mul_f32 v137, 0x3db504f3, v137
    v_cvt_pk_bf16_f32 v137, 0, v137
    v_max_f32 v13, v13, v137
    buffer_load_dwordx4 v[212:215], v5, s[12:15], s56 offen offset:2048 nt
    buffer_load_dwordx4 v[220:223], v8, s[20:23], s59 offen offset:2048
    buffer_load_dwordx4 a[4:7], v5, s[12:15], s56 offen offset:3072 nt
    s_add_u32 s56, s51, 49152
    buffer_load_dwordx4 a[12:15], v5, s[12:15], s56 offen offset:0 nt
    buffer_load_dwordx4 a[20:23], v5, s[12:15], s56 offen offset:1024 nt
    s_waitcnt vmcnt(20)
    v_mfma_f32_16x16x32_bf16 v[76:79], a[160:163], v[48:51], 0
    s_waitcnt vmcnt(19)
    v_mfma_f32_16x16x32_bf16 v[76:79], a[168:171], v[52:55], v[76:79]
    s_waitcnt vmcnt(18)
    v_mfma_f32_16x16x32_bf16 v[76:79], a[176:179], v[56:59], v[76:79]
    s_waitcnt vmcnt(17)
    v_mfma_f32_16x16x32_bf16 v[76:79], a[192:195], v[60:63], v[76:79]
    v_mov_b32_dpp v138, v72 quad_perm:[0,0,0,0] row_mask:0xf bank_mask:0xf
    v_add_f32_dpp v138, v73, v138 quad_perm:[1,1,1,1] row_mask:0xf bank_mask:0xf
    v_add_f32_dpp v138, v74, v138 quad_perm:[2,2,2,2] row_mask:0xf bank_mask:0xf
    v_add_f32_dpp v138, v75, v138 quad_perm:[3,3,3,3] row_mask:0xf bank_mask:0xf
    v_cvt_pk_bf16_f32 v138, 0, v138
    v_mul_f32 v138, 0x3db504f3, v138
    v_cvt_pk_bf16_f32 v138, 0, v138
    v_max_f32 v13, v13, v138
    v_mov_b32_dpp v139, v76 quad_perm:[0,0,0,0] row_mask:0xf bank_mask:0xf
    v_add_f32_dpp v139, v77, v139 quad_perm:[1,1,1,1] row_mask:0xf bank_mask:0xf
    v_add_f32_dpp v139, v78, v139 quad_perm:[2,2,2,2] row_mask:0xf bank_mask:0xf
    v_add_f32_dpp v139, v79, v139 quad_perm:[3,3,3,3] row_mask:0xf bank_mask:0xf
    v_cvt_pk_bf16_f32 v139, 0, v139
    v_mul_f32 v139, 0x3db504f3, v139
    v_cvt_pk_bf16_f32 v139, 0, v139
    v_max_f32 v13, v13, v139
    buffer_load_dwordx4 a[28:31], v5, s[12:15], s56 offen offset:2048 nt
    s_nop 0
    v_max_f32_dpp v13, v13, v13 row_ror:4 row_mask:0xf bank_mask:0xf
    s_nop 1
    v_max_f32_dpp v13, v13, v13 row_ror:8 row_mask:0xf bank_mask:0xf
    s_lshl_b32 s3, s46, 4
    v_lshl_add_u32 v20, v2, 2, s3
    ds_write_b32 v20, v13 offset:8192
    v_lshlrev_b32 v12, 2, v3
    s_waitcnt lgkmcnt(0)
    s_barrier
    ds_read_b32 v13, v12 offset:8192
    s_waitcnt lgkmcnt(0)
    v_max_f32_dpp v13, v13, v13 quad_perm:[1,0,3,2] row_mask:0xf bank_mask:0xf
    s_nop 1
    v_max_f32_dpp v13, v13, v13 quad_perm:[2,3,0,1] row_mask:0xf bank_mask:0xf
    s_nop 1
    v_max_f32_dpp v13, v13, v13 row_half_mirror row_mask:0xf bank_mask:0xf
    s_nop 1
    v_max_f32_dpp v13, v13, v13 row_mirror row_mask:0xf bank_mask:0xf
    v_mul_f32 v14, s60, v13
    v_fma_f32 v104, v104, s60, -v14
    v_exp_f32 v104, v104
    s_nop 0
    v_add_f32 v15, v15, v104
    v_cvt_pk_bf16_f32 v104, v104, v104
    v_fma_f32 v105, v105, s60, -v14
    v_exp_f32 v105, v105
    s_nop 0
    v_add_f32 v15, v15, v105
    v_cvt_pk_bf16_f32 v105, v105, v105
    buffer_load_dwordx4 a[36:39], v5, s[12:15], s56 offen offset:3072 nt
    v_and_b32_dpp v44, v104, v28 row_newbcast:0 row_mask:0xf bank_mask:0xf
    v_and_b32_dpp v45, v104, v29 row_newbcast:0 row_mask:0xf bank_mask:0xf
    v_and_b32_dpp v46, v104, v30 row_newbcast:0 row_mask:0xf bank_mask:0xf
    v_and_b32_dpp v47, v104, v31 row_newbcast:0 row_mask:0xf bank_mask:0xf
    s_waitcnt vmcnt(18)
    s_nop 0
    v_mfma_f32_16x16x32_bf16 v[80:83], v[44:47], a[200:203], 0
    buffer_load_dwordx4 a[52:55], v8, s[20:23], s59 offen offset:2304
    v_and_b32_dpp v40, v104, v28 row_newbcast:4 row_mask:0xf bank_mask:0xf
    v_and_b32_dpp v41, v104, v29 row_newbcast:4 row_mask:0xf bank_mask:0xf
    v_and_b32_dpp v42, v104, v30 row_newbcast:4 row_mask:0xf bank_mask:0xf
    v_and_b32_dpp v43, v104, v31 row_newbcast:4 row_mask:0xf bank_mask:0xf
    s_waitcnt vmcnt(17)
    s_nop 0
    v_mfma_f32_16x16x32_bf16 v[80:83], v[40:43], a[216:219], v[80:83]
    s_add_u32 s56, s51, 65536
    buffer_load_dwordx4 a[60:63], v5, s[12:15], s56 offen offset:0 nt
    v_and_b32_dpp v44, v104, v28 row_newbcast:8 row_mask:0xf bank_mask:0xf
    v_and_b32_dpp v45, v104, v29 row_newbcast:8 row_mask:0xf bank_mask:0xf
    v_and_b32_dpp v46, v104, v30 row_newbcast:8 row_mask:0xf bank_mask:0xf
    v_and_b32_dpp v47, v104, v31 row_newbcast:8 row_mask:0xf bank_mask:0xf
    s_waitcnt vmcnt(17)
    s_nop 0
    v_mfma_f32_16x16x32_bf16 v[80:83], v[44:47], a[224:227], v[80:83]
    buffer_load_dwordx4 a[68:71], v5, s[12:15], s56 offen offset:1024 nt
    v_and_b32_dpp v40, v104, v28 row_newbcast:12 row_mask:0xf bank_mask:0xf
    v_and_b32_dpp v41, v104, v29 row_newbcast:12 row_mask:0xf bank_mask:0xf
    v_and_b32_dpp v42, v104, v30 row_newbcast:12 row_mask:0xf bank_mask:0xf
    v_and_b32_dpp v43, v104, v31 row_newbcast:12 row_mask:0xf bank_mask:0xf
    s_waitcnt vmcnt(17)
    s_nop 0
    v_mfma_f32_16x16x32_bf16 v[80:83], v[40:43], a[240:243], v[80:83]
    buffer_load_dwordx4 a[76:79], v5, s[12:15], s56 offen offset:2048 nt
    v_fma_f32 v106, v106, s60, -v14
    v_exp_f32 v106, v106
    s_nop 0
    v_add_f32 v15, v15, v106
    v_cvt_pk_bf16_f32 v106, v106, v106
    v_fma_f32 v107, v107, s60, -v14
    v_exp_f32 v107, v107
    s_nop 0
    v_add_f32 v15, v15, v107
    v_cvt_pk_bf16_f32 v107, v107, v107
    v_and_b32_dpp v44, v105, v28 row_newbcast:0 row_mask:0xf bank_mask:0xf
    v_and_b32_dpp v45, v105, v29 row_newbcast:0 row_mask:0xf bank_mask:0xf
    v_and_b32_dpp v46, v105, v30 row_newbcast:0 row_mask:0xf bank_mask:0xf
    v_and_b32_dpp v47, v105, v31 row_newbcast:0 row_mask:0xf bank_mask:0xf
    s_waitcnt vmcnt(17)
    s_nop 0
    v_mfma_f32_16x16x32_bf16 v[80:83], v[44:47], a[248:251], v[80:83]
    buffer_load_dwordx4 a[84:87], v5, s[12:15], s56 offen offset:3072 nt
    v_and_b32_dpp v40, v105, v28 row_newbcast:4 row_mask:0xf bank_mask:0xf
    v_and_b32_dpp v41, v105, v29 row_newbcast:4 row_mask:0xf bank_mask:0xf
    v_and_b32_dpp v42, v105, v30 row_newbcast:4 row_mask:0xf bank_mask:0xf
    v_and_b32_dpp v43, v105, v31 row_newbcast:4 row_mask:0xf bank_mask:0xf
    s_waitcnt vmcnt(17)
    s_nop 0
    v_mfma_f32_16x16x32_bf16 v[80:83], v[40:43], v[156:159], v[80:83]
    s_add_u32 s56, s51, 81920
    buffer_load_dwordx4 a[100:103], v5, s[12:15], s56 offen offset:0 nt
    s_add_u32 s59, s54, 5120
    buffer_load_dwordx4 a[108:111], v8, s[20:23], s59 offen offset:0
    v_and_b32_dpp v44, v105, v28 row_newbcast:8 row_mask:0xf bank_mask:0xf
    v_and_b32_dpp v45, v105, v29 row_newbcast:8 row_mask:0xf bank_mask:0xf
    v_and_b32_dpp v46, v105, v30 row_newbcast:8 row_mask:0xf bank_mask:0xf
    v_and_b32_dpp v47, v105, v31 row_newbcast:8 row_mask:0xf bank_mask:0xf
    s_waitcnt vmcnt(17)
    s_nop 0
    v_mfma_f32_16x16x32_bf16 v[80:83], v[44:47], v[172:175], v[80:83]
    buffer_load_dwordx4 a[116:119], v5, s[12:15], s56 offen offset:1024 nt
    v_and_b32_dpp v40, v105, v28 row_newbcast:12 row_mask:0xf bank_mask:0xf
    v_and_b32_dpp v41, v105, v29 row_newbcast:12 row_mask:0xf bank_mask:0xf
    v_and_b32_dpp v42, v105, v30 row_newbcast:12 row_mask:0xf bank_mask:0xf
    v_and_b32_dpp v43, v105, v31 row_newbcast:12 row_mask:0xf bank_mask:0xf
    s_waitcnt vmcnt(17)
    s_nop 0
    v_mfma_f32_16x16x32_bf16 v[80:83], v[40:43], v[188:191], v[80:83]
    buffer_load_dwordx4 a[124:127], v5, s[12:15], s56 offen offset:2048 nt
    v_fma_f32 v108, v108, s60, -v14
    v_exp_f32 v108, v108
    s_nop 0
    v_add_f32 v15, v15, v108
    v_cvt_pk_bf16_f32 v108, v108, v108
    v_fma_f32 v109, v109, s60, -v14
    v_exp_f32 v109, v109
    s_nop 0
    v_add_f32 v15, v15, v109
    v_cvt_pk_bf16_f32 v109, v109, v109
    v_and_b32_dpp v44, v106, v28 row_newbcast:0 row_mask:0xf bank_mask:0xf
    v_and_b32_dpp v45, v106, v29 row_newbcast:0 row_mask:0xf bank_mask:0xf
    v_and_b32_dpp v46, v106, v30 row_newbcast:0 row_mask:0xf bank_mask:0xf
    v_and_b32_dpp v47, v106, v31 row_newbcast:0 row_mask:0xf bank_mask:0xf
    s_waitcnt vmcnt(17)
    s_nop 0
    v_mfma_f32_16x16x32_bf16 v[80:83], v[44:47], v[196:199], v[80:83]
    buffer_load_dwordx4 a[132:135], v5, s[12:15], s56 offen offset:3072 nt
    v_and_b32_dpp v40, v106, v28 row_newbcast:4 row_mask:0xf bank_mask:0xf
    v_and_b32_dpp v41, v106, v29 row_newbcast:4 row_mask:0xf bank_mask:0xf
    v_and_b32_dpp v42, v106, v30 row_newbcast:4 row_mask:0xf bank_mask:0xf
    v_and_b32_dpp v43, v106, v31 row_newbcast:4 row_mask:0xf bank_mask:0xf
    s_waitcnt vmcnt(17)
    s_nop 0
    v_mfma_f32_16x16x32_bf16 v[80:83], v[40:43], v[204:207], v[80:83]
    s_add_u32 s56, s51, 98304
    buffer_load_dwordx4 a[148:151], v5, s[12:15], s56 offen offset:0 nt
    v_and_b32_dpp v44, v106, v28 row_newbcast:8 row_mask:0xf bank_mask:0xf
    v_and_b32_dpp v45, v106, v29 row_newbcast:8 row_mask:0xf bank_mask:0xf
    v_and_b32_dpp v46, v106, v30 row_newbcast:8 row_mask:0xf bank_mask:0xf
    v_and_b32_dpp v47, v106, v31 row_newbcast:8 row_mask:0xf bank_mask:0xf
    s_waitcnt vmcnt(17)
    s_nop 0
    v_mfma_f32_16x16x32_bf16 v[80:83], v[44:47], v[212:215], v[80:83]
    buffer_load_dwordx4 a[156:159], v5, s[12:15], s56 offen offset:1024 nt
    buffer_load_dwordx4 a[164:167], v5, s[12:15], s56 offen offset:2048 nt
    v_and_b32_dpp v40, v106, v28 row_newbcast:12 row_mask:0xf bank_mask:0xf
    v_and_b32_dpp v41, v106, v29 row_newbcast:12 row_mask:0xf bank_mask:0xf
    v_and_b32_dpp v42, v106, v30 row_newbcast:12 row_mask:0xf bank_mask:0xf
    v_and_b32_dpp v43, v106, v31 row_newbcast:12 row_mask:0xf bank_mask:0xf
    s_waitcnt vmcnt(17)
    s_nop 0
    v_mfma_f32_16x16x32_bf16 v[80:83], v[40:43], a[4:7], v[80:83]
    buffer_load_dwordx4 a[172:175], v8, s[20:23], s59 offen offset:256
    v_fma_f32 v110, v110, s60, -v14
    v_exp_f32 v110, v110
    s_nop 0
    v_add_f32 v15, v15, v110
    v_cvt_pk_bf16_f32 v110, v110, v110
    v_fma_f32 v111, v111, s60, -v14
    v_exp_f32 v111, v111
    s_nop 0
    v_add_f32 v15, v15, v111
    v_cvt_pk_bf16_f32 v111, v111, v111
    v_and_b32_dpp v44, v107, v28 row_newbcast:0 row_mask:0xf bank_mask:0xf
    v_and_b32_dpp v45, v107, v29 row_newbcast:0 row_mask:0xf bank_mask:0xf
    v_and_b32_dpp v46, v107, v30 row_newbcast:0 row_mask:0xf bank_mask:0xf
    v_and_b32_dpp v47, v107, v31 row_newbcast:0 row_mask:0xf bank_mask:0xf
    s_waitcnt vmcnt(17)
    s_nop 0
    v_mfma_f32_16x16x32_bf16 v[80:83], v[44:47], a[12:15], v[80:83]
    buffer_load_dwordx4 a[180:183], v5, s[12:15], s56 offen offset:3072 nt
    v_and_b32_dpp v40, v107, v28 row_newbcast:4 row_mask:0xf bank_mask:0xf
    v_and_b32_dpp v41, v107, v29 row_newbcast:4 row_mask:0xf bank_mask:0xf
    v_and_b32_dpp v42, v107, v30 row_newbcast:4 row_mask:0xf bank_mask:0xf
    v_and_b32_dpp v43, v107, v31 row_newbcast:4 row_mask:0xf bank_mask:0xf
    s_waitcnt vmcnt(17)
    s_nop 0
    v_mfma_f32_16x16x32_bf16 v[80:83], v[40:43], a[20:23], v[80:83]
    s_add_u32 s56, s51, 114688
    buffer_load_dwordx4 a[196:199], v5, s[12:15], s56 offen offset:0 nt
    v_and_b32_dpp v44, v107, v28 row_newbcast:8 row_mask:0xf bank_mask:0xf
    v_and_b32_dpp v45, v107, v29 row_newbcast:8 row_mask:0xf bank_mask:0xf
    v_and_b32_dpp v46, v107, v30 row_newbcast:8 row_mask:0xf bank_mask:0xf
    v_and_b32_dpp v47, v107, v31 row_newbcast:8 row_mask:0xf bank_mask:0xf
    s_waitcnt vmcnt(17)
    s_nop 0
    v_mfma_f32_16x16x32_bf16 v[80:83], v[44:47], a[28:31], v[80:83]
    buffer_load_dwordx4 a[204:207], v5, s[12:15], s56 offen offset:1024 nt
    v_and_b32_dpp v40, v107, v28 row_newbcast:12 row_mask:0xf bank_mask:0xf
    v_and_b32_dpp v41, v107, v29 row_newbcast:12 row_mask:0xf bank_mask:0xf
    v_and_b32_dpp v42, v107, v30 row_newbcast:12 row_mask:0xf bank_mask:0xf
    v_and_b32_dpp v43, v107, v31 row_newbcast:12 row_mask:0xf bank_mask:0xf
    s_waitcnt vmcnt(17)
    s_nop 0
    v_mfma_f32_16x16x32_bf16 v[80:83], v[40:43], a[36:39], v[80:83]
    buffer_load_dwordx4 a[212:215], v5, s[12:15], s56 offen offset:2048 nt
    buffer_load_dwordx4 a[220:223], v5, s[12:15], s56 offen offset:3072 nt
    v_fma_f32 v112, v112, s60, -v14
    v_exp_f32 v112, v112
    s_nop 0
    v_add_f32 v15, v15, v112
    v_cvt_pk_bf16_f32 v112, v112, v112
    v_fma_f32 v113, v113, s60, -v14
    v_exp_f32 v113, v113
    s_nop 0
    v_add_f32 v15, v15, v113
    v_cvt_pk_bf16_f32 v113, v113, v113
    v_and_b32_dpp v44, v108, v28 row_newbcast:0 row_mask:0xf bank_mask:0xf
    v_and_b32_dpp v45, v108, v29 row_newbcast:0 row_mask:0xf bank_mask:0xf
    v_and_b32_dpp v46, v108, v30 row_newbcast:0 row_mask:0xf bank_mask:0xf
    v_and_b32_dpp v47, v108, v31 row_newbcast:0 row_mask:0xf bank_mask:0xf
    s_waitcnt vmcnt(17)
    s_nop 0
    v_mfma_f32_16x16x32_bf16 v[80:83], v[44:47], a[60:63], v[80:83]
    buffer_load_dwordx4 a[228:231], v8, s[20:23], s59 offen offset:512
    v_and_b32_dpp v40, v108, v28 row_newbcast:4 row_mask:0xf bank_mask:0xf
    v_and_b32_dpp v41, v108, v29 row_newbcast:4 row_mask:0xf bank_mask:0xf
    v_and_b32_dpp v42, v108, v30 row_newbcast:4 row_mask:0xf bank_mask:0xf
    v_and_b32_dpp v43, v108, v31 row_newbcast:4 row_mask:0xf bank_mask:0xf
    s_waitcnt vmcnt(17)
    s_nop 0
    v_mfma_f32_16x16x32_bf16 v[80:83], v[40:43], a[68:71], v[80:83]
    s_add_u32 s56, s51, 131072
    buffer_load_dwordx4 a[244:247], v5, s[12:15], s56 offen offset:0 nt
    v_and_b32_dpp v44, v108, v28 row_newbcast:8 row_mask:0xf bank_mask:0xf
    v_and_b32_dpp v45, v108, v29 row_newbcast:8 row_mask:0xf bank_mask:0xf
    v_and_b32_dpp v46, v108, v30 row_newbcast:8 row_mask:0xf bank_mask:0xf
    v_and_b32_dpp v47, v108, v31 row_newbcast:8 row_mask:0xf bank_mask:0xf
    s_waitcnt vmcnt(17)
    s_nop 0
    v_mfma_f32_16x16x32_bf16 v[80:83], v[44:47], a[76:79], v[80:83]
    buffer_load_dwordx4 a[252:255], v5, s[12:15], s56 offen offset:1024 nt
    v_and_b32_dpp v40, v108, v28 row_newbcast:12 row_mask:0xf bank_mask:0xf
    v_and_b32_dpp v41, v108, v29 row_newbcast:12 row_mask:0xf bank_mask:0xf
    v_and_b32_dpp v42, v108, v30 row_newbcast:12 row_mask:0xf bank_mask:0xf
    v_and_b32_dpp v43, v108, v31 row_newbcast:12 row_mask:0xf bank_mask:0xf
    s_waitcnt vmcnt(17)
    s_nop 0
    v_mfma_f32_16x16x32_bf16 v[80:83], v[40:43], a[84:87], v[80:83]
    buffer_load_dwordx4 v[160:163], v5, s[12:15], s56 offen offset:2048 nt
    v_fma_f32 v114, v114, s60, -v14
    v_exp_f32 v114, v114
    s_nop 0
    v_add_f32 v15, v15, v114
    v_cvt_pk_bf16_f32 v114, v114, v114
    v_fma_f32 v115, v115, s60, -v14
    v_exp_f32 v115, v115
    s_nop 0
    v_add_f32 v15, v15, v115
    v_cvt_pk_bf16_f32 v115, v115, v115
    v_and_b32_dpp v44, v109, v28 row_newbcast:0 row_mask:0xf bank_mask:0xf
    v_and_b32_dpp v45, v109, v29 row_newbcast:0 row_mask:0xf bank_mask:0xf
    v_and_b32_dpp v46, v109, v30 row_newbcast:0 row_mask:0xf bank_mask:0xf
    v_and_b32_dpp v47, v109, v31 row_newbcast:0 row_mask:0xf bank_mask:0xf
    s_waitcnt vmcnt(17)
    s_nop 0
    v_mfma_f32_16x16x32_bf16 v[80:83], v[44:47], a[100:103], v[80:83]
    buffer_load_dwordx4 v[168:171], v5, s[12:15], s56 offen offset:3072 nt
    s_add_u32 s56, s51, 147456
    buffer_load_dwordx4 v[176:179], v5, s[12:15], s56 offen offset:0 nt
    v_and_b32_dpp v40, v109, v28 row_newbcast:4 row_mask:0xf bank_mask:0xf
    v_and_b32_dpp v41, v109, v29 row_newbcast:4 row_mask:0xf bank_mask:0xf
    v_and_b32_dpp v42, v109, v30 row_newbcast:4 row_mask:0xf bank_mask:0xf
    v_and_b32_dpp v43, v109, v31 row_newbcast:4 row_mask:0xf bank_mask:0xf
    s_waitcnt vmcnt(17)
    s_nop 0
    v_mfma_f32_16x16x32_bf16 v[80:83], v[40:43], a[116:119], v[80:83]
    buffer_load_dwordx4 v[192:195], v8, s[20:23], s59 offen offset:768
    v_and_b32_dpp v44, v109, v28 row_newbcast:8 row_mask:0xf bank_mask:0xf
    v_and_b32_dpp v45, v109, v29 row_newbcast:8 row_mask:0xf bank_mask:0xf
    v_and_b32_dpp v46, v109, v30 row_newbcast:8 row_mask:0xf bank_mask:0xf
    v_and_b32_dpp v47, v109, v31 row_newbcast:8 row_mask:0xf bank_mask:0xf
    s_waitcnt vmcnt(17)
    s_nop 0
    v_mfma_f32_16x16x32_bf16 v[80:83], v[44:47], a[124:127], v[80:83]
    buffer_load_dwordx4 v[200:203], v5, s[12:15], s56 offen offset:1024 nt
    v_and_b32_dpp v40, v109, v28 row_newbcast:12 row_mask:0xf bank_mask:0xf
    v_and_b32_dpp v41, v109, v29 row_newbcast:12 row_mask:0xf bank_mask:0xf
    v_and_b32_dpp v42, v109, v30 row_newbcast:12 row_mask:0xf bank_mask:0xf
    v_and_b32_dpp v43, v109, v31 row_newbcast:12 row_mask:0xf bank_mask:0xf
    s_waitcnt vmcnt(17)
    s_nop 0
    v_mfma_f32_16x16x32_bf16 v[80:83], v[40:43], a[132:135], v[80:83]
    buffer_load_dwordx4 v[208:211], v5, s[12:15], s56 offen offset:2048 nt
    v_fma_f32 v116, v116, s60, -v14
    v_exp_f32 v116, v116
    s_nop 0
    v_add_f32 v15, v15, v116
    v_cvt_pk_bf16_f32 v116, v116, v116
    v_fma_f32 v117, v117, s60, -v14
    v_exp_f32 v117, v117
    s_nop 0
    v_add_f32 v15, v15, v117
    v_cvt_pk_bf16_f32 v117, v117, v117
    v_and_b32_dpp v44, v110, v28 row_newbcast:0 row_mask:0xf bank_mask:0xf
    v_and_b32_dpp v45, v110, v29 row_newbcast:0 row_mask:0xf bank_mask:0xf
    v_and_b32_dpp v46, v110, v30 row_newbcast:0 row_mask:0xf bank_mask:0xf
    v_and_b32_dpp v47, v110, v31 row_newbcast:0 row_mask:0xf bank_mask:0xf
    s_waitcnt vmcnt(17)
    s_nop 0
    v_mfma_f32_16x16x32_bf16 v[80:83], v[44:47], a[148:151], v[80:83]
    buffer_load_dwordx4 v[216:219], v5, s[12:15], s56 offen offset:3072 nt
    v_and_b32_dpp v40, v110, v28 row_newbcast:4 row_mask:0xf bank_mask:0xf
    v_and_b32_dpp v41, v110, v29 row_newbcast:4 row_mask:0xf bank_mask:0xf
    v_and_b32_dpp v42, v110, v30 row_newbcast:4 row_mask:0xf bank_mask:0xf
    v_and_b32_dpp v43, v110, v31 row_newbcast:4 row_mask:0xf bank_mask:0xf
    s_waitcnt vmcnt(17)
    s_nop 0
    v_mfma_f32_16x16x32_bf16 v[80:83], v[40:43], a[156:159], v[80:83]
    s_add_u32 s56, s51, 163840
    buffer_load_dwordx4 v[224:227], v5, s[12:15], s56 offen offset:0 nt
    v_and_b32_dpp v44, v110, v28 row_newbcast:8 row_mask:0xf bank_mask:0xf
    v_and_b32_dpp v45, v110, v29 row_newbcast:8 row_mask:0xf bank_mask:0xf
    v_and_b32_dpp v46, v110, v30 row_newbcast:8 row_mask:0xf bank_mask:0xf
    v_and_b32_dpp v47, v110, v31 row_newbcast:8 row_mask:0xf bank_mask:0xf
    s_waitcnt vmcnt(17)
    s_nop 0
    v_mfma_f32_16x16x32_bf16 v[80:83], v[44:47], a[164:167], v[80:83]
    buffer_load_dwordx4 v[232:235], v5, s[12:15], s56 offen offset:1024 nt
    buffer_load_dwordx4 v[236:239], v8, s[20:23], s59 offen offset:1024
    v_and_b32_dpp v40, v110, v28 row_newbcast:12 row_mask:0xf bank_mask:0xf
    v_and_b32_dpp v41, v110, v29 row_newbcast:12 row_mask:0xf bank_mask:0xf
    v_and_b32_dpp v42, v110, v30 row_newbcast:12 row_mask:0xf bank_mask:0xf
    v_and_b32_dpp v43, v110, v31 row_newbcast:12 row_mask:0xf bank_mask:0xf
    s_waitcnt vmcnt(17)
    s_nop 0
    v_mfma_f32_16x16x32_bf16 v[80:83], v[40:43], a[180:183], v[80:83]
    buffer_load_dwordx4 v[240:243], v5, s[12:15], s56 offen offset:2048 nt
    v_fma_f32 v118, v118, s60, -v14
    v_exp_f32 v118, v118
    s_nop 0
    v_add_f32 v15, v15, v118
    v_cvt_pk_bf16_f32 v118, v118, v118
    v_fma_f32 v119, v119, s60, -v14
    v_exp_f32 v119, v119
    s_nop 0
    v_add_f32 v15, v15, v119
    v_cvt_pk_bf16_f32 v119, v119, v119
    v_and_b32_dpp v44, v111, v28 row_newbcast:0 row_mask:0xf bank_mask:0xf
    v_and_b32_dpp v45, v111, v29 row_newbcast:0 row_mask:0xf bank_mask:0xf
    v_and_b32_dpp v46, v111, v30 row_newbcast:0 row_mask:0xf bank_mask:0xf
    v_and_b32_dpp v47, v111, v31 row_newbcast:0 row_mask:0xf bank_mask:0xf
    s_waitcnt vmcnt(17)
    s_nop 0
    v_mfma_f32_16x16x32_bf16 v[80:83], v[44:47], a[196:199], v[80:83]
    buffer_load_dwordx4 v[244:247], v5, s[12:15], s56 offen offset:3072 nt
    v_and_b32_dpp v40, v111, v28 row_newbcast:4 row_mask:0xf bank_mask:0xf
    v_and_b32_dpp v41, v111, v29 row_newbcast:4 row_mask:0xf bank_mask:0xf
    v_and_b32_dpp v42, v111, v30 row_newbcast:4 row_mask:0xf bank_mask:0xf
    v_and_b32_dpp v43, v111, v31 row_newbcast:4 row_mask:0xf bank_mask:0xf
    s_waitcnt vmcnt(17)
    s_nop 0
    v_mfma_f32_16x16x32_bf16 v[80:83], v[40:43], a[204:207], v[80:83]
    s_add_u32 s56, s51, 180224
    buffer_load_dwordx4 v[248:251], v5, s[12:15], s56 offen offset:0 nt
    v_and_b32_dpp v44, v111, v28 row_newbcast:8 row_mask:0xf bank_mask:0xf
    v_and_b32_dpp v45, v111, v29 row_newbcast:8 row_mask:0xf bank_mask:0xf
    v_and_b32_dpp v46, v111, v30 row_newbcast:8 row_mask:0xf bank_mask:0xf
    v_and_b32_dpp v47, v111, v31 row_newbcast:8 row_mask:0xf bank_mask:0xf
    s_waitcnt vmcnt(17)
    s_nop 0
    v_mfma_f32_16x16x32_bf16 v[80:83], v[44:47], a[212:215], v[80:83]
    buffer_load_dwordx4 a[8:11], v5, s[12:15], s56 offen offset:1024 nt
    v_and_b32_dpp v40, v111, v28 row_newbcast:12 row_mask:0xf bank_mask:0xf
    v_and_b32_dpp v41, v111, v29 row_newbcast:12 row_mask:0xf bank_mask:0xf
    v_and_b32_dpp v42, v111, v30 row_newbcast:12 row_mask:0xf bank_mask:0xf
    v_and_b32_dpp v43, v111, v31 row_newbcast:12 row_mask:0xf bank_mask:0xf
    s_waitcnt vmcnt(17)
    s_nop 0
    v_mfma_f32_16x16x32_bf16 v[80:83], v[40:43], a[220:223], v[80:83]
    buffer_load_dwordx4 a[16:19], v5, s[12:15], s56 offen offset:2048 nt
    buffer_load_dwordx4 a[24:27], v8, s[20:23], s59 offen offset:1280
    v_fma_f32 v120, v120, s60, -v14
    v_exp_f32 v120, v120
    s_nop 0
    v_add_f32 v15, v15, v120
    v_cvt_pk_bf16_f32 v120, v120, v120
    v_fma_f32 v121, v121, s60, -v14
    v_exp_f32 v121, v121
    s_nop 0
    v_add_f32 v15, v15, v121
    v_cvt_pk_bf16_f32 v121, v121, v121
    v_and_b32_dpp v44, v112, v28 row_newbcast:0 row_mask:0xf bank_mask:0xf
    v_and_b32_dpp v45, v112, v29 row_newbcast:0 row_mask:0xf bank_mask:0xf
    v_and_b32_dpp v46, v112, v30 row_newbcast:0 row_mask:0xf bank_mask:0xf
    v_and_b32_dpp v47, v112, v31 row_newbcast:0 row_mask:0xf bank_mask:0xf
    s_waitcnt vmcnt(17)
    s_nop 0
    v_mfma_f32_16x16x32_bf16 v[80:83], v[44:47], a[244:247], v[80:83]
    buffer_load_dwordx4 a[32:35], v5, s[12:15], s56 offen offset:3072 nt
    v_and_b32_dpp v40, v112, v28 row_newbcast:4 row_mask:0xf bank_mask:0xf
    v_and_b32_dpp v41, v112, v29 row_newbcast:4 row_mask:0xf bank_mask:0xf
    v_and_b32_dpp v42, v112, v30 row_newbcast:4 row_mask:0xf bank_mask:0xf
    v_and_b32_dpp v43, v112, v31 row_newbcast:4 row_mask:0xf bank_mask:0xf
    s_waitcnt vmcnt(17)
    s_nop 0
    v_mfma_f32_16x16x32_bf16 v[80:83], v[40:43], a[252:255], v[80:83]
    s_add_u32 s56, s51, 196608
    buffer_load_dwordx4 a[40:43], v5, s[12:15], s56 offen offset:0 nt
    v_and_b32_dpp v44, v112, v28 row_newbcast:8 row_mask:0xf bank_mask:0xf
    v_and_b32_dpp v45, v112, v29 row_newbcast:8 row_mask:0xf bank_mask:0xf
    v_and_b32_dpp v46, v112, v30 row_newbcast:8 row_mask:0xf bank_mask:0xf
    v_and_b32_dpp v47, v112, v31 row_newbcast:8 row_mask:0xf bank_mask:0xf
    s_waitcnt vmcnt(17)
    s_nop 0
    v_mfma_f32_16x16x32_bf16 v[80:83], v[44:47], v[160:163], v[80:83]
    buffer_load_dwordx4 a[56:59], v5, s[12:15], s56 offen offset:1024 nt
    v_and_b32_dpp v40, v112, v28 row_newbcast:12 row_mask:0xf bank_mask:0xf
    v_and_b32_dpp v41, v112, v29 row_newbcast:12 row_mask:0xf bank_mask:0xf
    v_and_b32_dpp v42, v112, v30 row_newbcast:12 row_mask:0xf bank_mask:0xf
    v_and_b32_dpp v43, v112, v31 row_newbcast:12 row_mask:0xf bank_mask:0xf
    s_waitcnt vmcnt(17)
    s_nop 0
    v_mfma_f32_16x16x32_bf16 v[80:83], v[40:43], v[168:171], v[80:83]
    buffer_load_dwordx4 a[64:67], v5, s[12:15], s56 offen offset:2048 nt
    v_fma_f32 v122, v122, s60, -v14
    v_exp_f32 v122, v122
    s_nop 0
    v_add_f32 v15, v15, v122
    v_cvt_pk_bf16_f32 v122, v122, v122
    v_fma_f32 v123, v123, s60, -v14
    v_exp_f32 v123, v123
    s_nop 0
    v_add_f32 v15, v15, v123
    v_cvt_pk_bf16_f32 v123, v123, v123
    v_and_b32_dpp v44, v113, v28 row_newbcast:0 row_mask:0xf bank_mask:0xf
    v_and_b32_dpp v45, v113, v29 row_newbcast:0 row_mask:0xf bank_mask:0xf
    v_and_b32_dpp v46, v113, v30 row_newbcast:0 row_mask:0xf bank_mask:0xf
    v_and_b32_dpp v47, v113, v31 row_newbcast:0 row_mask:0xf bank_mask:0xf
    s_waitcnt vmcnt(17)
    s_nop 0
    v_mfma_f32_16x16x32_bf16 v[80:83], v[44:47], v[176:179], v[80:83]
    buffer_load_dwordx4 a[72:75], v5, s[12:15], s56 offen offset:3072 nt
    buffer_load_dwordx4 a[80:83], v8, s[20:23], s59 offen offset:1536
    v_and_b32_dpp v40, v113, v28 row_newbcast:4 row_mask:0xf bank_mask:0xf
    v_and_b32_dpp v41, v113, v29 row_newbcast:4 row_mask:0xf bank_mask:0xf
    v_and_b32_dpp v42, v113, v30 row_newbcast:4 row_mask:0xf bank_mask:0xf
    v_and_b32_dpp v43, v113, v31 row_newbcast:4 row_mask:0xf bank_mask:0xf
    s_waitcnt vmcnt(17)
    s_nop 0
    v_mfma_f32_16x16x32_bf16 v[80:83], v[40:43], v[200:203], v[80:83]
    s_add_u32 s56, s51, 212992
    buffer_load_dwordx4 a[88:91], v5, s[12:15], s56 offen offset:0 nt
    v_and_b32_dpp v44, v113, v28 row_newbcast:8 row_mask:0xf bank_mask:0xf
    v_and_b32_dpp v45, v113, v29 row_newbcast:8 row_mask:0xf bank_mask:0xf
    v_and_b32_dpp v46, v113, v30 row_newbcast:8 row_mask:0xf bank_mask:0xf
    v_and_b32_dpp v47, v113, v31 row_newbcast:8 row_mask:0xf bank_mask:0xf
    s_waitcnt vmcnt(17)
    s_nop 0
    v_mfma_f32_16x16x32_bf16 v[80:83], v[44:47], v[208:211], v[80:83]
    buffer_load_dwordx4 a[104:107], v5, s[12:15], s56 offen offset:1024 nt
    v_and_b32_dpp v40, v113, v28 row_newbcast:12 row_mask:0xf bank_mask:0xf
    v_and_b32_dpp v41, v113, v29 row_newbcast:12 row_mask:0xf bank_mask:0xf
    v_and_b32_dpp v42, v113, v30 row_newbcast:12 row_mask:0xf bank_mask:0xf
    v_and_b32_dpp v43, v113, v31 row_newbcast:12 row_mask:0xf bank_mask:0xf
    s_waitcnt vmcnt(17)
    s_nop 0
    v_mfma_f32_16x16x32_bf16 v[80:83], v[40:43], v[216:219], v[80:83]
    buffer_load_dwordx4 a[112:115], v5, s[12:15], s56 offen offset:2048 nt
    v_fma_f32 v124, v124, s60, -v14
    v_exp_f32 v124, v124
    s_nop 0
    v_add_f32 v15, v15, v124
    v_cvt_pk_bf16_f32 v124, v124, v124
    v_fma_f32 v125, v125, s60, -v14
    v_exp_f32 v125, v125
    s_nop 0
    v_add_f32 v15, v15, v125
    v_cvt_pk_bf16_f32 v125, v125, v125
    v_and_b32_dpp v44, v114, v28 row_newbcast:0 row_mask:0xf bank_mask:0xf
    v_and_b32_dpp v45, v114, v29 row_newbcast:0 row_mask:0xf bank_mask:0xf
    v_and_b32_dpp v46, v114, v30 row_newbcast:0 row_mask:0xf bank_mask:0xf
    v_and_b32_dpp v47, v114, v31 row_newbcast:0 row_mask:0xf bank_mask:0xf
    s_waitcnt vmcnt(17)
    s_nop 0
    v_mfma_f32_16x16x32_bf16 v[80:83], v[44:47], v[224:227], v[80:83]
    buffer_load_dwordx4 a[120:123], v5, s[12:15], s56 offen offset:3072 nt
    v_and_b32_dpp v40, v114, v28 row_newbcast:4 row_mask:0xf bank_mask:0xf
    v_and_b32_dpp v41, v114, v29 row_newbcast:4 row_mask:0xf bank_mask:0xf
    v_and_b32_dpp v42, v114, v30 row_newbcast:4 row_mask:0xf bank_mask:0xf
    v_and_b32_dpp v43, v114, v31 row_newbcast:4 row_mask:0xf bank_mask:0xf
    s_waitcnt vmcnt(17)
    s_nop 0
    v_mfma_f32_16x16x32_bf16 v[80:83], v[40:43], v[232:235], v[80:83]
    s_add_u32 s56, s51, 229376
    buffer_load_dwordx4 a[136:139], v5, s[12:15], s56 offen offset:0 nt
    buffer_load_dwordx4 a[144:147], v8, s[20:23], s59 offen offset:1792
    v_and_b32_dpp v44, v114, v28 row_newbcast:8 row_mask:0xf bank_mask:0xf
    v_and_b32_dpp v45, v114, v29 row_newbcast:8 row_mask:0xf bank_mask:0xf
    v_and_b32_dpp v46, v114, v30 row_newbcast:8 row_mask:0xf bank_mask:0xf
    v_and_b32_dpp v47, v114, v31 row_newbcast:8 row_mask:0xf bank_mask:0xf
    s_waitcnt vmcnt(17)
    s_nop 0
    v_mfma_f32_16x16x32_bf16 v[80:83], v[44:47], v[240:243], v[80:83]
    buffer_load_dwordx4 a[160:163], v5, s[12:15], s56 offen offset:1024 nt
    v_and_b32_dpp v40, v114, v28 row_newbcast:12 row_mask:0xf bank_mask:0xf
    v_and_b32_dpp v41, v114, v29 row_newbcast:12 row_mask:0xf bank_mask:0xf
    v_and_b32_dpp v42, v114, v30 row_newbcast:12 row_mask:0xf bank_mask:0xf
    v_and_b32_dpp v43, v114, v31 row_newbcast:12 row_mask:0xf bank_mask:0xf
    s_waitcnt vmcnt(17)
    s_nop 0
    v_mfma_f32_16x16x32_bf16 v[80:83], v[40:43], v[244:247], v[80:83]
    buffer_load_dwordx4 a[168:171], v5, s[12:15], s56 offen offset:2048 nt
    v_fma_f32 v126, v126, s60, -v14
    v_exp_f32 v126, v126
    s_nop 0
    v_add_f32 v15, v15, v126
    v_cvt_pk_bf16_f32 v126, v126, v126
    v_fma_f32 v127, v127, s60, -v14
    v_exp_f32 v127, v127
    s_nop 0
    v_add_f32 v15, v15, v127
    v_cvt_pk_bf16_f32 v127, v127, v127
    v_and_b32_dpp v44, v115, v28 row_newbcast:0 row_mask:0xf bank_mask:0xf
    v_and_b32_dpp v45, v115, v29 row_newbcast:0 row_mask:0xf bank_mask:0xf
    v_and_b32_dpp v46, v115, v30 row_newbcast:0 row_mask:0xf bank_mask:0xf
    v_and_b32_dpp v47, v115, v31 row_newbcast:0 row_mask:0xf bank_mask:0xf
    s_waitcnt vmcnt(17)
    s_nop 0
    v_mfma_f32_16x16x32_bf16 v[80:83], v[44:47], v[248:251], v[80:83]
    buffer_load_dwordx4 a[176:179], v5, s[12:15], s56 offen offset:3072 nt
    v_and_b32_dpp v40, v115, v28 row_newbcast:4 row_mask:0xf bank_mask:0xf
    v_and_b32_dpp v41, v115, v29 row_newbcast:4 row_mask:0xf bank_mask:0xf
    v_and_b32_dpp v42, v115, v30 row_newbcast:4 row_mask:0xf bank_mask:0xf
    v_and_b32_dpp v43, v115, v31 row_newbcast:4 row_mask:0xf bank_mask:0xf
    s_waitcnt vmcnt(17)
    s_nop 0
    v_mfma_f32_16x16x32_bf16 v[80:83], v[40:43], a[8:11], v[80:83]
    s_add_u32 s56, s51, 245760
    buffer_load_dwordx4 a[192:195], v5, s[12:15], s56 offen offset:0 nt
    v_and_b32_dpp v44, v115, v28 row_newbcast:8 row_mask:0xf bank_mask:0xf
    v_and_b32_dpp v45, v115, v29 row_newbcast:8 row_mask:0xf bank_mask:0xf
    v_and_b32_dpp v46, v115, v30 row_newbcast:8 row_mask:0xf bank_mask:0xf
    v_and_b32_dpp v47, v115, v31 row_newbcast:8 row_mask:0xf bank_mask:0xf
    s_waitcnt vmcnt(17)
    s_nop 0
    v_mfma_f32_16x16x32_bf16 v[80:83], v[44:47], a[16:19], v[80:83]
    buffer_load_dwordx4 a[200:203], v5, s[12:15], s56 offen offset:1024 nt
    buffer_load_dwordx4 a[216:219], v8, s[20:23], s59 offen offset:2048
    v_and_b32_dpp v40, v115, v28 row_newbcast:12 row_mask:0xf bank_mask:0xf
    v_and_b32_dpp v41, v115, v29 row_newbcast:12 row_mask:0xf bank_mask:0xf
    v_and_b32_dpp v42, v115, v30 row_newbcast:12 row_mask:0xf bank_mask:0xf
    v_and_b32_dpp v43, v115, v31 row_newbcast:12 row_mask:0xf bank_mask:0xf
    s_waitcnt vmcnt(17)
    s_nop 0
    v_mfma_f32_16x16x32_bf16 v[80:83], v[40:43], a[32:35], v[80:83]
    buffer_load_dwordx4 a[224:227], v5, s[12:15], s56 offen offset:2048 nt
    v_fma_f32 v128, v128, s60, -v14
    v_exp_f32 v128, v128
    s_nop 0
    v_add_f32 v15, v15, v128
    v_cvt_pk_bf16_f32 v128, v128, v128
    v_fma_f32 v129, v129, s60, -v14
    v_exp_f32 v129, v129
    s_nop 0
    v_add_f32 v15, v15, v129
    v_cvt_pk_bf16_f32 v129, v129, v129
    v_and_b32_dpp v44, v116, v28 row_newbcast:0 row_mask:0xf bank_mask:0xf
    v_and_b32_dpp v45, v116, v29 row_newbcast:0 row_mask:0xf bank_mask:0xf
    v_and_b32_dpp v46, v116, v30 row_newbcast:0 row_mask:0xf bank_mask:0xf
    v_and_b32_dpp v47, v116, v31 row_newbcast:0 row_mask:0xf bank_mask:0xf
    s_waitcnt vmcnt(17)
    s_nop 0
    v_mfma_f32_16x16x32_bf16 v[80:83], v[44:47], a[40:43], v[80:83]
    buffer_load_dwordx4 a[240:243], v5, s[12:15], s56 offen offset:3072 nt
    v_and_b32_dpp v40, v116, v28 row_newbcast:4 row_mask:0xf bank_mask:0xf
    v_and_b32_dpp v41, v116, v29 row_newbcast:4 row_mask:0xf bank_mask:0xf
    v_and_b32_dpp v42, v116, v30 row_newbcast:4 row_mask:0xf bank_mask:0xf
    v_and_b32_dpp v43, v116, v31 row_newbcast:4 row_mask:0xf bank_mask:0xf
    s_waitcnt vmcnt(17)
    s_nop 0
    v_mfma_f32_16x16x32_bf16 v[80:83], v[40:43], a[56:59], v[80:83]
    s_add_u32 s56, s51, 262144
    buffer_load_dwordx4 a[248:251], v5, s[12:15], s56 offen offset:0 nt
    v_and_b32_dpp v44, v116, v28 row_newbcast:8 row_mask:0xf bank_mask:0xf
    v_and_b32_dpp v45, v116, v29 row_newbcast:8 row_mask:0xf bank_mask:0xf
    v_and_b32_dpp v46, v116, v30 row_newbcast:8 row_mask:0xf bank_mask:0xf
    v_and_b32_dpp v47, v116, v31 row_newbcast:8 row_mask:0xf bank_mask:0xf
    s_waitcnt vmcnt(17)
    s_nop 0
    v_mfma_f32_16x16x32_bf16 v[80:83], v[44:47], a[64:67], v[80:83]
    buffer_load_dwordx4 v[156:159], v5, s[12:15], s56 offen offset:1024 nt
    v_and_b32_dpp v40, v116, v28 row_newbcast:12 row_mask:0xf bank_mask:0xf
    v_and_b32_dpp v41, v116, v29 row_newbcast:12 row_mask:0xf bank_mask:0xf
    v_and_b32_dpp v42, v116, v30 row_newbcast:12 row_mask:0xf bank_mask:0xf
    v_and_b32_dpp v43, v116, v31 row_newbcast:12 row_mask:0xf bank_mask:0xf
    s_waitcnt vmcnt(17)
    s_nop 0
    v_mfma_f32_16x16x32_bf16 v[80:83], v[40:43], a[72:75], v[80:83]
    buffer_load_dwordx4 v[172:175], v5, s[12:15], s56 offen offset:2048 nt
    buffer_load_dwordx4 v[188:191], v8, s[20:23], s59 offen offset:2304
    v_fma_f32 v130, v130, s60, -v14
    v_exp_f32 v130, v130
    s_nop 0
    v_add_f32 v15, v15, v130
    v_cvt_pk_bf16_f32 v130, v130, v130
    v_fma_f32 v131, v131, s60, -v14
    v_exp_f32 v131, v131
    s_nop 0
    v_add_f32 v15, v15, v131
    v_cvt_pk_bf16_f32 v131, v131, v131
    v_and_b32_dpp v44, v117, v28 row_newbcast:0 row_mask:0xf bank_mask:0xf
    v_and_b32_dpp v45, v117, v29 row_newbcast:0 row_mask:0xf bank_mask:0xf
    v_and_b32_dpp v46, v117, v30 row_newbcast:0 row_mask:0xf bank_mask:0xf
    v_and_b32_dpp v47, v117, v31 row_newbcast:0 row_mask:0xf bank_mask:0xf
    s_waitcnt vmcnt(17)
    s_nop 0
    v_mfma_f32_16x16x32_bf16 v[80:83], v[44:47], a[88:91], v[80:83]
    buffer_load_dwordx4 v[196:199], v5, s[12:15], s56 offen offset:3072 nt
    v_and_b32_dpp v40, v117, v28 row_newbcast:4 row_mask:0xf bank_mask:0xf
    v_and_b32_dpp v41, v117, v29 row_newbcast:4 row_mask:0xf bank_mask:0xf
    v_and_b32_dpp v42, v117, v30 row_newbcast:4 row_mask:0xf bank_mask:0xf
    v_and_b32_dpp v43, v117, v31 row_newbcast:4 row_mask:0xf bank_mask:0xf
    s_waitcnt vmcnt(17)
    s_nop 0
    v_mfma_f32_16x16x32_bf16 v[80:83], v[40:43], a[104:107], v[80:83]
    s_add_u32 s56, s51, 278528
    buffer_load_dwordx4 v[204:207], v5, s[12:15], s56 offen offset:0 nt
    v_and_b32_dpp v44, v117, v28 row_newbcast:8 row_mask:0xf bank_mask:0xf
    v_and_b32_dpp v45, v117, v29 row_newbcast:8 row_mask:0xf bank_mask:0xf
    v_and_b32_dpp v46, v117, v30 row_newbcast:8 row_mask:0xf bank_mask:0xf
    v_and_b32_dpp v47, v117, v31 row_newbcast:8 row_mask:0xf bank_mask:0xf
    s_waitcnt vmcnt(17)
    s_nop 0
    v_mfma_f32_16x16x32_bf16 v[80:83], v[44:47], a[112:115], v[80:83]
    buffer_load_dwordx4 v[212:215], v5, s[12:15], s56 offen offset:1024 nt
    v_and_b32_dpp v40, v117, v28 row_newbcast:12 row_mask:0xf bank_mask:0xf
    v_and_b32_dpp v41, v117, v29 row_newbcast:12 row_mask:0xf bank_mask:0xf
    v_and_b32_dpp v42, v117, v30 row_newbcast:12 row_mask:0xf bank_mask:0xf
    v_and_b32_dpp v43, v117, v31 row_newbcast:12 row_mask:0xf bank_mask:0xf
    s_waitcnt vmcnt(17)
    s_nop 0
    v_mfma_f32_16x16x32_bf16 v[80:83], v[40:43], a[120:123], v[80:83]
    buffer_load_dwordx4 a[4:7], v5, s[12:15], s56 offen offset:2048 nt
    v_fma_f32 v132, v132, s60, -v14
    v_exp_f32 v132, v132
    s_nop 0
    v_add_f32 v15, v15, v132
    v_cvt_pk_bf16_f32 v132, v132, v132
    v_fma_f32 v133, v133, s60, -v14
    v_exp_f32 v133, v133
    s_nop 0
    v_add_f32 v15, v15, v133
    v_cvt_pk_bf16_f32 v133, v133, v133
    v_and_b32_dpp v44, v118, v28 row_newbcast:0 row_mask:0xf bank_mask:0xf
    v_and_b32_dpp v45, v118, v29 row_newbcast:0 row_mask:0xf bank_mask:0xf
    v_and_b32_dpp v46, v118, v30 row_newbcast:0 row_mask:0xf bank_mask:0xf
    v_and_b32_dpp v47, v118, v31 row_newbcast:0 row_mask:0xf bank_mask:0xf
    s_waitcnt vmcnt(17)
    s_nop 0
    v_mfma_f32_16x16x32_bf16 v[80:83], v[44:47], a[136:139], v[80:83]
    buffer_load_dwordx4 a[12:15], v5, s[12:15], s56 offen offset:3072 nt
    s_add_u32 s59, s54, 7680
    buffer_load_dwordx4 a[20:23], v8, s[20:23], s59 offen offset:0
    v_and_b32_dpp v40, v118, v28 row_newbcast:4 row_mask:0xf bank_mask:0xf
    v_and_b32_dpp v41, v118, v29 row_newbcast:4 row_mask:0xf bank_mask:0xf
    v_and_b32_dpp v42, v118, v30 row_newbcast:4 row_mask:0xf bank_mask:0xf
    v_and_b32_dpp v43, v118, v31 row_newbcast:4 row_mask:0xf bank_mask:0xf
    s_waitcnt vmcnt(17)
    s_nop 0
    v_mfma_f32_16x16x32_bf16 v[80:83], v[40:43], a[160:163], v[80:83]
    s_add_u32 s56, s51, 294912
    buffer_load_dwordx4 a[28:31], v5, s[12:15], s56 offen offset:0 nt
    v_and_b32_dpp v44, v118, v28 row_newbcast:8 row_mask:0xf bank_mask:0xf
    v_and_b32_dpp v45, v118, v29 row_newbcast:8 row_mask:0xf bank_mask:0xf
    v_and_b32_dpp v46, v118, v30 row_newbcast:8 row_mask:0xf bank_mask:0xf
    v_and_b32_dpp v47, v118, v31 row_newbcast:8 row_mask:0xf bank_mask:0xf
    s_waitcnt vmcnt(17)
    s_nop 0
    v_mfma_f32_16x16x32_bf16 v[80:83], v[44:47], a[168:171], v[80:83]
    buffer_load_dwordx4 a[36:39], v5, s[12:15], s56 offen offset:1024 nt
    v_and_b32_dpp v40, v118, v28 row_newbcast:12 row_mask:0xf bank_mask:0xf
    v_and_b32_dpp v41, v118, v29 row_newbcast:12 row_mask:0xf bank_mask:0xf
    v_and_b32_dpp v42, v118, v30 row_newbcast:12 row_mask:0xf bank_mask:0xf
    v_and_b32_dpp v43, v118, v31 row_newbcast:12 row_mask:0xf bank_mask:0xf
    s_waitcnt vmcnt(17)
    s_nop 0
    v_mfma_f32_16x16x32_bf16 v[80:83], v[40:43], a[176:179], v[80:83]
    buffer_load_dwordx4 a[60:63], v5, s[12:15], s56 offen offset:2048 nt
    v_fma_f32 v134, v134, s60, -v14
    v_exp_f32 v134, v134
    s_nop 0
    v_add_f32 v15, v15, v134
    v_cvt_pk_bf16_f32 v134, v134, v134
    v_fma_f32 v135, v135, s60, -v14
    v_exp_f32 v135, v135
    s_nop 0
    v_add_f32 v15, v15, v135
    v_cvt_pk_bf16_f32 v135, v135, v135
    v_and_b32_dpp v44, v119, v28 row_newbcast:0 row_mask:0xf bank_mask:0xf
    v_and_b32_dpp v45, v119, v29 row_newbcast:0 row_mask:0xf bank_mask:0xf
    v_and_b32_dpp v46, v119, v30 row_newbcast:0 row_mask:0xf bank_mask:0xf
    v_and_b32_dpp v47, v119, v31 row_newbcast:0 row_mask:0xf bank_mask:0xf
    s_waitcnt vmcnt(17)
    s_nop 0
    v_mfma_f32_16x16x32_bf16 v[80:83], v[44:47], a[192:195], v[80:83]
    buffer_load_dwordx4 a[68:71], v5, s[12:15], s56 offen offset:3072 nt
    v_and_b32_dpp v40, v119, v28 row_newbcast:4 row_mask:0xf bank_mask:0xf
    v_and_b32_dpp v41, v119, v29 row_newbcast:4 row_mask:0xf bank_mask:0xf
    v_and_b32_dpp v42, v119, v30 row_newbcast:4 row_mask:0xf bank_mask:0xf
    v_and_b32_dpp v43, v119, v31 row_newbcast:4 row_mask:0xf bank_mask:0xf
    s_waitcnt vmcnt(17)
    s_nop 0
    v_mfma_f32_16x16x32_bf16 v[80:83], v[40:43], a[200:203], v[80:83]
    s_add_u32 s56, s51, 311296
    buffer_load_dwordx4 a[76:79], v5, s[12:15], s56 offen offset:0 nt
    buffer_load_dwordx4 a[84:87], v8, s[20:23], s59 offen offset:256
    v_and_b32_dpp v44, v119, v28 row_newbcast:8 row_mask:0xf bank_mask:0xf
    v_and_b32_dpp v45, v119, v29 row_newbcast:8 row_mask:0xf bank_mask:0xf
    v_and_b32_dpp v46, v119, v30 row_newbcast:8 row_mask:0xf bank_mask:0xf
    v_and_b32_dpp v47, v119, v31 row_newbcast:8 row_mask:0xf bank_mask:0xf
    s_waitcnt vmcnt(17)
    s_nop 0
    v_mfma_f32_16x16x32_bf16 v[80:83], v[44:47], a[224:227], v[80:83]
    buffer_load_dwordx4 a[100:103], v5, s[12:15], s56 offen offset:1024 nt
    v_and_b32_dpp v40, v119, v28 row_newbcast:12 row_mask:0xf bank_mask:0xf
    v_and_b32_dpp v41, v119, v29 row_newbcast:12 row_mask:0xf bank_mask:0xf
    v_and_b32_dpp v42, v119, v30 row_newbcast:12 row_mask:0xf bank_mask:0xf
    v_and_b32_dpp v43, v119, v31 row_newbcast:12 row_mask:0xf bank_mask:0xf
    s_waitcnt vmcnt(17)
    s_nop 0
    v_mfma_f32_16x16x32_bf16 v[80:83], v[40:43], a[240:243], v[80:83]
    buffer_load_dwordx4 a[116:119], v5, s[12:15], s56 offen offset:2048 nt
    v_fma_f32 v136, v136, s60, -v14
    v_exp_f32 v136, v136
    s_nop 0
    v_add_f32 v15, v15, v136
    v_cvt_pk_bf16_f32 v136, v136, v136
    v_fma_f32 v137, v137, s60, -v14
    v_exp_f32 v137, v137
    s_nop 0
    v_add_f32 v15, v15, v137
    v_cvt_pk_bf16_f32 v137, v137, v137
    v_and_b32_dpp v44, v120, v28 row_newbcast:0 row_mask:0xf bank_mask:0xf
    v_and_b32_dpp v45, v120, v29 row_newbcast:0 row_mask:0xf bank_mask:0xf
    v_and_b32_dpp v46, v120, v30 row_newbcast:0 row_mask:0xf bank_mask:0xf
    v_and_b32_dpp v47, v120, v31 row_newbcast:0 row_mask:0xf bank_mask:0xf
    s_waitcnt vmcnt(17)
    s_nop 0
    v_mfma_f32_16x16x32_bf16 v[80:83], v[44:47], a[248:251], v[80:83]
    buffer_load_dwordx4 a[124:127], v5, s[12:15], s56 offen offset:3072 nt
    v_and_b32_dpp v40, v120, v28 row_newbcast:4 row_mask:0xf bank_mask:0xf
    v_and_b32_dpp v41, v120, v29 row_newbcast:4 row_mask:0xf bank_mask:0xf
    v_and_b32_dpp v42, v120, v30 row_newbcast:4 row_mask:0xf bank_mask:0xf
    v_and_b32_dpp v43, v120, v31 row_newbcast:4 row_mask:0xf bank_mask:0xf
    s_waitcnt vmcnt(17)
    s_nop 0
    v_mfma_f32_16x16x32_bf16 v[80:83], v[40:43], v[156:159], v[80:83]
    s_add_u32 s56, s51, 327680
    buffer_load_dwordx4 a[132:135], v5, s[12:15], s56 offen offset:0 nt
    v_and_b32_dpp v44, v120, v28 row_newbcast:8 row_mask:0xf bank_mask:0xf
    v_and_b32_dpp v45, v120, v29 row_newbcast:8 row_mask:0xf bank_mask:0xf
    v_and_b32_dpp v46, v120, v30 row_newbcast:8 row_mask:0xf bank_mask:0xf
    v_and_b32_dpp v47, v120, v31 row_newbcast:8 row_mask:0xf bank_mask:0xf
    s_waitcnt vmcnt(17)
    s_nop 0
    v_mfma_f32_16x16x32_bf16 v[80:83], v[44:47], v[172:175], v[80:83]
    buffer_load_dwordx4 a[148:151], v5, s[12:15], s56 offen offset:1024 nt
    buffer_load_dwordx4 a[156:159], v8, s[20:23], s59 offen offset:512
    v_and_b32_dpp v40, v120, v28 row_newbcast:12 row_mask:0xf bank_mask:0xf
    v_and_b32_dpp v41, v120, v29 row_newbcast:12 row_mask:0xf bank_mask:0xf
    v_and_b32_dpp v42, v120, v30 row_newbcast:12 row_mask:0xf bank_mask:0xf
    v_and_b32_dpp v43, v120, v31 row_newbcast:12 row_mask:0xf bank_mask:0xf
    s_waitcnt vmcnt(17)
    s_nop 0
    v_mfma_f32_16x16x32_bf16 v[80:83], v[40:43], v[196:199], v[80:83]
    buffer_load_dwordx4 a[164:167], v5, s[12:15], s56 offen offset:2048 nt
    v_fma_f32 v138, v138, s60, -v14
    v_exp_f32 v138, v138
    s_nop 0
    v_add_f32 v15, v15, v138
    v_cvt_pk_bf16_f32 v138, v138, v138
    v_fma_f32 v139, v139, s60, -v14
    v_exp_f32 v139, v139
    s_nop 0
    v_add_f32 v15, v15, v139
    v_cvt_pk_bf16_f32 v139, v139, v139
    v_and_b32_dpp v44, v121, v28 row_newbcast:0 row_mask:0xf bank_mask:0xf
    v_and_b32_dpp v45, v121, v29 row_newbcast:0 row_mask:0xf bank_mask:0xf
    v_and_b32_dpp v46, v121, v30 row_newbcast:0 row_mask:0xf bank_mask:0xf
    v_and_b32_dpp v47, v121, v31 row_newbcast:0 row_mask:0xf bank_mask:0xf
    s_waitcnt vmcnt(17)
    s_nop 0
    v_mfma_f32_16x16x32_bf16 v[80:83], v[44:47], v[204:207], v[80:83]
    buffer_load_dwordx4 a[180:183], v5, s[12:15], s56 offen offset:3072 nt
    v_and_b32_dpp v40, v121, v28 row_newbcast:4 row_mask:0xf bank_mask:0xf
    v_and_b32_dpp v41, v121, v29 row_newbcast:4 row_mask:0xf bank_mask:0xf
    v_and_b32_dpp v42, v121, v30 row_newbcast:4 row_mask:0xf bank_mask:0xf
    v_and_b32_dpp v43, v121, v31 row_newbcast:4 row_mask:0xf bank_mask:0xf
    s_waitcnt vmcnt(17)
    s_nop 0
    v_mfma_f32_16x16x32_bf16 v[80:83], v[40:43], v[212:215], v[80:83]
    s_add_u32 s56, s51, 344064
    buffer_load_dwordx4 a[196:199], v5, s[12:15], s56 offen offset:0 nt
    v_and_b32_dpp v44, v121, v28 row_newbcast:8 row_mask:0xf bank_mask:0xf
    v_and_b32_dpp v45, v121, v29 row_newbcast:8 row_mask:0xf bank_mask:0xf
    v_and_b32_dpp v46, v121, v30 row_newbcast:8 row_mask:0xf bank_mask:0xf
    v_and_b32_dpp v47, v121, v31 row_newbcast:8 row_mask:0xf bank_mask:0xf
    s_waitcnt vmcnt(17)
    s_nop 0
    v_mfma_f32_16x16x32_bf16 v[80:83], v[44:47], a[4:7], v[80:83]
    buffer_load_dwordx4 a[204:207], v5, s[12:15], s56 offen offset:1024 nt
    v_and_b32_dpp v40, v121, v28 row_newbcast:12 row_mask:0xf bank_mask:0xf
    v_and_b32_dpp v41, v121, v29 row_newbcast:12 row_mask:0xf bank_mask:0xf
    v_and_b32_dpp v42, v121, v30 row_newbcast:12 row_mask:0xf bank_mask:0xf
    v_and_b32_dpp v43, v121, v31 row_newbcast:12 row_mask:0xf bank_mask:0xf
    s_waitcnt vmcnt(17)
    s_nop 0
    v_mfma_f32_16x16x32_bf16 v[80:83], v[40:43], a[12:15], v[80:83]
    buffer_load_dwordx4 a[212:215], v5, s[12:15], s56 offen offset:2048 nt
    buffer_load_dwordx4 a[220:223], v8, s[20:23], s59 offen offset:768
    v_add_f32_dpp v15, v15, v15 row_ror:4 row_mask:0xf bank_mask:0xf
    s_nop 1
    v_add_f32_dpp v15, v15, v15 row_ror:8 row_mask:0xf bank_mask:0xf
    ds_write_b32 v20, v15 offset:8256
    s_lshl_b32 s88, s48, 6
    s_lshl_b32 s3, s47, 1
    s_add_u32 s88, s88, s3
    s_add_u32 s88, s88, s49
    s_mul_i32 s61, s88, 2560
    s_mul_i32 s3, s46, 640
    s_add_u32 s61, s61, s3
    s_lshl_b32 s62, s88, 6
    s_add_u32 s62, s62, 655360
    s_lshl_b32 s63, s50, 1
    s_add_u32 s63, s63, s49
    s_lshl_b32 s64, s63, 5
    s_add_u32 s64, s64, s68
    s_mul_i32 s65, s48, 163840
    s_lshl_b32 s3, s63, 6
    s_add_u32 s65, s65, s3
    s_and_b32 s92, s44, 0xfff
    s_bfe_u32 s93, s44, 0xc000c
    s_and_b32 s94, s45, 0xfff
    s_bfe_u32 s95, s45, 0xc000c
    v_lshlrev_b32 v17, 1, v3
    buffer_load_ushort v18, v17, s[4:7], s64 offen
    buffer_load_dwordx4 a[244:247], v5, s[12:15], s56 offen offset:3072 nt
    v_and_b32_dpp v44, v122, v28 row_newbcast:0 row_mask:0xf bank_mask:0xf
    v_and_b32_dpp v45, v122, v29 row_newbcast:0 row_mask:0xf bank_mask:0xf
    v_and_b32_dpp v46, v122, v30 row_newbcast:0 row_mask:0xf bank_mask:0xf
    v_and_b32_dpp v47, v122, v31 row_newbcast:0 row_mask:0xf bank_mask:0xf
    s_waitcnt vmcnt(19)
    s_nop 0
    v_mfma_f32_16x16x32_bf16 v[80:83], v[44:47], a[28:31], v[80:83]
    v_and_b32_dpp v40, v122, v28 row_newbcast:4 row_mask:0xf bank_mask:0xf
    v_and_b32_dpp v41, v122, v29 row_newbcast:4 row_mask:0xf bank_mask:0xf
    v_and_b32_dpp v42, v122, v30 row_newbcast:4 row_mask:0xf bank_mask:0xf
    v_and_b32_dpp v43, v122, v31 row_newbcast:4 row_mask:0xf bank_mask:0xf
    s_waitcnt vmcnt(18)
    s_nop 0
    v_mfma_f32_16x16x32_bf16 v[80:83], v[40:43], a[36:39], v[80:83]
    s_add_u32 s56, s51, 360448
    buffer_load_dwordx4 a[252:255], v5, s[12:15], s56 offen offset:0 nt
    v_and_b32_dpp v44, v122, v28 row_newbcast:8 row_mask:0xf bank_mask:0xf
    v_and_b32_dpp v45, v122, v29 row_newbcast:8 row_mask:0xf bank_mask:0xf
    v_and_b32_dpp v46, v122, v30 row_newbcast:8 row_mask:0xf bank_mask:0xf
    v_and_b32_dpp v47, v122, v31 row_newbcast:8 row_mask:0xf bank_mask:0xf
    s_waitcnt vmcnt(18)
    s_nop 0
    v_mfma_f32_16x16x32_bf16 v[80:83], v[44:47], a[60:63], v[80:83]
    buffer_load_dwordx4 v[160:163], v5, s[12:15], s56 offen offset:1024 nt
    v_and_b32_dpp v40, v122, v28 row_newbcast:12 row_mask:0xf bank_mask:0xf
    v_and_b32_dpp v41, v122, v29 row_newbcast:12 row_mask:0xf bank_mask:0xf
    v_and_b32_dpp v42, v122, v30 row_newbcast:12 row_mask:0xf bank_mask:0xf
    v_and_b32_dpp v43, v122, v31 row_newbcast:12 row_mask:0xf bank_mask:0xf
    s_waitcnt vmcnt(18)
    s_nop 0
    v_mfma_f32_16x16x32_bf16 v[80:83], v[40:43], a[68:71], v[80:83]
    buffer_load_dwordx4 v[168:171], v5, s[12:15], s56 offen offset:2048 nt
    v_and_b32_dpp v44, v123, v28 row_newbcast:0 row_mask:0xf bank_mask:0xf
    v_and_b32_dpp v45, v123, v29 row_newbcast:0 row_mask:0xf bank_mask:0xf
    v_and_b32_dpp v46, v123, v30 row_newbcast:0 row_mask:0xf bank_mask:0xf
    v_and_b32_dpp v47, v123, v31 row_newbcast:0 row_mask:0xf bank_mask:0xf
    s_waitcnt vmcnt(18)
    s_nop 0
    v_mfma_f32_16x16x32_bf16 v[80:83], v[44:47], a[76:79], v[80:83]
    buffer_load_dwordx4 v[176:179], v5, s[12:15], s56 offen offset:3072 nt
    buffer_load_dwordx4 v[200:203], v8, s[20:23], s59 offen offset:1024
    v_and_b32_dpp v40, v123, v28 row_newbcast:4 row_mask:0xf bank_mask:0xf
    v_and_b32_dpp v41, v123, v29 row_newbcast:4 row_mask:0xf bank_mask:0xf
    v_and_b32_dpp v42, v123, v30 row_newbcast:4 row_mask:0xf bank_mask:0xf
    v_and_b32_dpp v43, v123, v31 row_newbcast:4 row_mask:0xf bank_mask:0xf
    s_waitcnt vmcnt(18)
    s_nop 0
    v_mfma_f32_16x16x32_bf16 v[80:83], v[40:43], a[100:103], v[80:83]
    s_add_u32 s56, s51, 376832
    buffer_load_dwordx4 v[208:211], v5, s[12:15], s56 offen offset:0 nt
    v_and_b32_dpp v44, v123, v28 row_newbcast:8 row_mask:0xf bank_mask:0xf
    v_and_b32_dpp v45, v123, v29 row_newbcast:8 row_mask:0xf bank_mask:0xf
    v_and_b32_dpp v46, v123, v30 row_newbcast:8 row_mask:0xf bank_mask:0xf
    v_and_b32_dpp v47, v123, v31 row_newbcast:8 row_mask:0xf bank_mask:0xf
    s_waitcnt vmcnt(18)
    s_nop 0
    v_mfma_f32_16x16x32_bf16 v[80:83], v[44:47], a[116:119], v[80:83]
    buffer_load_dwordx4 v[216:219], v5, s[12:15], s56 offen offset:1024 nt
    v_and_b32_dpp v40, v123, v28 row_newbcast:12 row_mask:0xf bank_mask:0xf
    v_and_b32_dpp v41, v123, v29 row_newbcast:12 row_mask:0xf bank_mask:0xf
    v_and_b32_dpp v42, v123, v30 row_newbcast:12 row_mask:0xf bank_mask:0xf
    v_and_b32_dpp v43, v123, v31 row_newbcast:12 row_mask:0xf bank_mask:0xf
    s_waitcnt vmcnt(18)
    s_nop 0
    v_mfma_f32_16x16x32_bf16 v[80:83], v[40:43], a[124:127], v[80:83]
    buffer_load_dwordx4 v[224:227], v5, s[12:15], s56 offen offset:2048 nt
    s_waitcnt lgkmcnt(0)
    s_barrier
    ds_read_b32 v15, v12 offset:8256
    v_mov_b32 v140, v13
    v_mov_b32 v142, s44
    v_mov_b32 v143, s45
    v_mov_b32 v144, 0xfff
    s_waitcnt lgkmcnt(0)
    v_add_f32_dpp v15, v15, v15 quad_perm:[1,0,3,2] row_mask:0xf bank_mask:0xf
    s_nop 1
    v_add_f32_dpp v15, v15, v15 quad_perm:[2,3,0,1] row_mask:0xf bank_mask:0xf
    s_nop 1
    v_add_f32_dpp v15, v15, v15 row_half_mirror row_mask:0xf bank_mask:0xf
    s_nop 1
    v_add_f32_dpp v15, v15, v15 row_mirror row_mask:0xf bank_mask:0xf
    s_cmp_lg_u32 s46, 0
    s_cbranch_scc1 L_pubml_b
    v_mov_b32 v141, v15
    s_mov_b64 exec, 1
    buffer_store_dwordx4 v[140:143], off, s[36:39], s62 sc1
    s_mov_b64 exec, -1
L_pubml_b:
    s_xor_b32 s62, s62, 64
    v_and_b32_dpp v44, v124, v28 row_newbcast:0 row_mask:0xf bank_mask:0xf
    v_and_b32_dpp v45, v124, v29 row_newbcast:0 row_mask:0xf bank_mask:0xf
    v_and_b32_dpp v46, v124, v30 row_newbcast:0 row_mask:0xf bank_mask:0xf
    v_and_b32_dpp v47, v124, v31 row_newbcast:0 row_mask:0xf bank_mask:0xf
    s_waitcnt vmcnt(18)
    s_nop 0
    v_mfma_f32_16x16x32_bf16 v[80:83], v[44:47], a[132:135], v[80:83]
    buffer_load_dwordx4 v[232:235], v5, s[12:15], s56 offen offset:3072 nt
    v_and_b32_dpp v40, v124, v28 row_newbcast:4 row_mask:0xf bank_mask:0xf
    v_and_b32_dpp v41, v124, v29 row_newbcast:4 row_mask:0xf bank_mask:0xf
    v_and_b32_dpp v42, v124, v30 row_newbcast:4 row_mask:0xf bank_mask:0xf
    v_and_b32_dpp v43, v124, v31 row_newbcast:4 row_mask:0xf bank_mask:0xf
    s_waitcnt vmcnt(18)
    s_nop 0
    v_mfma_f32_16x16x32_bf16 v[80:83], v[40:43], a[148:151], v[80:83]
    s_add_u32 s56, s51, 393216
    buffer_load_dwordx4 v[240:243], v5, s[12:15], s56 offen offset:0 nt
    buffer_load_dwordx4 v[244:247], v8, s[20:23], s59 offen offset:1280
    v_and_b32_dpp v44, v124, v28 row_newbcast:8 row_mask:0xf bank_mask:0xf
    v_and_b32_dpp v45, v124, v29 row_newbcast:8 row_mask:0xf bank_mask:0xf
    v_and_b32_dpp v46, v124, v30 row_newbcast:8 row_mask:0xf bank_mask:0xf
    v_and_b32_dpp v47, v124, v31 row_newbcast:8 row_mask:0xf bank_mask:0xf
    s_waitcnt vmcnt(18)
    s_nop 0
    v_mfma_f32_16x16x32_bf16 v[80:83], v[44:47], a[164:167], v[80:83]
    buffer_load_dwordx4 v[248:251], v5, s[12:15], s56 offen offset:1024 nt
    v_and_b32_dpp v40, v124, v28 row_newbcast:12 row_mask:0xf bank_mask:0xf
    v_and_b32_dpp v41, v124, v29 row_newbcast:12 row_mask:0xf bank_mask:0xf
    v_and_b32_dpp v42, v124, v30 row_newbcast:12 row_mask:0xf bank_mask:0xf
    v_and_b32_dpp v43, v124, v31 row_newbcast:12 row_mask:0xf bank_mask:0xf
    s_waitcnt vmcnt(18)
    s_nop 0
    v_mfma_f32_16x16x32_bf16 v[80:83], v[40:43], a[180:183], v[80:83]
    buffer_load_dwordx4 a[8:11], v5, s[12:15], s56 offen offset:2048 nt
    v_lshrrev_b32 v10, 2, v0
    v_mul_u32_u24 v24, 2560, v10
    v_and_b32 v10, 3, v0
    v_lshl_add_u32 v24, v10, 4, v24
    v_lshrrev_b32 v25, 4, v0
    v_lshlrev_b32 v25, 6, v25
    v_lshl_add_u32 v25, v10, 4, v25
    v_lshlrev_b32 v26, 8, v2
    v_lshl_add_u32 v26, v3, 2, v26
    v_add_u32 v26, 10496, v26
    v_and_b32 v21, 31, v1
    v_lshlrev_b32 v21, 4, v21
    s_mul_i32 s3, s46, 2560
    v_add_u32 v21, s3, v21
    s_mul_i32 s3, s46, 40
    v_add_u32 v23, s3, v1
    v_lshrrev_b32 v22, 5, v23
    v_lshlrev_b32 v22, 9, v22
    v_and_b32 v10, 1, v23
    v_lshl_add_u32 v22, v10, 8, v22
    v_bfe_u32 v10, v23, 1, 4
    v_lshl_add_u32 v22, v10, 4, v22
    v_and_b32_dpp v44, v125, v28 row_newbcast:0 row_mask:0xf bank_mask:0xf
    v_and_b32_dpp v45, v125, v29 row_newbcast:0 row_mask:0xf bank_mask:0xf
    v_and_b32_dpp v46, v125, v30 row_newbcast:0 row_mask:0xf bank_mask:0xf
    v_and_b32_dpp v47, v125, v31 row_newbcast:0 row_mask:0xf bank_mask:0xf
    s_waitcnt vmcnt(18)
    s_nop 0
    v_mfma_f32_16x16x32_bf16 v[80:83], v[44:47], a[196:199], v[80:83]
    buffer_load_dwordx4 a[16:19], v5, s[12:15], s56 offen offset:3072 nt
    v_and_b32_dpp v40, v125, v28 row_newbcast:4 row_mask:0xf bank_mask:0xf
    v_and_b32_dpp v41, v125, v29 row_newbcast:4 row_mask:0xf bank_mask:0xf
    v_and_b32_dpp v42, v125, v30 row_newbcast:4 row_mask:0xf bank_mask:0xf
    v_and_b32_dpp v43, v125, v31 row_newbcast:4 row_mask:0xf bank_mask:0xf
    s_waitcnt vmcnt(18)
    s_nop 0
    v_mfma_f32_16x16x32_bf16 v[80:83], v[40:43], a[204:207], v[80:83]
    s_add_u32 s56, s51, 409600
    buffer_load_dwordx4 a[32:35], v5, s[12:15], s56 offen offset:0 nt
    v_and_b32_dpp v44, v125, v28 row_newbcast:8 row_mask:0xf bank_mask:0xf
    v_and_b32_dpp v45, v125, v29 row_newbcast:8 row_mask:0xf bank_mask:0xf
    v_and_b32_dpp v46, v125, v30 row_newbcast:8 row_mask:0xf bank_mask:0xf
    v_and_b32_dpp v47, v125, v31 row_newbcast:8 row_mask:0xf bank_mask:0xf
    s_waitcnt vmcnt(18)
    s_nop 0
    v_mfma_f32_16x16x32_bf16 v[80:83], v[44:47], a[212:215], v[80:83]
    buffer_load_dwordx4 a[40:43], v5, s[12:15], s56 offen offset:1024 nt
    buffer_load_dwordx4 a[56:59], v8, s[20:23], s59 offen offset:1536
    v_and_b32_dpp v40, v125, v28 row_newbcast:12 row_mask:0xf bank_mask:0xf
    v_and_b32_dpp v41, v125, v29 row_newbcast:12 row_mask:0xf bank_mask:0xf
    v_and_b32_dpp v42, v125, v30 row_newbcast:12 row_mask:0xf bank_mask:0xf
    v_and_b32_dpp v43, v125, v31 row_newbcast:12 row_mask:0xf bank_mask:0xf
    s_waitcnt vmcnt(17)
    s_nop 0
    v_mfma_f32_16x16x32_bf16 v[80:83], v[40:43], a[244:247], v[80:83]
    buffer_load_dwordx4 a[64:67], v5, s[12:15], s56 offen offset:2048 nt
    v_lshlrev_b32 v10, 5, v3
    v_lshl_add_u32 v10, v2, 4, v10
    s_lshl_b32 s3, s46, 9
    v_add_u32 v10, s3, v10
    v_lshrrev_b32 v11, 3, v3
    v_lshlrev_b32 v11, 10, v11
    v_lshl_add_u32 v11, v2, 5, v11
    v_and_b32 v12, 7, v3
    v_lshl_add_u32 v11, v12, 2, v11
    s_lshl_b32 s3, s46, 7
    s_add_u32 s3, s3, 8448
    v_add_u32 v11, s3, v11
    v_and_b32_dpp v44, v126, v28 row_newbcast:0 row_mask:0xf bank_mask:0xf
    v_and_b32_dpp v45, v126, v29 row_newbcast:0 row_mask:0xf bank_mask:0xf
    v_and_b32_dpp v46, v126, v30 row_newbcast:0 row_mask:0xf bank_mask:0xf
    v_and_b32_dpp v47, v126, v31 row_newbcast:0 row_mask:0xf bank_mask:0xf
    s_waitcnt vmcnt(17)
    s_nop 0
    v_mfma_f32_16x16x32_bf16 v[80:83], v[44:47], a[252:255], v[80:83]
    buffer_load_dwordx4 a[72:75], v5, s[12:15], s56 offen offset:3072 nt
    v_and_b32_dpp v40, v126, v28 row_newbcast:4 row_mask:0xf bank_mask:0xf
    v_and_b32_dpp v41, v126, v29 row_newbcast:4 row_mask:0xf bank_mask:0xf
    v_and_b32_dpp v42, v126, v30 row_newbcast:4 row_mask:0xf bank_mask:0xf
    v_and_b32_dpp v43, v126, v31 row_newbcast:4 row_mask:0xf bank_mask:0xf
    s_waitcnt vmcnt(17)
    s_nop 0
    v_mfma_f32_16x16x32_bf16 v[80:83], v[40:43], v[160:163], v[80:83]
    s_add_u32 s56, s51, 425984
    buffer_load_dwordx4 a[88:91], v5, s[12:15], s56 offen offset:0 nt
    v_and_b32_dpp v44, v126, v28 row_newbcast:8 row_mask:0xf bank_mask:0xf
    v_and_b32_dpp v45, v126, v29 row_newbcast:8 row_mask:0xf bank_mask:0xf
    v_and_b32_dpp v46, v126, v30 row_newbcast:8 row_mask:0xf bank_mask:0xf
    v_and_b32_dpp v47, v126, v31 row_newbcast:8 row_mask:0xf bank_mask:0xf
    s_waitcnt vmcnt(17)
    s_nop 0
    v_mfma_f32_16x16x32_bf16 v[80:83], v[44:47], v[168:171], v[80:83]
    buffer_load_dwordx4 a[104:107], v5, s[12:15], s56 offen offset:1024 nt
    v_and_b32_dpp v40, v126, v28 row_newbcast:12 row_mask:0xf bank_mask:0xf
    v_and_b32_dpp v41, v126, v29 row_newbcast:12 row_mask:0xf bank_mask:0xf
    v_and_b32_dpp v42, v126, v30 row_newbcast:12 row_mask:0xf bank_mask:0xf
    v_and_b32_dpp v43, v126, v31 row_newbcast:12 row_mask:0xf bank_mask:0xf
    s_waitcnt vmcnt(17)
    s_nop 0
    v_mfma_f32_16x16x32_bf16 v[80:83], v[40:43], v[176:179], v[80:83]
    buffer_load_dwordx4 a[112:115], v5, s[12:15], s56 offen offset:2048 nt
    buffer_load_dwordx4 a[120:123], v8, s[20:23], s59 offen offset:1792
    v_and_b32_dpp v44, v127, v28 row_newbcast:0 row_mask:0xf bank_mask:0xf
    v_and_b32_dpp v45, v127, v29 row_newbcast:0 row_mask:0xf bank_mask:0xf
    v_and_b32_dpp v46, v127, v30 row_newbcast:0 row_mask:0xf bank_mask:0xf
    v_and_b32_dpp v47, v127, v31 row_newbcast:0 row_mask:0xf bank_mask:0xf
    s_waitcnt vmcnt(17)
    s_nop 0
    v_mfma_f32_16x16x32_bf16 v[80:83], v[44:47], v[208:211], v[80:83]
    buffer_load_dwordx4 a[136:139], v5, s[12:15], s56 offen offset:3072 nt
    v_and_b32_dpp v40, v127, v28 row_newbcast:4 row_mask:0xf bank_mask:0xf
    v_and_b32_dpp v41, v127, v29 row_newbcast:4 row_mask:0xf bank_mask:0xf
    v_and_b32_dpp v42, v127, v30 row_newbcast:4 row_mask:0xf bank_mask:0xf
    v_and_b32_dpp v43, v127, v31 row_newbcast:4 row_mask:0xf bank_mask:0xf
    s_waitcnt vmcnt(17)
    s_nop 0
    v_mfma_f32_16x16x32_bf16 v[80:83], v[40:43], v[216:219], v[80:83]
    s_add_u32 s56, s51, 442368
    buffer_load_dwordx4 a[160:163], v5, s[12:15], s56 offen offset:0 nt
    v_and_b32_dpp v44, v127, v28 row_newbcast:8 row_mask:0xf bank_mask:0xf
    v_and_b32_dpp v45, v127, v29 row_newbcast:8 row_mask:0xf bank_mask:0xf
    v_and_b32_dpp v46, v127, v30 row_newbcast:8 row_mask:0xf bank_mask:0xf
    v_and_b32_dpp v47, v127, v31 row_newbcast:8 row_mask:0xf bank_mask:0xf
    s_waitcnt vmcnt(17)
    s_nop 0
    v_mfma_f32_16x16x32_bf16 v[80:83], v[44:47], v[224:227], v[80:83]
    buffer_load_dwordx4 a[168:171], v5, s[12:15], s56 offen offset:1024 nt
    v_and_b32_dpp v40, v127, v28 row_newbcast:12 row_mask:0xf bank_mask:0xf
    v_and_b32_dpp v41, v127, v29 row_newbcast:12 row_mask:0xf bank_mask:0xf
    v_and_b32_dpp v42, v127, v30 row_newbcast:12 row_mask:0xf bank_mask:0xf
    v_and_b32_dpp v43, v127, v31 row_newbcast:12 row_mask:0xf bank_mask:0xf
    s_waitcnt vmcnt(17)
    s_nop 0
    v_mfma_f32_16x16x32_bf16 v[80:83], v[40:43], v[232:235], v[80:83]
    buffer_load_dwordx4 a[176:179], v5, s[12:15], s56 offen offset:2048 nt
    v_and_b32_dpp v44, v128, v28 row_newbcast:0 row_mask:0xf bank_mask:0xf
    v_and_b32_dpp v45, v128, v29 row_newbcast:0 row_mask:0xf bank_mask:0xf
    v_and_b32_dpp v46, v128, v30 row_newbcast:0 row_mask:0xf bank_mask:0xf
    v_and_b32_dpp v47, v128, v31 row_newbcast:0 row_mask:0xf bank_mask:0xf
    s_waitcnt vmcnt(17)
    s_nop 0
    v_mfma_f32_16x16x32_bf16 v[80:83], v[44:47], v[240:243], v[80:83]
    buffer_load_dwordx4 a[192:195], v5, s[12:15], s56 offen offset:3072 nt
    buffer_load_dwordx4 a[200:203], v8, s[20:23], s59 offen offset:2048
    v_and_b32_dpp v40, v128, v28 row_newbcast:4 row_mask:0xf bank_mask:0xf
    v_and_b32_dpp v41, v128, v29 row_newbcast:4 row_mask:0xf bank_mask:0xf
    v_and_b32_dpp v42, v128, v30 row_newbcast:4 row_mask:0xf bank_mask:0xf
    v_and_b32_dpp v43, v128, v31 row_newbcast:4 row_mask:0xf bank_mask:0xf
    s_waitcnt vmcnt(17)
    s_nop 0
    v_mfma_f32_16x16x32_bf16 v[80:83], v[40:43], v[248:251], v[80:83]
    s_add_u32 s56, s51, 458752
    buffer_load_dwordx4 a[224:227], v5, s[12:15], s56 offen offset:0 nt
    v_and_b32_dpp v44, v128, v28 row_newbcast:8 row_mask:0xf bank_mask:0xf
    v_and_b32_dpp v45, v128, v29 row_newbcast:8 row_mask:0xf bank_mask:0xf
    v_and_b32_dpp v46, v128, v30 row_newbcast:8 row_mask:0xf bank_mask:0xf
    v_and_b32_dpp v47, v128, v31 row_newbcast:8 row_mask:0xf bank_mask:0xf
    s_waitcnt vmcnt(17)
    s_nop 0
    v_mfma_f32_16x16x32_bf16 v[80:83], v[44:47], a[8:11], v[80:83]
    buffer_load_dwordx4 a[240:243], v5, s[12:15], s56 offen offset:1024 nt
    v_and_b32_dpp v40, v128, v28 row_newbcast:12 row_mask:0xf bank_mask:0xf
    v_and_b32_dpp v41, v128, v29 row_newbcast:12 row_mask:0xf bank_mask:0xf
    v_and_b32_dpp v42, v128, v30 row_newbcast:12 row_mask:0xf bank_mask:0xf
    v_and_b32_dpp v43, v128, v31 row_newbcast:12 row_mask:0xf bank_mask:0xf
    s_waitcnt vmcnt(17)
    s_nop 0
    v_mfma_f32_16x16x32_bf16 v[80:83], v[40:43], a[16:19], v[80:83]
    buffer_load_dwordx4 a[248:251], v5, s[12:15], s56 offen offset:2048 nt
    v_and_b32_dpp v44, v129, v28 row_newbcast:0 row_mask:0xf bank_mask:0xf
    v_and_b32_dpp v45, v129, v29 row_newbcast:0 row_mask:0xf bank_mask:0xf
    v_and_b32_dpp v46, v129, v30 row_newbcast:0 row_mask:0xf bank_mask:0xf
    v_and_b32_dpp v47, v129, v31 row_newbcast:0 row_mask:0xf bank_mask:0xf
    s_waitcnt vmcnt(17)
    s_nop 0
    v_mfma_f32_16x16x32_bf16 v[80:83], v[44:47], a[32:35], v[80:83]
    buffer_load_dwordx4 v[156:159], v5, s[12:15], s56 offen offset:3072 nt
    v_and_b32_dpp v40, v129, v28 row_newbcast:4 row_mask:0xf bank_mask:0xf
    v_and_b32_dpp v41, v129, v29 row_newbcast:4 row_mask:0xf bank_mask:0xf
    v_and_b32_dpp v42, v129, v30 row_newbcast:4 row_mask:0xf bank_mask:0xf
    v_and_b32_dpp v43, v129, v31 row_newbcast:4 row_mask:0xf bank_mask:0xf
    s_waitcnt vmcnt(17)
    s_nop 0
    v_mfma_f32_16x16x32_bf16 v[80:83], v[40:43], a[40:43], v[80:83]
    s_add_u32 s56, s51, 475136
    buffer_load_dwordx4 v[172:175], v5, s[12:15], s56 offen offset:0 nt
    buffer_load_dwordx4 v[196:199], v8, s[20:23], s59 offen offset:2304
    v_and_b32_dpp v44, v129, v28 row_newbcast:8 row_mask:0xf bank_mask:0xf
    v_and_b32_dpp v45, v129, v29 row_newbcast:8 row_mask:0xf bank_mask:0xf
    v_and_b32_dpp v46, v129, v30 row_newbcast:8 row_mask:0xf bank_mask:0xf
    v_and_b32_dpp v47, v129, v31 row_newbcast:8 row_mask:0xf bank_mask:0xf
    s_waitcnt vmcnt(17)
    s_nop 0
    v_mfma_f32_16x16x32_bf16 v[80:83], v[44:47], a[64:67], v[80:83]
    buffer_load_dwordx4 v[204:207], v5, s[12:15], s56 offen offset:1024 nt
    v_and_b32_dpp v40, v129, v28 row_newbcast:12 row_mask:0xf bank_mask:0xf
    v_and_b32_dpp v41, v129, v29 row_newbcast:12 row_mask:0xf bank_mask:0xf
    v_and_b32_dpp v42, v129, v30 row_newbcast:12 row_mask:0xf bank_mask:0xf
    v_and_b32_dpp v43, v129, v31 row_newbcast:12 row_mask:0xf bank_mask:0xf
    s_waitcnt vmcnt(17)
    s_nop 0
    v_mfma_f32_16x16x32_bf16 v[80:83], v[40:43], a[72:75], v[80:83]
    buffer_load_dwordx4 v[212:215], v5, s[12:15], s56 offen offset:2048 nt
    v_and_b32_dpp v44, v130, v28 row_newbcast:0 row_mask:0xf bank_mask:0xf
    v_and_b32_dpp v45, v130, v29 row_newbcast:0 row_mask:0xf bank_mask:0xf
    v_and_b32_dpp v46, v130, v30 row_newbcast:0 row_mask:0xf bank_mask:0xf
    v_and_b32_dpp v47, v130, v31 row_newbcast:0 row_mask:0xf bank_mask:0xf
    s_waitcnt vmcnt(17)
    s_nop 0
    v_mfma_f32_16x16x32_bf16 v[80:83], v[44:47], a[88:91], v[80:83]
    buffer_load_dwordx4 a[4:7], v5, s[12:15], s56 offen offset:3072 nt
    v_and_b32_dpp v40, v130, v28 row_newbcast:4 row_mask:0xf bank_mask:0xf
    v_and_b32_dpp v41, v130, v29 row_newbcast:4 row_mask:0xf bank_mask:0xf
    v_and_b32_dpp v42, v130, v30 row_newbcast:4 row_mask:0xf bank_mask:0xf
    v_and_b32_dpp v43, v130, v31 row_newbcast:4 row_mask:0xf bank_mask:0xf
    s_waitcnt vmcnt(17)
    s_nop 0
    v_mfma_f32_16x16x32_bf16 v[80:83], v[40:43], a[104:107], v[80:83]
    s_add_u32 s56, s51, 491520
    buffer_load_dwordx4 a[12:15], v5, s[12:15], s56 offen offset:0 nt
    v_and_b32_dpp v44, v130, v28 row_newbcast:8 row_mask:0xf bank_mask:0xf
    v_and_b32_dpp v45, v130, v29 row_newbcast:8 row_mask:0xf bank_mask:0xf
    v_and_b32_dpp v46, v130, v30 row_newbcast:8 row_mask:0xf bank_mask:0xf
    v_and_b32_dpp v47, v130, v31 row_newbcast:8 row_mask:0xf bank_mask:0xf
    s_waitcnt vmcnt(17)
    s_nop 0
    v_mfma_f32_16x16x32_bf16 v[80:83], v[44:47], a[112:115], v[80:83]
    buffer_load_dwordx4 a[28:31], v5, s[12:15], s56 offen offset:1024 nt
    buffer_load_dwordx4 a[36:39], v5, s[12:15], s56 offen offset:2048 nt
    v_and_b32_dpp v40, v130, v28 row_newbcast:12 row_mask:0xf bank_mask:0xf
    v_and_b32_dpp v41, v130, v29 row_newbcast:12 row_mask:0xf bank_mask:0xf
    v_and_b32_dpp v42, v130, v30 row_newbcast:12 row_mask:0xf bank_mask:0xf
    v_and_b32_dpp v43, v130, v31 row_newbcast:12 row_mask:0xf bank_mask:0xf
    s_waitcnt vmcnt(17)
    s_nop 0
    v_mfma_f32_16x16x32_bf16 v[80:83], v[40:43], a[136:139], v[80:83]
    buffer_load_dwordx4 a[60:63], v5, s[12:15], s56 offen offset:3072 nt
    v_and_b32_dpp v44, v131, v28 row_newbcast:0 row_mask:0xf bank_mask:0xf
    v_and_b32_dpp v45, v131, v29 row_newbcast:0 row_mask:0xf bank_mask:0xf
    v_and_b32_dpp v46, v131, v30 row_newbcast:0 row_mask:0xf bank_mask:0xf
    v_and_b32_dpp v47, v131, v31 row_newbcast:0 row_mask:0xf bank_mask:0xf
    s_waitcnt vmcnt(17)
    s_nop 0
    v_mfma_f32_16x16x32_bf16 v[80:83], v[44:47], a[160:163], v[80:83]
    s_add_u32 s56, s51, 507904
    buffer_load_dwordx4 a[68:71], v5, s[12:15], s56 offen offset:0 nt
    v_and_b32_dpp v40, v131, v28 row_newbcast:4 row_mask:0xf bank_mask:0xf
    v_and_b32_dpp v41, v131, v29 row_newbcast:4 row_mask:0xf bank_mask:0xf
    v_and_b32_dpp v42, v131, v30 row_newbcast:4 row_mask:0xf bank_mask:0xf
    v_and_b32_dpp v43, v131, v31 row_newbcast:4 row_mask:0xf bank_mask:0xf
    s_waitcnt vmcnt(17)
    s_nop 0
    v_mfma_f32_16x16x32_bf16 v[80:83], v[40:43], a[168:171], v[80:83]
    buffer_load_dwordx4 a[76:79], v5, s[12:15], s56 offen offset:1024 nt
    v_and_b32_dpp v44, v131, v28 row_newbcast:8 row_mask:0xf bank_mask:0xf
    v_and_b32_dpp v45, v131, v29 row_newbcast:8 row_mask:0xf bank_mask:0xf
    v_and_b32_dpp v46, v131, v30 row_newbcast:8 row_mask:0xf bank_mask:0xf
    v_and_b32_dpp v47, v131, v31 row_newbcast:8 row_mask:0xf bank_mask:0xf
    s_waitcnt vmcnt(17)
    s_nop 0
    v_mfma_f32_16x16x32_bf16 v[80:83], v[44:47], a[176:179], v[80:83]
    buffer_load_dwordx4 a[100:103], v5, s[12:15], s56 offen offset:2048 nt
    v_and_b32_dpp v40, v131, v28 row_newbcast:12 row_mask:0xf bank_mask:0xf
    v_and_b32_dpp v41, v131, v29 row_newbcast:12 row_mask:0xf bank_mask:0xf
    v_and_b32_dpp v42, v131, v30 row_newbcast:12 row_mask:0xf bank_mask:0xf
    v_and_b32_dpp v43, v131, v31 row_newbcast:12 row_mask:0xf bank_mask:0xf
    s_waitcnt vmcnt(17)
    s_nop 0
    v_mfma_f32_16x16x32_bf16 v[80:83], v[40:43], a[192:195], v[80:83]
    buffer_load_dwordx4 a[116:119], v5, s[12:15], s56 offen offset:3072 nt
    s_add_u32 s56, s51, 524288
    buffer_load_dwordx4 a[124:127], v5, s[12:15], s56 offen offset:0 nt
    v_and_b32_dpp v44, v132, v28 row_newbcast:0 row_mask:0xf bank_mask:0xf
    v_and_b32_dpp v45, v132, v29 row_newbcast:0 row_mask:0xf bank_mask:0xf
    v_and_b32_dpp v46, v132, v30 row_newbcast:0 row_mask:0xf bank_mask:0xf
    v_and_b32_dpp v47, v132, v31 row_newbcast:0 row_mask:0xf bank_mask:0xf
    s_waitcnt vmcnt(17)
    s_nop 0
    v_mfma_f32_16x16x32_bf16 v[80:83], v[44:47], a[224:227], v[80:83]
    buffer_load_dwordx4 a[132:135], v5, s[12:15], s56 offen offset:1024 nt
    v_and_b32_dpp v40, v132, v28 row_newbcast:4 row_mask:0xf bank_mask:0xf
    v_and_b32_dpp v41, v132, v29 row_newbcast:4 row_mask:0xf bank_mask:0xf
    v_and_b32_dpp v42, v132, v30 row_newbcast:4 row_mask:0xf bank_mask:0xf
    v_and_b32_dpp v43, v132, v31 row_newbcast:4 row_mask:0xf bank_mask:0xf
    s_waitcnt vmcnt(17)
    s_nop 0
    v_mfma_f32_16x16x32_bf16 v[80:83], v[40:43], a[240:243], v[80:83]
    buffer_load_dwordx4 a[148:151], v5, s[12:15], s56 offen offset:2048 nt
    v_and_b32_dpp v44, v132, v28 row_newbcast:8 row_mask:0xf bank_mask:0xf
    v_and_b32_dpp v45, v132, v29 row_newbcast:8 row_mask:0xf bank_mask:0xf
    v_and_b32_dpp v46, v132, v30 row_newbcast:8 row_mask:0xf bank_mask:0xf
    v_and_b32_dpp v47, v132, v31 row_newbcast:8 row_mask:0xf bank_mask:0xf
    s_waitcnt vmcnt(17)
    s_nop 0
    v_mfma_f32_16x16x32_bf16 v[80:83], v[44:47], a[248:251], v[80:83]
    buffer_load_dwordx4 a[164:167], v5, s[12:15], s56 offen offset:3072 nt
    v_and_b32_dpp v40, v132, v28 row_newbcast:12 row_mask:0xf bank_mask:0xf
    v_and_b32_dpp v41, v132, v29 row_newbcast:12 row_mask:0xf bank_mask:0xf
    v_and_b32_dpp v42, v132, v30 row_newbcast:12 row_mask:0xf bank_mask:0xf
    v_and_b32_dpp v43, v132, v31 row_newbcast:12 row_mask:0xf bank_mask:0xf
    s_waitcnt vmcnt(17)
    s_nop 0
    v_mfma_f32_16x16x32_bf16 v[80:83], v[40:43], v[156:159], v[80:83]
    s_add_u32 s56, s51, 540672
    buffer_load_dwordx4 a[180:183], v5, s[12:15], s56 offen offset:0 nt
    buffer_load_dwordx4 v[36:39], off, s[36:39], s62 sc1
    v_and_b32_dpp v44, v133, v28 row_newbcast:0 row_mask:0xf bank_mask:0xf
    v_and_b32_dpp v45, v133, v29 row_newbcast:0 row_mask:0xf bank_mask:0xf
    v_and_b32_dpp v46, v133, v30 row_newbcast:0 row_mask:0xf bank_mask:0xf
    v_and_b32_dpp v47, v133, v31 row_newbcast:0 row_mask:0xf bank_mask:0xf
    s_waitcnt vmcnt(18)
    s_nop 0
    v_mfma_f32_16x16x32_bf16 v[80:83], v[44:47], v[172:175], v[80:83]
    buffer_load_dwordx4 a[196:199], v5, s[12:15], s56 offen offset:1024 nt
    buffer_load_dwordx4 a[204:207], v5, s[12:15], s56 offen offset:2048 nt
    v_and_b32_dpp v40, v133, v28 row_newbcast:4 row_mask:0xf bank_mask:0xf
    v_and_b32_dpp v41, v133, v29 row_newbcast:4 row_mask:0xf bank_mask:0xf
    v_and_b32_dpp v42, v133, v30 row_newbcast:4 row_mask:0xf bank_mask:0xf
    v_and_b32_dpp v43, v133, v31 row_newbcast:4 row_mask:0xf bank_mask:0xf
    s_waitcnt vmcnt(18)
    s_nop 0
    v_mfma_f32_16x16x32_bf16 v[80:83], v[40:43], v[204:207], v[80:83]
    buffer_load_dwordx4 a[212:215], v5, s[12:15], s56 offen offset:3072 nt
    v_and_b32_dpp v44, v133, v28 row_newbcast:8 row_mask:0xf bank_mask:0xf
    v_and_b32_dpp v45, v133, v29 row_newbcast:8 row_mask:0xf bank_mask:0xf
    v_and_b32_dpp v46, v133, v30 row_newbcast:8 row_mask:0xf bank_mask:0xf
    v_and_b32_dpp v47, v133, v31 row_newbcast:8 row_mask:0xf bank_mask:0xf
    s_waitcnt vmcnt(18)
    s_nop 0
    v_mfma_f32_16x16x32_bf16 v[80:83], v[44:47], v[212:215], v[80:83]
    s_add_u32 s56, s51, 557056
    buffer_load_dwordx4 a[244:247], v5, s[12:15], s56 offen offset:0 nt
    v_and_b32_dpp v40, v133, v28 row_newbcast:12 row_mask:0xf bank_mask:0xf
    v_and_b32_dpp v41, v133, v29 row_newbcast:12 row_mask:0xf bank_mask:0xf
    v_and_b32_dpp v42, v133, v30 row_newbcast:12 row_mask:0xf bank_mask:0xf
    v_and_b32_dpp v43, v133, v31 row_newbcast:12 row_mask:0xf bank_mask:0xf
    s_waitcnt vmcnt(18)
    s_nop 0
    v_mfma_f32_16x16x32_bf16 v[80:83], v[40:43], a[4:7], v[80:83]
    buffer_load_dwordx4 a[252:255], v5, s[12:15], s56 offen offset:1024 nt
    v_and_b32_dpp v44, v134, v28 row_newbcast:0 row_mask:0xf bank_mask:0xf
    v_and_b32_dpp v45, v134, v29 row_newbcast:0 row_mask:0xf bank_mask:0xf
    v_and_b32_dpp v46, v134, v30 row_newbcast:0 row_mask:0xf bank_mask:0xf
    v_and_b32_dpp v47, v134, v31 row_newbcast:0 row_mask:0xf bank_mask:0xf
    s_waitcnt vmcnt(18)
    s_nop 0
    v_mfma_f32_16x16x32_bf16 v[80:83], v[44:47], a[12:15], v[80:83]
    buffer_load_dwordx4 v[160:163], v5, s[12:15], s56 offen offset:2048 nt
    v_and_b32_dpp v40, v134, v28 row_newbcast:4 row_mask:0xf bank_mask:0xf
    v_and_b32_dpp v41, v134, v29 row_newbcast:4 row_mask:0xf bank_mask:0xf
    v_and_b32_dpp v42, v134, v30 row_newbcast:4 row_mask:0xf bank_mask:0xf
    v_and_b32_dpp v43, v134, v31 row_newbcast:4 row_mask:0xf bank_mask:0xf
    s_waitcnt vmcnt(18)
    s_nop 0
    v_mfma_f32_16x16x32_bf16 v[80:83], v[40:43], a[28:31], v[80:83]
    buffer_load_dwordx4 v[168:171], v5, s[12:15], s56 offen offset:3072 nt
    v_and_b32_dpp v44, v134, v28 row_newbcast:8 row_mask:0xf bank_mask:0xf
    v_and_b32_dpp v45, v134, v29 row_newbcast:8 row_mask:0xf bank_mask:0xf
    v_and_b32_dpp v46, v134, v30 row_newbcast:8 row_mask:0xf bank_mask:0xf
    v_and_b32_dpp v47, v134, v31 row_newbcast:8 row_mask:0xf bank_mask:0xf
    s_waitcnt vmcnt(18)
    s_nop 0
    v_mfma_f32_16x16x32_bf16 v[80:83], v[44:47], a[36:39], v[80:83]
    s_add_u32 s56, s51, 573440
    buffer_load_dwordx4 v[176:179], v5, s[12:15], s56 offen offset:0 nt
    v_and_b32_dpp v40, v134, v28 row_newbcast:12 row_mask:0xf bank_mask:0xf
    v_and_b32_dpp v41, v134, v29 row_newbcast:12 row_mask:0xf bank_mask:0xf
    v_and_b32_dpp v42, v134, v30 row_newbcast:12 row_mask:0xf bank_mask:0xf
    v_and_b32_dpp v43, v134, v31 row_newbcast:12 row_mask:0xf bank_mask:0xf
    s_waitcnt vmcnt(18)
    s_nop 0
    v_mfma_f32_16x16x32_bf16 v[80:83], v[40:43], a[60:63], v[80:83]
    buffer_load_dwordx4 v[208:211], v5, s[12:15], s56 offen offset:1024 nt
    v_and_b32_dpp v44, v135, v28 row_newbcast:0 row_mask:0xf bank_mask:0xf
    v_and_b32_dpp v45, v135, v29 row_newbcast:0 row_mask:0xf bank_mask:0xf
    v_and_b32_dpp v46, v135, v30 row_newbcast:0 row_mask:0xf bank_mask:0xf
    v_and_b32_dpp v47, v135, v31 row_newbcast:0 row_mask:0xf bank_mask:0xf
    s_waitcnt vmcnt(18)
    s_nop 0
    v_mfma_f32_16x16x32_bf16 v[80:83], v[44:47], a[68:71], v[80:83]
    buffer_load_dwordx4 v[216:219], v5, s[12:15], s56 offen offset:2048 nt
    v_and_b32_dpp v40, v135, v28 row_newbcast:4 row_mask:0xf bank_mask:0xf
    v_and_b32_dpp v41, v135, v29 row_newbcast:4 row_mask:0xf bank_mask:0xf
    v_and_b32_dpp v42, v135, v30 row_newbcast:4 row_mask:0xf bank_mask:0xf
    v_and_b32_dpp v43, v135, v31 row_newbcast:4 row_mask:0xf bank_mask:0xf
    s_waitcnt vmcnt(18)
    s_nop 0
    v_mfma_f32_16x16x32_bf16 v[80:83], v[40:43], a[76:79], v[80:83]
    buffer_load_dwordx4 v[224:227], v5, s[12:15], s56 offen offset:3072 nt
    v_and_b32_dpp v44, v135, v28 row_newbcast:8 row_mask:0xf bank_mask:0xf
    v_and_b32_dpp v45, v135, v29 row_newbcast:8 row_mask:0xf bank_mask:0xf
    v_and_b32_dpp v46, v135, v30 row_newbcast:8 row_mask:0xf bank_mask:0xf
    v_and_b32_dpp v47, v135, v31 row_newbcast:8 row_mask:0xf bank_mask:0xf
    s_waitcnt vmcnt(18)
    s_nop 0
    v_mfma_f32_16x16x32_bf16 v[80:83], v[44:47], a[100:103], v[80:83]
    v_and_b32_dpp v40, v135, v28 row_newbcast:12 row_mask:0xf bank_mask:0xf
    v_and_b32_dpp v41, v135, v29 row_newbcast:12 row_mask:0xf bank_mask:0xf
    v_and_b32_dpp v42, v135, v30 row_newbcast:12 row_mask:0xf bank_mask:0xf
    v_and_b32_dpp v43, v135, v31 row_newbcast:12 row_mask:0xf bank_mask:0xf
    s_waitcnt vmcnt(17)
    s_nop 0
    v_mfma_f32_16x16x32_bf16 v[80:83], v[40:43], a[116:119], v[80:83]
    v_and_b32_dpp v44, v136, v28 row_newbcast:0 row_mask:0xf bank_mask:0xf
    v_and_b32_dpp v45, v136, v29 row_newbcast:0 row_mask:0xf bank_mask:0xf
    v_and_b32_dpp v46, v136, v30 row_newbcast:0 row_mask:0xf bank_mask:0xf
    v_and_b32_dpp v47, v136, v31 row_newbcast:0 row_mask:0xf bank_mask:0xf
    s_waitcnt vmcnt(16)
    s_nop 0
    v_mfma_f32_16x16x32_bf16 v[80:83], v[44:47], a[124:127], v[80:83]
    v_and_b32_dpp v40, v136, v28 row_newbcast:4 row_mask:0xf bank_mask:0xf
    v_and_b32_dpp v41, v136, v29 row_newbcast:4 row_mask:0xf bank_mask:0xf
    v_and_b32_dpp v42, v136, v30 row_newbcast:4 row_mask:0xf bank_mask:0xf
    v_and_b32_dpp v43, v136, v31 row_newbcast:4 row_mask:0xf bank_mask:0xf
    s_waitcnt vmcnt(15)
    s_nop 0
    v_mfma_f32_16x16x32_bf16 v[80:83], v[40:43], a[132:135], v[80:83]
    v_and_b32_dpp v44, v136, v28 row_newbcast:8 row_mask:0xf bank_mask:0xf
    v_and_b32_dpp v45, v136, v29 row_newbcast:8 row_mask:0xf bank_mask:0xf
    v_and_b32_dpp v46, v136, v30 row_newbcast:8 row_mask:0xf bank_mask:0xf
    v_and_b32_dpp v47, v136, v31 row_newbcast:8 row_mask:0xf bank_mask:0xf
    s_waitcnt vmcnt(14)
    s_nop 0
    v_mfma_f32_16x16x32_bf16 v[80:83], v[44:47], a[148:151], v[80:83]
    v_and_b32_dpp v40, v136, v28 row_newbcast:12 row_mask:0xf bank_mask:0xf
    v_and_b32_dpp v41, v136, v29 row_newbcast:12 row_mask:0xf bank_mask:0xf
    v_and_b32_dpp v42, v136, v30 row_newbcast:12 row_mask:0xf bank_mask:0xf
    v_and_b32_dpp v43, v136, v31 row_newbcast:12 row_mask:0xf bank_mask:0xf
    s_waitcnt vmcnt(13)
    s_nop 0
    v_mfma_f32_16x16x32_bf16 v[80:83], v[40:43], a[164:167], v[80:83]
    v_and_b32_dpp v44, v137, v28 row_newbcast:0 row_mask:0xf bank_mask:0xf
    v_and_b32_dpp v45, v137, v29 row_newbcast:0 row_mask:0xf bank_mask:0xf
    v_and_b32_dpp v46, v137, v30 row_newbcast:0 row_mask:0xf bank_mask:0xf
    v_and_b32_dpp v47, v137, v31 row_newbcast:0 row_mask:0xf bank_mask:0xf
    s_waitcnt vmcnt(12)
    s_nop 0
    v_mfma_f32_16x16x32_bf16 v[80:83], v[44:47], a[180:183], v[80:83]
    v_and_b32_dpp v40, v137, v28 row_newbcast:4 row_mask:0xf bank_mask:0xf
    v_and_b32_dpp v41, v137, v29 row_newbcast:4 row_mask:0xf bank_mask:0xf
    v_and_b32_dpp v42, v137, v30 row_newbcast:4 row_mask:0xf bank_mask:0xf
    v_and_b32_dpp v43, v137, v31 row_newbcast:4 row_mask:0xf bank_mask:0xf
    s_waitcnt vmcnt(10)
    s_nop 0
    v_mfma_f32_16x16x32_bf16 v[80:83], v[40:43], a[196:199], v[80:83]
    v_and_b32_dpp v44, v137, v28 row_newbcast:8 row_mask:0xf bank_mask:0xf
    v_and_b32_dpp v45, v137, v29 row_newbcast:8 row_mask:0xf bank_mask:0xf
    v_and_b32_dpp v46, v137, v30 row_newbcast:8 row_mask:0xf bank_mask:0xf
    v_and_b32_dpp v47, v137, v31 row_newbcast:8 row_mask:0xf bank_mask:0xf
    s_waitcnt vmcnt(9)
    s_nop 0
    v_mfma_f32_16x16x32_bf16 v[80:83], v[44:47], a[204:207], v[80:83]
    v_and_b32_dpp v40, v137, v28 row_newbcast:12 row_mask:0xf bank_mask:0xf
    v_and_b32_dpp v41, v137, v29 row_newbcast:12 row_mask:0xf bank_mask:0xf
    v_and_b32_dpp v42, v137, v30 row_newbcast:12 row_mask:0xf bank_mask:0xf
    v_and_b32_dpp v43, v137, v31 row_newbcast:12 row_mask:0xf bank_mask:0xf
    s_waitcnt vmcnt(8)
    s_nop 0
    v_mfma_f32_16x16x32_bf16 v[80:83], v[40:43], a[212:215], v[80:83]
    v_and_b32_dpp v44, v138, v28 row_newbcast:0 row_mask:0xf bank_mask:0xf
    v_and_b32_dpp v45, v138, v29 row_newbcast:0 row_mask:0xf bank_mask:0xf
    v_and_b32_dpp v46, v138, v30 row_newbcast:0 row_mask:0xf bank_mask:0xf
    v_and_b32_dpp v47, v138, v31 row_newbcast:0 row_mask:0xf bank_mask:0xf
    s_waitcnt vmcnt(7)
    s_nop 0
    v_mfma_f32_16x16x32_bf16 v[80:83], v[44:47], a[244:247], v[80:83]
    v_and_b32_dpp v40, v138, v28 row_newbcast:4 row_mask:0xf bank_mask:0xf
    v_and_b32_dpp v41, v138, v29 row_newbcast:4 row_mask:0xf bank_mask:0xf
    v_and_b32_dpp v42, v138, v30 row_newbcast:4 row_mask:0xf bank_mask:0xf
    v_and_b32_dpp v43, v138, v31 row_newbcast:4 row_mask:0xf bank_mask:0xf
    s_waitcnt vmcnt(6)
    s_nop 0
    v_mfma_f32_16x16x32_bf16 v[80:83], v[40:43], a[252:255], v[80:83]
    v_and_b32_dpp v44, v138, v28 row_newbcast:8 row_mask:0xf bank_mask:0xf
    v_and_b32_dpp v45, v138, v29 row_newbcast:8 row_mask:0xf bank_mask:0xf
    v_and_b32_dpp v46, v138, v30 row_newbcast:8 row_mask:0xf bank_mask:0xf
    v_and_b32_dpp v47, v138, v31 row_newbcast:8 row_mask:0xf bank_mask:0xf
    s_waitcnt vmcnt(5)
    s_nop 0
    v_mfma_f32_16x16x32_bf16 v[80:83], v[44:47], v[160:163], v[80:83]
    v_and_b32_dpp v40, v138, v28 row_newbcast:12 row_mask:0xf bank_mask:0xf
    v_and_b32_dpp v41, v138, v29 row_newbcast:12 row_mask:0xf bank_mask:0xf
    v_and_b32_dpp v42, v138, v30 row_newbcast:12 row_mask:0xf bank_mask:0xf
    v_and_b32_dpp v43, v138, v31 row_newbcast:12 row_mask:0xf bank_mask:0xf
    s_waitcnt vmcnt(4)
    s_nop 0
    v_mfma_f32_16x16x32_bf16 v[80:83], v[40:43], v[168:171], v[80:83]
    v_cmp_ne_u64 vcc, s[44:45], v[38:39]
    s_mov_b32 s66, 0
    s_cmp_eq_u64 vcc, 0
    s_cbranch_scc1 L_mlok_b
L_mlwait_b:
    buffer_load_dwordx4 v[36:39], off, s[36:39], s62 sc1
    s_add_u32 s66, s66, 1
    s_waitcnt vmcnt(0)
    v_cmp_ne_u64 vcc, s[44:45], v[38:39]
    s_cmp_gt_u32 s66, 0x200000
    s_cbranch_scc1 L_mlok_b
    s_cmp_lg_u64 vcc, 0
    s_cbranch_scc1 L_mlwait_b
L_mlok_b:
    v_max_f32 v16, v36, v13
    v_sub_f32 v36, v36, v16
    v_sub_f32 v38, v13, v16
    v_mul_f32 v36, s60, v36
    v_mul_f32 v38, s60, v38
    v_exp_f32 v36, v36
    v_exp_f32 v38, v38
    v_mul_f32 v16, v36, v37
    v_fmac_f32 v16, v38, v15
    v_rcp_f32 v16, v16
    v_lshlrev_b32 v18, 16, v18
    v_mul_f32 v16, v16, v38
    v_and_b32_dpp v44, v139, v28 row_newbcast:0 row_mask:0xf bank_mask:0xf
    v_and_b32_dpp v45, v139, v29 row_newbcast:0 row_mask:0xf bank_mask:0xf
    v_and_b32_dpp v46, v139, v30 row_newbcast:0 row_mask:0xf bank_mask:0xf
    v_and_b32_dpp v47, v139, v31 row_newbcast:0 row_mask:0xf bank_mask:0xf
    s_waitcnt vmcnt(3)
    s_nop 0
    v_mfma_f32_16x16x32_bf16 v[80:83], v[44:47], v[176:179], v[80:83]
    v_and_b32_dpp v40, v139, v28 row_newbcast:4 row_mask:0xf bank_mask:0xf
    v_and_b32_dpp v41, v139, v29 row_newbcast:4 row_mask:0xf bank_mask:0xf
    v_and_b32_dpp v42, v139, v30 row_newbcast:4 row_mask:0xf bank_mask:0xf
    v_and_b32_dpp v43, v139, v31 row_newbcast:4 row_mask:0xf bank_mask:0xf
    s_waitcnt vmcnt(2)
    s_nop 0
    v_mfma_f32_16x16x32_bf16 v[80:83], v[40:43], v[208:211], v[80:83]
    v_and_b32_dpp v44, v139, v28 row_newbcast:8 row_mask:0xf bank_mask:0xf
    v_and_b32_dpp v45, v139, v29 row_newbcast:8 row_mask:0xf bank_mask:0xf
    v_and_b32_dpp v46, v139, v30 row_newbcast:8 row_mask:0xf bank_mask:0xf
    v_and_b32_dpp v47, v139, v31 row_newbcast:8 row_mask:0xf bank_mask:0xf
    s_waitcnt vmcnt(1)
    s_nop 0
    v_mfma_f32_16x16x32_bf16 v[80:83], v[44:47], v[216:219], v[80:83]
    v_and_b32_dpp v40, v139, v28 row_newbcast:12 row_mask:0xf bank_mask:0xf
    v_and_b32_dpp v41, v139, v29 row_newbcast:12 row_mask:0xf bank_mask:0xf
    v_and_b32_dpp v42, v139, v30 row_newbcast:12 row_mask:0xf bank_mask:0xf
    v_and_b32_dpp v43, v139, v31 row_newbcast:12 row_mask:0xf bank_mask:0xf
    s_waitcnt vmcnt(0)
    s_nop 0
    v_mfma_f32_16x16x32_bf16 v[80:83], v[40:43], v[224:227], v[80:83]
    s_mov_b32 exec_hi, 0
    s_nop 6
    ds_write_b128 v10, v[80:83] offset:8448
    s_mov_b32 exec_hi, -1
    s_waitcnt lgkmcnt(0)
    s_barrier
    ds_read2_b32 v[36:37], v11 offset0:0 offset1:128
    s_waitcnt lgkmcnt(0)
    v_add_f32 v36, v36, v37
    v_mul_f32 v36, v36, v16
    s_nop 1
    v_add_f32_dpp v36, v36, v36 row_ror:8 row_mask:0xf bank_mask:0xf
    v_cvt_pk_bf16_f32 v36, v36, v36
    s_nop 1
    v_and_b32_dpp v104, v36, v28 row_newbcast:0 row_mask:0xf bank_mask:0xf
    v_and_b32_dpp v105, v36, v29 row_newbcast:0 row_mask:0xf bank_mask:0xf
    v_and_b32_dpp v106, v36, v30 row_newbcast:0 row_mask:0xf bank_mask:0xf
    v_and_b32_dpp v107, v36, v31 row_newbcast:0 row_mask:0xf bank_mask:0xf
    s_nop 1
    v_mfma_f32_16x16x32_bf16 v[84:87], v[104:107], a[128:131], 0
    v_and_b32_dpp v108, v36, v28 row_newbcast:1 row_mask:0xf bank_mask:0xf
    v_and_b32_dpp v109, v36, v29 row_newbcast:1 row_mask:0xf bank_mask:0xf
    v_mfma_f32_16x16x32_bf16 v[88:91], v[104:107], a[184:187], 0
    v_and_b32_dpp v110, v36, v30 row_newbcast:1 row_mask:0xf bank_mask:0xf
    v_and_b32_dpp v111, v36, v31 row_newbcast:1 row_mask:0xf bank_mask:0xf
    v_mfma_f32_16x16x32_bf16 v[92:95], v[104:107], a[232:235], 0
    s_nop 0
    v_mfma_f32_16x16x32_bf16 v[84:87], v[108:111], a[44:47], v[84:87]
    v_and_b32_dpp v112, v36, v28 row_newbcast:2 row_mask:0xf bank_mask:0xf
    v_and_b32_dpp v113, v36, v29 row_newbcast:2 row_mask:0xf bank_mask:0xf
    v_mfma_f32_16x16x32_bf16 v[88:91], v[108:111], a[92:95], v[88:91]
    v_and_b32_dpp v114, v36, v30 row_newbcast:2 row_mask:0xf bank_mask:0xf
    v_and_b32_dpp v115, v36, v31 row_newbcast:2 row_mask:0xf bank_mask:0xf
    v_mfma_f32_16x16x32_bf16 v[92:95], v[108:111], a[140:143], v[92:95]
    s_nop 0
    v_mfma_f32_16x16x32_bf16 v[84:87], v[112:115], v[184:187], v[84:87]
    v_and_b32_dpp v116, v36, v28 row_newbcast:3 row_mask:0xf bank_mask:0xf
    v_and_b32_dpp v117, v36, v29 row_newbcast:3 row_mask:0xf bank_mask:0xf
    v_mfma_f32_16x16x32_bf16 v[88:91], v[112:115], v[228:231], v[88:91]
    v_and_b32_dpp v118, v36, v30 row_newbcast:3 row_mask:0xf bank_mask:0xf
    v_and_b32_dpp v119, v36, v31 row_newbcast:3 row_mask:0xf bank_mask:0xf
    v_mfma_f32_16x16x32_bf16 v[92:95], v[112:115], v[252:255], v[92:95]
    s_nop 0
    v_mfma_f32_16x16x32_bf16 v[84:87], v[116:119], a[152:155], v[84:87]
    v_and_b32_dpp v120, v36, v28 row_newbcast:4 row_mask:0xf bank_mask:0xf
    v_and_b32_dpp v121, v36, v29 row_newbcast:4 row_mask:0xf bank_mask:0xf
    v_mfma_f32_16x16x32_bf16 v[88:91], v[116:119], a[208:211], v[88:91]
    v_and_b32_dpp v122, v36, v30 row_newbcast:4 row_mask:0xf bank_mask:0xf
    v_and_b32_dpp v123, v36, v31 row_newbcast:4 row_mask:0xf bank_mask:0xf
    v_mfma_f32_16x16x32_bf16 v[92:95], v[116:119], v[164:167], v[92:95]
    s_nop 0
    v_mfma_f32_16x16x32_bf16 v[84:87], v[120:123], a[108:111], v[84:87]
    v_and_b32_dpp v124, v36, v28 row_newbcast:5 row_mask:0xf bank_mask:0xf
    v_and_b32_dpp v125, v36, v29 row_newbcast:5 row_mask:0xf bank_mask:0xf
    v_mfma_f32_16x16x32_bf16 v[88:91], v[120:123], a[172:175], v[88:91]
    v_and_b32_dpp v126, v36, v30 row_newbcast:5 row_mask:0xf bank_mask:0xf
    v_and_b32_dpp v127, v36, v31 row_newbcast:5 row_mask:0xf bank_mask:0xf
    v_mfma_f32_16x16x32_bf16 v[92:95], v[120:123], a[228:231], v[92:95]
    s_nop 0
    v_mfma_f32_16x16x32_bf16 v[84:87], v[124:127], a[24:27], v[84:87]
    v_and_b32_dpp v128, v36, v28 row_newbcast:6 row_mask:0xf bank_mask:0xf
    v_and_b32_dpp v129, v36, v29 row_newbcast:6 row_mask:0xf bank_mask:0xf
    v_mfma_f32_16x16x32_bf16 v[88:91], v[124:127], a[80:83], v[88:91]
    v_and_b32_dpp v130, v36, v30 row_newbcast:6 row_mask:0xf bank_mask:0xf
    v_and_b32_dpp v131, v36, v31 row_newbcast:6 row_mask:0xf bank_mask:0xf
    v_mfma_f32_16x16x32_bf16 v[92:95], v[124:127], a[144:147], v[92:95]
    s_nop 0
    v_mfma_f32_16x16x32_bf16 v[84:87], v[128:131], a[20:23], v[84:87]
    v_and_b32_dpp v132, v36, v28 row_newbcast:7 row_mask:0xf bank_mask:0xf
    v_and_b32_dpp v133, v36, v29 row_newbcast:7 row_mask:0xf bank_mask:0xf
    v_mfma_f32_16x16x32_bf16 v[88:91], v[128:131], a[84:87], v[88:91]
    v_and_b32_dpp v134, v36, v30 row_newbcast:7 row_mask:0xf bank_mask:0xf
    v_and_b32_dpp v135, v36, v31 row_newbcast:7 row_mask:0xf bank_mask:0xf
    v_mfma_f32_16x16x32_bf16 v[92:95], v[128:131], a[156:159], v[92:95]
    s_nop 0
    v_mfma_f32_16x16x32_bf16 v[84:87], v[132:135], v[244:247], v[84:87]
    v_mfma_f32_16x16x32_bf16 v[88:91], v[132:135], a[56:59], v[88:91]
    v_mfma_f32_16x16x32_bf16 v[92:95], v[132:135], a[120:123], v[92:95]
    v_mfma_f32_16x16x32_bf16 v[96:99], v[104:107], v[180:183], 0
    v_mfma_f32_16x16x32_bf16 v[96:99], v[108:111], a[188:191], v[96:99]
    v_mfma_f32_16x16x32_bf16 v[96:99], v[112:115], a[48:51], v[96:99]
    v_mfma_f32_16x16x32_bf16 v[96:99], v[116:119], v[220:223], v[96:99]
    v_mfma_f32_16x16x32_bf16 v[96:99], v[120:123], v[192:195], v[96:99]
    v_mfma_f32_16x16x32_bf16 v[96:99], v[124:127], a[216:219], v[96:99]
    v_mfma_f32_16x16x32_bf16 v[96:99], v[128:131], a[220:223], v[96:99]
    ds_write_b128 v21, v[84:87] offset:11520
    v_mfma_f32_16x16x32_bf16 v[96:99], v[132:135], a[200:203], v[96:99]
    ds_write_b128 v21, v[88:91] offset:12032
    v_mfma_f32_16x16x32_bf16 v[100:103], v[104:107], a[0:3], 0
    ds_write_b128 v21, v[92:95] offset:12544
    v_mfma_f32_16x16x32_bf16 v[100:103], v[108:111], a[236:239], v[100:103]
    v_mfma_f32_16x16x32_bf16 v[100:103], v[112:115], a[96:99], v[100:103]
    v_mfma_f32_16x16x32_bf16 v[100:103], v[116:119], a[52:55], v[100:103]
    v_mfma_f32_16x16x32_bf16 v[100:103], v[120:123], v[236:239], v[100:103]
    v_mfma_f32_16x16x32_bf16 v[100:103], v[124:127], v[188:191], v[100:103]
    v_mfma_f32_16x16x32_bf16 v[100:103], v[128:131], v[200:203], v[100:103]
    v_mfma_f32_16x16x32_bf16 v[100:103], v[132:135], v[196:199], v[100:103]
    ds_write_b128 v21, v[96:99] offset:13056
    s_nop 6
    ds_write_b128 v21, v[100:103] offset:13568
    s_mov_b32 exec_hi, 0xff
    s_waitcnt lgkmcnt(0)
    s_barrier
    ds_read_b128 v[104:107], v22 offset:11520
    ds_read_b128 v[108:111], v22 offset:14080
    ds_read_b128 v[112:115], v22 offset:16640
    ds_read_b128 v[116:119], v22 offset:19200
    s_waitcnt lgkmcnt(2)
    v_pk_add_f32 v[104:105], v[104:105], v[108:109]
    v_pk_add_f32 v[106:107], v[106:107], v[110:111]
    s_waitcnt lgkmcnt(0)
    v_pk_add_f32 v[112:113], v[112:113], v[116:117]
    v_pk_add_f32 v[114:115], v[114:115], v[118:119]
    v_pk_add_f32 v[104:105], v[104:105], v[112:113]
    v_pk_add_f32 v[106:107], v[106:107], v[114:115]
    v_add_u32 v104, 0x800, v104
    v_add_u32 v105, 0x800, v105
    v_add_u32 v106, 0x800, v106
    v_add_u32 v107, 0x800, v107
    v_bfi_b32 v104, v144, s92, v104
    v_bfi_b32 v105, v144, s93, v105
    v_bfi_b32 v106, v144, s94, v106
    v_bfi_b32 v107, v144, s95, v107
    buffer_store_dwordx4 v[104:107], v5, s[36:39], s61 offen sc1
    s_mov_b32 exec_hi, -1
    s_cmp_ge_u32 s63, 40
    s_cbranch_scc1 L_fin_done_b
    s_mov_b32 s66, 0
    s_branch L_zload_b
L_zwait_b:
L_zload_b:
    buffer_load_dwordx4 v[84:87], v24, s[36:39], s65 offen sc1
    s_add_u32 s66, s66, 1
    s_waitcnt vmcnt(0)
    v_xor_b32 v84, s92, v84
    v_xor_b32 v85, s93, v85
    v_xor_b32 v86, s94, v86
    v_xor_b32 v87, s95, v87
    v_or3_b32 v88, v84, v85, v86
    v_or_b32 v88, v88, v87
    v_and_b32 v88, v88, v144
    v_cmp_ne_u32 vcc, 0, v88
    s_cmp_gt_u32 s66, 0x200000
    s_cbranch_scc1 L_polled_b
    s_and_b64 exec, exec, vcc
    s_cbranch_scc1 L_zwait_b
L_polled_b:
    s_mov_b64 exec, -1
    v_add_f32_dpp v84, v84, v84 row_ror:4 row_mask:0xf bank_mask:0xf
    v_add_f32_dpp v85, v85, v85 row_ror:4 row_mask:0xf bank_mask:0xf
    v_add_f32_dpp v86, v86, v86 row_ror:4 row_mask:0xf bank_mask:0xf
    v_add_f32_dpp v87, v87, v87 row_ror:4 row_mask:0xf bank_mask:0xf
    v_add_f32_dpp v84, v84, v84 row_ror:8 row_mask:0xf bank_mask:0xf
    v_add_f32_dpp v85, v85, v85 row_ror:8 row_mask:0xf bank_mask:0xf
    v_add_f32_dpp v86, v86, v86 row_ror:8 row_mask:0xf bank_mask:0xf
    v_add_f32_dpp v87, v87, v87 row_ror:8 row_mask:0xf bank_mask:0xf
    ds_write_b128 v25, v[84:87] offset:10496
    s_waitcnt lgkmcnt(0)
    s_barrier
    s_cmp_lg_u32 s46, 0
    s_cbranch_scc1 L_fin_done_b
    ds_read2_b32 v[84:85], v26 offset0:0 offset1:16
    ds_read2_b32 v[86:87], v26 offset0:32 offset1:48
    s_waitcnt lgkmcnt(0)
    v_pk_add_f32 v[84:85], v[84:85], v[86:87]
    v_add_f32 v84, v84, v85
    v_mov_b32 v85, v84
    s_nop 1
    v_permlane32_swap_b32 v84, v85
    v_add_f32 v84, v84, v85
    v_mov_b32 v85, v84
    s_nop 1
    v_permlane16_swap_b32 v84, v85
    v_add_f32 v84, v84, v85
    v_add_f32 v84, v84, v18
    v_cvt_pk_bf16_f32 v84, v84, v84
    s_mov_b64 exec, 0xffff
    buffer_store_short v84, v17, s[40:43], s64 offen
    s_cmp_lg_u32 s63, 0
    s_cbranch_scc1 L_fin_done_b
    s_mov_b64 exec, 1
    buffer_store_dwordx2 v[142:143], off, s[36:39], s67 sc1
L_fin_done_b:
    s_endpgm
.p2align 6
L_var_c:
    s_add_u32 s56, s51, 196608
    buffer_load_dwordx4 v[252:255], v4, s[8:11], s56 offen offset:0 nt
    buffer_load_dwordx4 a[8:11], v4, s[8:11], s56 offen offset:1024 nt
    v_mov_b32_dpp v10, v34 row_newbcast:1 row_mask:0xf bank_mask:0x3
    v_mov_b32_dpp v10, v34 row_newbcast:9 row_mask:0xf bank_mask:0xc
    v_and_b32 v40, v10, v28
    v_and_b32 v41, v10, v29
    v_and_b32 v42, v10, v30
    v_and_b32 v43, v10, v31
    s_waitcnt vmcnt(19)
    s_nop 0
    v_mfma_f32_16x16x32_bf16 v[64:67], v[40:43], v[180:183], v[64:67]
    s_waitcnt vmcnt(17)
    v_mfma_f32_16x16x32_bf16 v[68:71], v[40:43], v[188:191], v[68:71]
    buffer_load_dwordx4 a[16:19], v4, s[8:11], s56 offen offset:2048 nt
    buffer_load_dwordx4 a[24:27], v4, s[8:11], s56 offen offset:3072 nt
    s_add_u32 s56, s51, 212992
    buffer_load_dwordx4 a[32:35], v4, s[8:11], s56 offen offset:0 nt
    buffer_load_dwordx4 a[40:43], v4, s[8:11], s56 offen offset:1024 nt
    v_mov_b32_dpp v10, v34 row_newbcast:2 row_mask:0xf bank_mask:0x3
    v_mov_b32_dpp v10, v34 row_newbcast:10 row_mask:0xf bank_mask:0xc
    v_and_b32 v44, v10, v28
    v_and_b32 v45, v10, v29
    v_and_b32 v46, v10, v30
    v_and_b32 v47, v10, v31
    s_waitcnt vmcnt(19)
    s_nop 0
    v_mfma_f32_16x16x32_bf16 v[64:67], v[44:47], v[196:199], v[64:67]
    s_waitcnt vmcnt(17)
    v_mfma_f32_16x16x32_bf16 v[68:71], v[44:47], v[204:207], v[68:71]
    buffer_load_dwordx4 a[48:51], v4, s[8:11], s56 offen offset:2048 nt
    buffer_load_dwordx4 a[56:59], v4, s[8:11], s56 offen offset:3072 nt
    s_add_u32 s56, s51, 229376
    buffer_load_dwordx4 a[64:67], v4, s[8:11], s56 offen offset:0 nt
    buffer_load_dwordx4 a[72:75], v4, s[8:11], s56 offen offset:1024 nt
    v_mov_b32_dpp v10, v34 row_newbcast:3 row_mask:0xf bank_mask:0x3
    v_mov_b32_dpp v10, v34 row_newbcast:11 row_mask:0xf bank_mask:0xc
    v_and_b32 v40, v10, v28
    v_and_b32 v41, v10, v29
    v_and_b32 v42, v10, v30
    v_and_b32 v43, v10, v31
    s_waitcnt vmcnt(19)
    s_nop 0
    v_mfma_f32_16x16x32_bf16 v[64:67], v[40:43], v[212:215], v[64:67]
    s_waitcnt vmcnt(17)
    v_mfma_f32_16x16x32_bf16 v[68:71], v[40:43], v[220:223], v[68:71]
    v_lshrrev_b32 v10, 3, v3
    v_lshlrev_b32 v19, 9, v10
    v_and_b32 v10, 7, v3
    v_lshl_add_u32 v19, v10, 5, v19
    v_and_b32 v10, 1, v2
    v_lshl_add_u32 v19, v10, 4, v19
    s_lshl_b32 s3, s46, 10
    v_add_u32 v19, s3, v19
    s_mov_b32 exec_lo, 0x00ff00ff
    s_mov_b32 exec_hi, 0xff00ff00
    ds_write_b128 v19, v[64:67] offset:0
    ds_write_b128 v19, v[68:71] offset:256
    s_mov_b64 exec, -1
    v_lshrrev_b32 v10, 2, v3
    v_lshlrev_b32 v10, 10, v10
    v_lshl_add_u32 v10, v2, 7, v10
    v_and_b32 v11, 3, v3
    v_lshl_add_u32 v10, v11, 5, v10
    buffer_load_dwordx4 a[80:83], v4, s[8:11], s56 offen offset:2048 nt
    s_waitcnt lgkmcnt(0)
    s_barrier
    ds_read_b128 v[140:143], v10 offset:0
    ds_read_b128 v[144:147], v10 offset:16
    ds_read_b128 v[148:151], v10 offset:512
    ds_read_b128 v[152:155], v10 offset:528
    s_add_u32 s44, s44, 0x9e3779b9
    s_add_u32 s45, s45, 0x85ebca6b
    s_waitcnt lgkmcnt(0)
    v_pk_add_f32 v[140:141], v[140:141], v[148:149]
    v_pk_add_f32 v[142:143], v[142:143], v[150:151]
    v_pk_add_f32 v[144:145], v[144:145], v[152:153]
    v_pk_add_f32 v[146:147], v[146:147], v[154:155]
    v_add_f32_dpp v140, v140, v140 row_ror:4 row_mask:0xf bank_mask:0xf
    v_add_f32_dpp v141, v141, v141 row_ror:4 row_mask:0xf bank_mask:0xf
    v_add_f32_dpp v142, v142, v142 row_ror:4 row_mask:0xf bank_mask:0xf
    v_add_f32_dpp v143, v143, v143 row_ror:4 row_mask:0xf bank_mask:0xf
    v_add_f32_dpp v144, v144, v144 row_ror:4 row_mask:0xf bank_mask:0xf
    v_add_f32_dpp v145, v145, v145 row_ror:4 row_mask:0xf bank_mask:0xf
    v_add_f32_dpp v146, v146, v146 row_ror:4 row_mask:0xf bank_mask:0xf
    v_add_f32_dpp v147, v147, v147 row_ror:4 row_mask:0xf bank_mask:0xf
    v_add_f32_dpp v140, v140, v140 row_ror:8 row_mask:0xf bank_mask:0xf
    v_add_f32_dpp v141, v141, v141 row_ror:8 row_mask:0xf bank_mask:0xf
    v_add_f32_dpp v142, v142, v142 row_ror:8 row_mask:0xf bank_mask:0xf
    v_add_f32_dpp v143, v143, v143 row_ror:8 row_mask:0xf bank_mask:0xf
    v_add_f32_dpp v144, v144, v144 row_ror:8 row_mask:0xf bank_mask:0xf
    v_add_f32_dpp v145, v145, v145 row_ror:8 row_mask:0xf bank_mask:0xf
    v_add_f32_dpp v146, v146, v146 row_ror:8 row_mask:0xf bank_mask:0xf
    v_add_f32_dpp v147, v147, v147 row_ror:8 row_mask:0xf bank_mask:0xf
    buffer_load_dwordx4 a[88:91], v4, s[8:11], s56 offen offset:3072 nt
    v_cvt_pk_bf16_f32 v148, v140, v141
    v_cvt_pk_bf16_f32 v149, v142, v143
    v_cvt_pk_bf16_f32 v150, v144, v145
    v_cvt_pk_bf16_f32 v151, v146, v147
    v_mov_b32_dpp v48, v148 quad_perm:[0,1,2,3] row_mask:0xf bank_mask:0x1
    v_mov_b32_dpp v49, v149 quad_perm:[0,1,2,3] row_mask:0xf bank_mask:0x1
    v_mov_b32_dpp v50, v150 quad_perm:[0,1,2,3] row_mask:0xf bank_mask:0x1
    v_mov_b32_dpp v51, v151 quad_perm:[0,1,2,3] row_mask:0xf bank_mask:0x1
    v_mov_b32_dpp v52, v148 quad_perm:[0,1,2,3] row_mask:0xf bank_mask:0x2
    v_mov_b32_dpp v53, v149 quad_perm:[0,1,2,3] row_mask:0xf bank_mask:0x2
    v_mov_b32_dpp v54, v150 quad_perm:[0,1,2,3] row_mask:0xf bank_mask:0x2
    v_mov_b32_dpp v55, v151 quad_perm:[0,1,2,3] row_mask:0xf bank_mask:0x2
    v_mov_b32_dpp v56, v148 quad_perm:[0,1,2,3] row_mask:0xf bank_mask:0x4
    v_mov_b32_dpp v57, v149 quad_perm:[0,1,2,3] row_mask:0xf bank_mask:0x4
    v_mov_b32_dpp v58, v150 quad_perm:[0,1,2,3] row_mask:0xf bank_mask:0x4
    v_mov_b32_dpp v59, v151 quad_perm:[0,1,2,3] row_mask:0xf bank_mask:0x4
    v_mov_b32_dpp v60, v148 quad_perm:[0,1,2,3] row_mask:0xf bank_mask:0x8
    v_mov_b32_dpp v61, v149 quad_perm:[0,1,2,3] row_mask:0xf bank_mask:0x8
    v_mov_b32_dpp v62, v150 quad_perm:[0,1,2,3] row_mask:0xf bank_mask:0x8
    v_mov_b32_dpp v63, v151 quad_perm:[0,1,2,3] row_mask:0xf bank_mask:0x8
    v_mfma_f32_16x16x32_bf16 v[72:75], a[0:3], v[48:51], 0
    v_mfma_f32_16x16x32_bf16 v[72:75], a[4:7], v[52:55], v[72:75]
    v_mfma_f32_16x16x32_bf16 v[72:75], a[12:15], v[56:59], v[72:75]
    v_mfma_f32_16x16x32_bf16 v[72:75], a[20:23], v[60:63], v[72:75]
    s_add_u32 s56, s51, 245760
    buffer_load_dwordx4 a[96:99], v4, s[8:11], s56 offen offset:0 nt
    v_mfma_f32_16x16x32_bf16 v[76:79], a[28:31], v[48:51], 0
    v_mfma_f32_16x16x32_bf16 v[76:79], a[36:39], v[52:55], v[76:79]
    v_mfma_f32_16x16x32_bf16 v[76:79], a[44:47], v[56:59], v[76:79]
    v_mfma_f32_16x16x32_bf16 v[76:79], a[52:55], v[60:63], v[76:79]
    s_nop 1
    v_mov_b32_dpp v104, v72 quad_perm:[0,0,0,0] row_mask:0xf bank_mask:0xf
    v_add_f32_dpp v104, v73, v104 quad_perm:[1,1,1,1] row_mask:0xf bank_mask:0xf
    v_add_f32_dpp v104, v74, v104 quad_perm:[2,2,2,2] row_mask:0xf bank_mask:0xf
    v_add_f32_dpp v104, v75, v104 quad_perm:[3,3,3,3] row_mask:0xf bank_mask:0xf
    v_cvt_pk_bf16_f32 v104, 0, v104
    v_mul_f32 v104, 0x3db504f3, v104
    v_cvt_pk_bf16_f32 v104, 0, v104
    v_max_f32 v13, v13, v104
    v_mfma_f32_16x16x32_bf16 v[72:75], a[60:63], v[48:51], 0
    v_mfma_f32_16x16x32_bf16 v[72:75], a[68:71], v[52:55], v[72:75]
    v_mfma_f32_16x16x32_bf16 v[72:75], a[76:79], v[56:59], v[72:75]
    v_mfma_f32_16x16x32_bf16 v[72:75], a[84:87], v[60:63], v[72:75]
    v_mov_b32_dpp v105, v76 quad_perm:[0,0,0,0] row_mask:0xf bank_mask:0xf
    v_add_f32_dpp v105, v77, v105 quad_perm:[1,1,1,1] row_mask:0xf bank_mask:0xf
    v_add_f32_dpp v105, v78, v105 quad_perm:[2,2,2,2] row_mask:0xf bank_mask:0xf
    v_add_f32_dpp v105, v79, v105 quad_perm:[3,3,3,3] row_mask:0xf bank_mask:0xf
    v_cvt_pk_bf16_f32 v105, 0, v105
    v_mul_f32 v105, 0x3db504f3, v105
    v_cvt_pk_bf16_f32 v105, 0, v105
    v_max_f32 v13, v13, v105
    buffer_load_dwordx4 a[104:107], v4, s[8:11], s56 offen offset:1024 nt
    v_mfma_f32_16x16x32_bf16 v[76:79], a[92:95], v[48:51], 0
    v_mfma_f32_16x16x32_bf16 v[76:79], a[100:103], v[52:55], v[76:79]
    v_mfma_f32_16x16x32_bf16 v[76:79], a[108:111], v[56:59], v[76:79]
    v_mfma_f32_16x16x32_bf16 v[76:79], a[116:119], v[60:63], v[76:79]
    v_mov_b32_dpp v106, v72 quad_perm:[0,0,0,0] row_mask:0xf bank_mask:0xf
    v_add_f32_dpp v106, v73, v106 quad_perm:[1,1,1,1] row_mask:0xf bank_mask:0xf
    v_add_f32_dpp v106, v74, v106 quad_perm:[2,2,2,2] row_mask:0xf bank_mask:0xf
    v_add_f32_dpp v106, v75, v106 quad_perm:[3,3,3,3] row_mask:0xf bank_mask:0xf
    v_cvt_pk_bf16_f32 v106, 0, v106
    v_mul_f32 v106, 0x3db504f3, v106
    v_cvt_pk_bf16_f32 v106, 0, v106
    v_max_f32 v13, v13, v106
    v_mfma_f32_16x16x32_bf16 v[72:75], a[124:127], v[48:51], 0
    v_mfma_f32_16x16x32_bf16 v[72:75], a[132:135], v[52:55], v[72:75]
    v_mfma_f32_16x16x32_bf16 v[72:75], a[140:143], v[56:59], v[72:75]
    v_mfma_f32_16x16x32_bf16 v[72:75], a[148:151], v[60:63], v[72:75]
    v_mov_b32_dpp v107, v76 quad_perm:[0,0,0,0] row_mask:0xf bank_mask:0xf
    v_add_f32_dpp v107, v77, v107 quad_perm:[1,1,1,1] row_mask:0xf bank_mask:0xf
    v_add_f32_dpp v107, v78, v107 quad_perm:[2,2,2,2] row_mask:0xf bank_mask:0xf
    v_add_f32_dpp v107, v79, v107 quad_perm:[3,3,3,3] row_mask:0xf bank_mask:0xf
    v_cvt_pk_bf16_f32 v107, 0, v107
    v_mul_f32 v107, 0x3db504f3, v107
    v_cvt_pk_bf16_f32 v107, 0, v107
    v_max_f32 v13, v13, v107
    buffer_load_dwordx4 a[112:115], v4, s[8:11], s56 offen offset:2048 nt
    v_mfma_f32_16x16x32_bf16 v[76:79], a[156:159], v[48:51], 0
    v_mfma_f32_16x16x32_bf16 v[76:79], a[164:167], v[52:55], v[76:79]
    v_mfma_f32_16x16x32_bf16 v[76:79], a[172:175], v[56:59], v[76:79]
    v_mfma_f32_16x16x32_bf16 v[76:79], a[180:183], v[60:63], v[76:79]
    v_mov_b32_dpp v108, v72 quad_perm:[0,0,0,0] row_mask:0xf bank_mask:0xf
    v_add_f32_dpp v108, v73, v108 quad_perm:[1,1,1,1] row_mask:0xf bank_mask:0xf
    v_add_f32_dpp v108, v74, v108 quad_perm:[2,2,2,2] row_mask:0xf bank_mask:0xf
    v_add_f32_dpp v108, v75, v108 quad_perm:[3,3,3,3] row_mask:0xf bank_mask:0xf
    v_cvt_pk_bf16_f32 v108, 0, v108
    v_mul_f32 v108, 0x3db504f3, v108
    v_cvt_pk_bf16_f32 v108, 0, v108
    v_max_f32 v13, v13, v108
    v_mfma_f32_16x16x32_bf16 v[72:75], a[188:191], v[48:51], 0
    v_mfma_f32_16x16x32_bf16 v[72:75], a[196:199], v[52:55], v[72:75]
    v_mfma_f32_16x16x32_bf16 v[72:75], a[204:207], v[56:59], v[72:75]
    v_mfma_f32_16x16x32_bf16 v[72:75], a[212:215], v[60:63], v[72:75]
    v_mov_b32_dpp v109, v76 quad_perm:[0,0,0,0] row_mask:0xf bank_mask:0xf
    v_add_f32_dpp v109, v77, v109 quad_perm:[1,1,1,1] row_mask:0xf bank_mask:0xf
    v_add_f32_dpp v109, v78, v109 quad_perm:[2,2,2,2] row_mask:0xf bank_mask:0xf
    v_add_f32_dpp v109, v79, v109 quad_perm:[3,3,3,3] row_mask:0xf bank_mask:0xf
    v_cvt_pk_bf16_f32 v109, 0, v109
    v_mul_f32 v109, 0x3db504f3, v109
    v_cvt_pk_bf16_f32 v109, 0, v109
    v_max_f32 v13, v13, v109
    buffer_load_dwordx4 a[120:123], v4, s[8:11], s56 offen offset:3072 nt
    v_mfma_f32_16x16x32_bf16 v[76:79], a[220:223], v[48:51], 0
    v_mfma_f32_16x16x32_bf16 v[76:79], a[228:231], v[52:55], v[76:79]
    v_mfma_f32_16x16x32_bf16 v[76:79], a[236:239], v[56:59], v[76:79]
    v_mfma_f32_16x16x32_bf16 v[76:79], a[244:247], v[60:63], v[76:79]
    v_mov_b32_dpp v110, v72 quad_perm:[0,0,0,0] row_mask:0xf bank_mask:0xf
    v_add_f32_dpp v110, v73, v110 quad_perm:[1,1,1,1] row_mask:0xf bank_mask:0xf
    v_add_f32_dpp v110, v74, v110 quad_perm:[2,2,2,2] row_mask:0xf bank_mask:0xf
    v_add_f32_dpp v110, v75, v110 quad_perm:[3,3,3,3] row_mask:0xf bank_mask:0xf
    v_cvt_pk_bf16_f32 v110, 0, v110
    v_mul_f32 v110, 0x3db504f3, v110
    v_cvt_pk_bf16_f32 v110, 0, v110
    v_max_f32 v13, v13, v110
    v_mfma_f32_16x16x32_bf16 v[72:75], a[252:255], v[48:51], 0
    v_mfma_f32_16x16x32_bf16 v[72:75], v[160:163], v[52:55], v[72:75]
    v_mfma_f32_16x16x32_bf16 v[72:75], v[168:171], v[56:59], v[72:75]
    v_mfma_f32_16x16x32_bf16 v[72:75], v[176:179], v[60:63], v[72:75]
    v_mov_b32_dpp v111, v76 quad_perm:[0,0,0,0] row_mask:0xf bank_mask:0xf
    v_add_f32_dpp v111, v77, v111 quad_perm:[1,1,1,1] row_mask:0xf bank_mask:0xf
    v_add_f32_dpp v111, v78, v111 quad_perm:[2,2,2,2] row_mask:0xf bank_mask:0xf
    v_add_f32_dpp v111, v79, v111 quad_perm:[3,3,3,3] row_mask:0xf bank_mask:0xf
    v_cvt_pk_bf16_f32 v111, 0, v111
    v_mul_f32 v111, 0x3db504f3, v111
    v_cvt_pk_bf16_f32 v111, 0, v111
    v_max_f32 v13, v13, v111
    s_add_u32 s59, s54, 0
    buffer_load_dwordx4 a[128:131], v8, s[20:23], s59 offen offset:0
    v_mfma_f32_16x16x32_bf16 v[76:79], v[184:187], v[48:51], 0
    v_mfma_f32_16x16x32_bf16 v[76:79], v[192:195], v[52:55], v[76:79]
    v_mfma_f32_16x16x32_bf16 v[76:79], v[200:203], v[56:59], v[76:79]
    v_mfma_f32_16x16x32_bf16 v[76:79], v[208:211], v[60:63], v[76:79]
    v_mov_b32_dpp v112, v72 quad_perm:[0,0,0,0] row_mask:0xf bank_mask:0xf
    v_add_f32_dpp v112, v73, v112 quad_perm:[1,1,1,1] row_mask:0xf bank_mask:0xf
    v_add_f32_dpp v112, v74, v112 quad_perm:[2,2,2,2] row_mask:0xf bank_mask:0xf
    v_add_f32_dpp v112, v75, v112 quad_perm:[3,3,3,3] row_mask:0xf bank_mask:0xf
    v_cvt_pk_bf16_f32 v112, 0, v112
    v_mul_f32 v112, 0x3db504f3, v112
    v_cvt_pk_bf16_f32 v112, 0, v112
    v_max_f32 v13, v13, v112
    v_mfma_f32_16x16x32_bf16 v[72:75], v[216:219], v[48:51], 0
    s_waitcnt vmcnt(23)
    v_mfma_f32_16x16x32_bf16 v[72:75], v[224:227], v[52:55], v[72:75]
    s_waitcnt vmcnt(22)
    v_mfma_f32_16x16x32_bf16 v[72:75], v[228:231], v[56:59], v[72:75]
    s_waitcnt vmcnt(21)
    v_mfma_f32_16x16x32_bf16 v[72:75], v[232:235], v[60:63], v[72:75]
    v_mov_b32_dpp v113, v76 quad_perm:[0,0,0,0] row_mask:0xf bank_mask:0xf
    v_add_f32_dpp v113, v77, v113 quad_perm:[1,1,1,1] row_mask:0xf bank_mask:0xf
    v_add_f32_dpp v113, v78, v113 quad_perm:[2,2,2,2] row_mask:0xf bank_mask:0xf
    v_add_f32_dpp v113, v79, v113 quad_perm:[3,3,3,3] row_mask:0xf bank_mask:0xf
    v_cvt_pk_bf16_f32 v113, 0, v113
    v_mul_f32 v113, 0x3db504f3, v113
    v_cvt_pk_bf16_f32 v113, 0, v113
    v_max_f32 v13, v13, v113
    s_add_u32 s56, s51, 262144
    buffer_load_dwordx4 a[136:139], v4, s[8:11], s56 offen offset:0 nt
    s_waitcnt vmcnt(21)
    v_mfma_f32_16x16x32_bf16 v[76:79], v[236:239], v[48:51], 0
    s_waitcnt vmcnt(20)
    v_mfma_f32_16x16x32_bf16 v[76:79], v[240:243], v[52:55], v[76:79]
    s_waitcnt vmcnt(19)
    v_mfma_f32_16x16x32_bf16 v[76:79], v[244:247], v[56:59], v[76:79]
    s_waitcnt vmcnt(18)
    v_mfma_f32_16x16x32_bf16 v[76:79], v[248:251], v[60:63], v[76:79]
    v_mov_b32_dpp v114, v72 quad_perm:[0,0,0,0] row_mask:0xf bank_mask:0xf
    v_add_f32_dpp v114, v73, v114 quad_perm:[1,1,1,1] row_mask:0xf bank_mask:0xf
    v_add_f32_dpp v114, v74, v114 quad_perm:[2,2,2,2] row_mask:0xf bank_mask:0xf
    v_add_f32_dpp v114, v75, v114 quad_perm:[3,3,3,3] row_mask:0xf bank_mask:0xf
    v_cvt_pk_bf16_f32 v114, 0, v114
    v_mul_f32 v114, 0x3db504f3, v114
    v_cvt_pk_bf16_f32 v114, 0, v114
    v_max_f32 v13, v13, v114
    buffer_load_dwordx4 a[144:147], v4, s[8:11], s56 offen offset:1024 nt
    buffer_load_dwordx4 a[152:155], v4, s[8:11], s56 offen offset:2048 nt
    buffer_load_dwordx4 a[160:163], v4, s[8:11], s56 offen offset:3072 nt
    s_waitcnt vmcnt(20)
    v_mfma_f32_16x16x32_bf16 v[72:75], v[252:255], v[48:51], 0
    s_waitcnt vmcnt(19)
    v_mfma_f32_16x16x32_bf16 v[72:75], a[8:11], v[52:55], v[72:75]
    s_waitcnt vmcnt(18)
    v_mfma_f32_16x16x32_bf16 v[72:75], a[16:19], v[56:59], v[72:75]
    s_waitcnt vmcnt(17)
    v_mfma_f32_16x16x32_bf16 v[72:75], a[24:27], v[60:63], v[72:75]
    v_mov_b32_dpp v115, v76 quad_perm:[0,0,0,0] row_mask:0xf bank_mask:0xf
    v_add_f32_dpp v115, v77, v115 quad_perm:[1,1,1,1] row_mask:0xf bank_mask:0xf
    v_add_f32_dpp v115, v78, v115 quad_perm:[2,2,2,2] row_mask:0xf bank_mask:0xf
    v_add_f32_dpp v115, v79, v115 quad_perm:[3,3,3,3] row_mask:0xf bank_mask:0xf
    v_cvt_pk_bf16_f32 v115, 0, v115
    v_mul_f32 v115, 0x3db504f3, v115
    v_cvt_pk_bf16_f32 v115, 0, v115
    v_max_f32 v13, v13, v115
    s_add_u32 s56, s51, 278528
    buffer_load_dwordx4 a[168:171], v4, s[8:11], s56 offen offset:0 nt
    buffer_load_dwordx4 a[176:179], v8, s[20:23], s59 offen offset:256
    buffer_load_dwordx4 a[184:187], v4, s[8:11], s56 offen offset:1024 nt
    buffer_load_dwordx4 a[192:195], v4, s[8:11], s56 offen offset:2048 nt
    s_waitcnt vmcnt(20)
    v_mfma_f32_16x16x32_bf16 v[76:79], a[32:35], v[48:51], 0
    s_waitcnt vmcnt(19)
    v_mfma_f32_16x16x32_bf16 v[76:79], a[40:43], v[52:55], v[76:79]
    s_waitcnt vmcnt(18)
    v_mfma_f32_16x16x32_bf16 v[76:79], a[48:51], v[56:59], v[76:79]
    s_waitcnt vmcnt(17)
    v_mfma_f32_16x16x32_bf16 v[76:79], a[56:59], v[60:63], v[76:79]
    v_mov_b32_dpp v116, v72 quad_perm:[0,0,0,0] row_mask:0xf bank_mask:0xf
    v_add_f32_dpp v116, v73, v116 quad_perm:[1,1,1,1] row_mask:0xf bank_mask:0xf
    v_add_f32_dpp v116, v74, v116 quad_perm:[2,2,2,2] row_mask:0xf bank_mask:0xf
    v_add_f32_dpp v116, v75, v116 quad_perm:[3,3,3,3] row_mask:0xf bank_mask:0xf
    v_cvt_pk_bf16_f32 v116, 0, v116
    v_mul_f32 v116, 0x3db504f3, v116
    v_cvt_pk_bf16_f32 v116, 0, v116
    v_max_f32 v13, v13, v116
    buffer_load_dwordx4 a[200:203], v4, s[8:11], s56 offen offset:3072 nt
    s_add_u32 s56, s51, 294912
    buffer_load_dwordx4 a[208:211], v4, s[8:11], s56 offen offset:0 nt
    buffer_load_dwordx4 a[216:219], v8, s[20:23], s59 offen offset:512
    buffer_load_dwordx4 a[224:227], v4, s[8:11], s56 offen offset:1024 nt
    s_waitcnt vmcnt(20)
    v_mfma_f32_16x16x32_bf16 v[72:75], a[64:67], v[48:51], 0
    s_waitcnt vmcnt(19)
    v_mfma_f32_16x16x32_bf16 v[72:75], a[72:75], v[52:55], v[72:75]
    s_waitcnt vmcnt(18)
    v_mfma_f32_16x16x32_bf16 v[72:75], a[80:83], v[56:59], v[72:75]
    s_waitcnt vmcnt(17)
    v_mfma_f32_16x16x32_bf16 v[72:75], a[88:91], v[60:63], v[72:75]
    v_mov_b32_dpp v117, v76 quad_perm:[0,0,0,0] row_mask:0xf bank_mask:0xf
    v_add_f32_dpp v117, v77, v117 quad_perm:[1,1,1,1] row_mask:0xf bank_mask:0xf
    v_add_f32_dpp v117, v78, v117 quad_perm:[2,2,2,2] row_mask:0xf bank_mask:0xf
    v_add_f32_dpp v117, v79, v117 quad_perm:[3,3,3,3] row_mask:0xf bank_mask:0xf
    v_cvt_pk_bf16_f32 v117, 0, v117
    v_mul_f32 v117, 0x3db504f3, v117
    v_cvt_pk_bf16_f32 v117, 0, v117
    v_max_f32 v13, v13, v117
    buffer_load_dwordx4 a[232:235], v4, s[8:11], s56 offen offset:2048 nt
    buffer_load_dwordx4 a[240:243], v4, s[8:11], s56 offen offset:3072 nt
    s_add_u32 s56, s51, 311296
    buffer_load_dwordx4 a[248:251], v4, s[8:11], s56 offen offset:0 nt
    buffer_load_dwordx4 v[156:159], v8, s[20:23], s59 offen offset:768
    s_waitcnt vmcnt(20)
    v_mfma_f32_16x16x32_bf16 v[76:79], a[96:99], v[48:51], 0
    s_waitcnt vmcnt(19)
    v_mfma_f32_16x16x32_bf16 v[76:79], a[104:107], v[52:55], v[76:79]
    s_waitcnt vmcnt(18)
    v_mfma_f32_16x16x32_bf16 v[76:79], a[112:115], v[56:59], v[76:79]
    s_waitcnt vmcnt(17)
    v_mfma_f32_16x16x32_bf16 v[76:79], a[120:123], v[60:63], v[76:79]
    v_mov_b32_dpp v118, v72 quad_perm:[0,0,0,0] row_mask:0xf bank_mask:0xf
    v_add_f32_dpp v118, v73, v118 quad_perm:[1,1,1,1] row_mask:0xf bank_mask:0xf
    v_add_f32_dpp v118, v74, v118 quad_perm:[2,2,2,2] row_mask:0xf bank_mask:0xf
    v_add_f32_dpp v118, v75, v118 quad_perm:[3,3,3,3] row_mask:0xf bank_mask:0xf
    v_cvt_pk_bf16_f32 v118, 0, v118
    v_mul_f32 v118, 0x3db504f3, v118
    v_cvt_pk_bf16_f32 v118, 0, v118
    v_max_f32 v13, v13, v118
    buffer_load_dwordx4 v[164:167], v4, s[8:11], s56 offen offset:1024 nt
    buffer_load_dwordx4 v[172:175], v4, s[8:11], s56 offen offset:2048 nt
    buffer_load_dwordx4 v[180:183], v4, s[8:11], s56 offen offset:3072 nt
    s_add_u32 s56, s51, 327680
    buffer_load_dwordx4 v[188:191], v4, s[8:11], s56 offen offset:0 nt
    buffer_load_dwordx4 v[196:199], v8, s[20:23], s59 offen offset:1024
    s_waitcnt vmcnt(20)
    v_mfma_f32_16x16x32_bf16 v[72:75], a[136:139], v[48:51], 0
    s_waitcnt vmcnt(19)
    v_mfma_f32_16x16x32_bf16 v[72:75], a[144:147], v[52:55], v[72:75]
    s_waitcnt vmcnt(18)
    v_mfma_f32_16x16x32_bf16 v[72:75], a[152:155], v[56:59], v[72:75]
    s_waitcnt vmcnt(17)
    v_mfma_f32_16x16x32_bf16 v[72:75], a[160:163], v[60:63], v[72:75]
    v_mov_b32_dpp v119, v76 quad_perm:[0,0,0,0] row_mask:0xf bank_mask:0xf
    v_add_f32_dpp v119, v77, v119 quad_perm:[1,1,1,1] row_mask:0xf bank_mask:0xf
    v_add_f32_dpp v119, v78, v119 quad_perm:[2,2,2,2] row_mask:0xf bank_mask:0xf
    v_add_f32_dpp v119, v79, v119 quad_perm:[3,3,3,3] row_mask:0xf bank_mask:0xf
    v_cvt_pk_bf16_f32 v119, 0, v119
    v_mul_f32 v119, 0x3db504f3, v119
    v_cvt_pk_bf16_f32 v119, 0, v119
    v_max_f32 v13, v13, v119
    buffer_load_dwordx4 v[204:207], v4, s[8:11], s56 offen offset:1024 nt
    buffer_load_dwordx4 v[212:215], v4, s[8:11], s56 offen offset:2048 nt
    buffer_load_dwordx4 v[220:223], v4, s[8:11], s56 offen offset:3072 nt
    s_add_u32 s56, s51, 344064
    buffer_load_dwordx4 a[0:3], v4, s[8:11], s56 offen offset:0 nt
    buffer_load_dwordx4 a[4:7], v4, s[8:11], s56 offen offset:1024 nt
    s_waitcnt vmcnt(21)
    v_mfma_f32_16x16x32_bf16 v[76:79], a[168:171], v[48:51], 0
    s_waitcnt vmcnt(19)
    v_mfma_f32_16x16x32_bf16 v[76:79], a[184:187], v[52:55], v[76:79]
    s_waitcnt vmcnt(18)
    v_mfma_f32_16x16x32_bf16 v[76:79], a[192:195], v[56:59], v[76:79]
    s_waitcnt vmcnt(17)
    v_mfma_f32_16x16x32_bf16 v[76:79], a[200:203], v[60:63], v[76:79]
    v_mov_b32_dpp v120, v72 quad_perm:[0,0,0,0] row_mask:0xf bank_mask:0xf
    v_add_f32_dpp v120, v73, v120 quad_perm:[1,1,1,1] row_mask:0xf bank_mask:0xf
    v_add_f32_dpp v120, v74, v120 quad_perm:[2,2,2,2] row_mask:0xf bank_mask:0xf
    v_add_f32_dpp v120, v75, v120 quad_perm:[3,3,3,3] row_mask:0xf bank_mask:0xf
    v_cvt_pk_bf16_f32 v120, 0, v120
    v_mul_f32 v120, 0x3db504f3, v120
    v_cvt_pk_bf16_f32 v120, 0, v120
    v_max_f32 v13, v13, v120
    buffer_load_dwordx4 a[12:15], v8, s[20:23], s59 offen offset:1280
    buffer_load_dwordx4 a[20:23], v4, s[8:11], s56 offen offset:2048 nt
    buffer_load_dwordx4 a[28:31], v4, s[8:11], s56 offen offset:3072 nt
    s_add_u32 s56, s51, 360448
    buffer_load_dwordx4 a[36:39], v4, s[8:11], s56 offen offset:0 nt
    buffer_load_dwordx4 a[44:47], v4, s[8:11], s56 offen offset:1024 nt
    s_waitcnt vmcnt(21)
    v_mfma_f32_16x16x32_bf16 v[72:75], a[208:211], v[48:51], 0
    s_waitcnt vmcnt(19)
    v_mfma_f32_16x16x32_bf16 v[72:75], a[224:227], v[52:55], v[72:75]
    s_waitcnt vmcnt(18)
    v_mfma_f32_16x16x32_bf16 v[72:75], a[232:235], v[56:59], v[72:75]
    s_waitcnt vmcnt(17)
    v_mfma_f32_16x16x32_bf16 v[72:75], a[240:243], v[60:63], v[72:75]
    v_mov_b32_dpp v121, v76 quad_perm:[0,0,0,0] row_mask:0xf bank_mask:0xf
    v_add_f32_dpp v121, v77, v121 quad_perm:[1,1,1,1] row_mask:0xf bank_mask:0xf
    v_add_f32_dpp v121, v78, v121 quad_perm:[2,2,2,2] row_mask:0xf bank_mask:0xf
    v_add_f32_dpp v121, v79, v121 quad_perm:[3,3,3,3] row_mask:0xf bank_mask:0xf
    v_cvt_pk_bf16_f32 v121, 0, v121
    v_mul_f32 v121, 0x3db504f3, v121
    v_cvt_pk_bf16_f32 v121, 0, v121
    v_max_f32 v13, v13, v121
    buffer_load_dwordx4 a[52:55], v8, s[20:23], s59 offen offset:1536
    buffer_load_dwordx4 a[60:63], v4, s[8:11], s56 offen offset:2048 nt
    buffer_load_dwordx4 a[68:71], v4, s[8:11], s56 offen offset:3072 nt
    s_add_u32 s56, s51, 376832
    buffer_load_dwordx4 a[76:79], v4, s[8:11], s56 offen offset:0 nt
    buffer_load_dwordx4 a[84:87], v4, s[8:11], s56 offen offset:1024 nt
    s_waitcnt vmcnt(21)
    v_mfma_f32_16x16x32_bf16 v[76:79], a[248:251], v[48:51], 0
    s_waitcnt vmcnt(19)
    v_mfma_f32_16x16x32_bf16 v[76:79], v[164:167], v[52:55], v[76:79]
    s_waitcnt vmcnt(18)
    v_mfma_f32_16x16x32_bf16 v[76:79], v[172:175], v[56:59], v[76:79]
    s_waitcnt vmcnt(17)
    v_mfma_f32_16x16x32_bf16 v[76:79], v[180:183], v[60:63], v[76:79]
    v_mov_b32_dpp v122, v72 quad_perm:[0,0,0,0] row_mask:0xf bank_mask:0xf
    v_add_f32_dpp v122, v73, v122 quad_perm:[1,1,1,1] row_mask:0xf bank_mask:0xf
    v_add_f32_dpp v122, v74, v122 quad_perm:[2,2,2,2] row_mask:0xf bank_mask:0xf
    v_add_f32_dpp v122, v75, v122 quad_perm:[3,3,3,3] row_mask:0xf bank_mask:0xf
    v_cvt_pk_bf16_f32 v122, 0, v122
    v_mul_f32 v122, 0x3db504f3, v122
    v_cvt_pk_bf16_f32 v122, 0, v122
    v_max_f32 v13, v13, v122
    buffer_load_dwordx4 a[92:95], v8, s[20:23], s59 offen offset:1792
    buffer_load_dwordx4 a[100:103], v4, s[8:11], s56 offen offset:2048 nt
    buffer_load_dwordx4 a[108:111], v4, s[8:11], s56 offen offset:3072 nt
    s_add_u32 s56, s51, 393216
    buffer_load_dwordx4 a[116:119], v4, s[8:11], s56 offen offset:0 nt
    buffer_load_dwordx4 a[124:127], v4, s[8:11], s56 offen offset:1024 nt
    s_waitcnt vmcnt(21)
    v_mfma_f32_16x16x32_bf16 v[72:75], v[188:191], v[48:51], 0
    s_waitcnt vmcnt(19)
    v_mfma_f32_16x16x32_bf16 v[72:75], v[204:207], v[52:55], v[72:75]
    s_waitcnt vmcnt(18)
    v_mfma_f32_16x16x32_bf16 v[72:75], v[212:215], v[56:59], v[72:75]
    s_waitcnt vmcnt(17)
    v_mfma_f32_16x16x32_bf16 v[72:75], v[220:223], v[60:63], v[72:75]
    v_mov_b32_dpp v123, v76 quad_perm:[0,0,0,0] row_mask:0xf bank_mask:0xf
    v_add_f32_dpp v123, v77, v123 quad_perm:[1,1,1,1] row_mask:0xf bank_mask:0xf
    v_add_f32_dpp v123, v78, v123 quad_perm:[2,2,2,2] row_mask:0xf bank_mask:0xf
    v_add_f32_dpp v123, v79, v123 quad_perm:[3,3,3,3] row_mask:0xf bank_mask:0xf
    v_cvt_pk_bf16_f32 v123, 0, v123
    v_mul_f32 v123, 0x3db504f3, v123
    v_cvt_pk_bf16_f32 v123, 0, v123
    v_max_f32 v13, v13, v123
    buffer_load_dwordx4 a[132:135], v8, s[20:23], s59 offen offset:2048
    buffer_load_dwordx4 a[140:143], v4, s[8:11], s56 offen offset:2048 nt
    buffer_load_dwordx4 a[148:151], v4, s[8:11], s56 offen offset:3072 nt
    s_add_u32 s56, s51, 409600
    buffer_load_dwordx4 a[156:159], v4, s[8:11], s56 offen offset:0 nt
    buffer_load_dwordx4 a[164:167], v4, s[8:11], s56 offen offset:1024 nt
    s_waitcnt vmcnt(21)
    v_mfma_f32_16x16x32_bf16 v[76:79], a[0:3], v[48:51], 0
    s_waitcnt vmcnt(20)
    v_mfma_f32_16x16x32_bf16 v[76:79], a[4:7], v[52:55], v[76:79]
    s_waitcnt vmcnt(18)
    v_mfma_f32_16x16x32_bf16 v[76:79], a[20:23], v[56:59], v[76:79]
    s_waitcnt vmcnt(17)
    v_mfma_f32_16x16x32_bf16 v[76:79], a[28:31], v[60:63], v[76:79]
    v_mov_b32_dpp v124, v72 quad_perm:[0,0,0,0] row_mask:0xf bank_mask:0xf
    v_add_f32_dpp v124, v73, v124 quad_perm:[1,1,1,1] row_mask:0xf bank_mask:0xf
    v_add_f32_dpp v124, v74, v124 quad_perm:[2,2,2,2] row_mask:0xf bank_mask:0xf
    v_add_f32_dpp v124, v75, v124 quad_perm:[3,3,3,3] row_mask:0xf bank_mask:0xf
    v_cvt_pk_bf16_f32 v124, 0, v124
    v_mul_f32 v124, 0x3db504f3, v124
    v_cvt_pk_bf16_f32 v124, 0, v124
    v_max_f32 v13, v13, v124
    buffer_load_dwordx4 a[172:175], v4, s[8:11], s56 offen offset:2048 nt
    buffer_load_dwordx4 a[180:183], v8, s[20:23], s59 offen offset:2304
    buffer_load_dwordx4 a[188:191], v4, s[8:11], s56 offen offset:3072 nt
    s_add_u32 s56, s51, 425984
    buffer_load_dwordx4 a[196:199], v4, s[8:11], s56 offen offset:0 nt
    buffer_load_dwordx4 a[204:207], v4, s[8:11], s56 offen offset:1024 nt
    s_waitcnt vmcnt(21)
    v_mfma_f32_16x16x32_bf16 v[72:75], a[36:39], v[48:51], 0
    s_waitcnt vmcnt(20)
    v_mfma_f32_16x16x32_bf16 v[72:75], a[44:47], v[52:55], v[72:75]
    s_waitcnt vmcnt(18)
    v_mfma_f32_16x16x32_bf16 v[72:75], a[60:63], v[56:59], v[72:75]
    s_waitcnt vmcnt(17)
    v_mfma_f32_16x16x32_bf16 v[72:75], a[68:71], v[60:63], v[72:75]
    v_mov_b32_dpp v125, v76 quad_perm:[0,0,0,0] row_mask:0xf bank_mask:0xf
    v_add_f32_dpp v125, v77, v125 quad_perm:[1,1,1,1] row_mask:0xf bank_mask:0xf
    v_add_f32_dpp v125, v78, v125 quad_perm:[2,2,2,2] row_mask:0xf bank_mask:0xf
    v_add_f32_dpp v125, v79, v125 quad_perm:[3,3,3,3] row_mask:0xf bank_mask:0xf
    v_cvt_pk_bf16_f32 v125, 0, v125
    v_mul_f32 v125, 0x3db504f3, v125
    v_cvt_pk_bf16_f32 v125, 0, v125
    v_max_f32 v13, v13, v125
    buffer_load_dwordx4 a[212:215], v4, s[8:11], s56 offen offset:2048 nt
    s_add_u32 s59, s54, 2560
    buffer_load_dwordx4 a[220:223], v8, s[20:23], s59 offen offset:0
    buffer_load_dwordx4 a[228:231], v4, s[8:11], s56 offen offset:3072 nt
    s_add_u32 s56, s51, 442368
    buffer_load_dwordx4 a[236:239], v4, s[8:11], s56 offen offset:0 nt
    buffer_load_dwordx4 a[244:247], v4, s[8:11], s56 offen offset:1024 nt
    s_waitcnt vmcnt(21)
    v_mfma_f32_16x16x32_bf16 v[76:79], a[76:79], v[48:51], 0
    s_waitcnt vmcnt(20)
    v_mfma_f32_16x16x32_bf16 v[76:79], a[84:87], v[52:55], v[76:79]
    s_waitcnt vmcnt(18)
    v_mfma_f32_16x16x32_bf16 v[76:79], a[100:103], v[56:59], v[76:79]
    s_waitcnt vmcnt(17)
    v_mfma_f32_16x16x32_bf16 v[76:79], a[108:111], v[60:63], v[76:79]
    v_mov_b32_dpp v126, v72 quad_perm:[0,0,0,0] row_mask:0xf bank_mask:0xf
    v_add_f32_dpp v126, v73, v126 quad_perm:[1,1,1,1] row_mask:0xf bank_mask:0xf
    v_add_f32_dpp v126, v74, v126 quad_perm:[2,2,2,2] row_mask:0xf bank_mask:0xf
    v_add_f32_dpp v126, v75, v126 quad_perm:[3,3,3,3] row_mask:0xf bank_mask:0xf
    v_cvt_pk_bf16_f32 v126, 0, v126
    v_mul_f32 v126, 0x3db504f3, v126
    v_cvt_pk_bf16_f32 v126, 0, v126
    v_max_f32 v13, v13, v126
    buffer_load_dwordx4 a[252:255], v4, s[8:11], s56 offen offset:2048 nt
    buffer_load_dwordx4 v[160:163], v8, s[20:23], s59 offen offset:256
    buffer_load_dwordx4 v[168:171], v4, s[8:11], s56 offen offset:3072 nt
    s_add_u32 s56, s51, 458752
    buffer_load_dwordx4 v[176:179], v4, s[8:11], s56 offen offset:0 nt
    buffer_load_dwordx4 v[184:187], v4, s[8:11], s56 offen offset:1024 nt
    s_waitcnt vmcnt(21)
    v_mfma_f32_16x16x32_bf16 v[72:75], a[116:119], v[48:51], 0
    s_waitcnt vmcnt(20)
    v_mfma_f32_16x16x32_bf16 v[72:75], a[124:127], v[52:55], v[72:75]
    s_waitcnt vmcnt(18)
    v_mfma_f32_16x16x32_bf16 v[72:75], a[140:143], v[56:59], v[72:75]
    s_waitcnt vmcnt(17)
    v_mfma_f32_16x16x32_bf16 v[72:75], a[148:151], v[60:63], v[72:75]
    v_mov_b32_dpp v127, v76 quad_perm:[0,0,0,0] row_mask:0xf bank_mask:0xf
    v_add_f32_dpp v127, v77, v127 quad_perm:[1,1,1,1] row_mask:0xf bank_mask:0xf
    v_add_f32_dpp v127, v78, v127 quad_perm:[2,2,2,2] row_mask:0xf bank_mask:0xf
    v_add_f32_dpp v127, v79, v127 quad_perm:[3,3,3,3] row_mask:0xf bank_mask:0xf
    v_cvt_pk_bf16_f32 v127, 0, v127
    v_mul_f32 v127, 0x3db504f3, v127
    v_cvt_pk_bf16_f32 v127, 0, v127
    v_max_f32 v13, v13, v127
    buffer_load_dwordx4 v[192:195], v4, s[8:11], s56 offen offset:2048 nt
    buffer_load_dwordx4 v[200:203], v8, s[20:23], s59 offen offset:512
    buffer_load_dwordx4 v[208:211], v4, s[8:11], s56 offen offset:3072 nt
    s_add_u32 s56, s51, 475136
    buffer_load_dwordx4 v[216:219], v4, s[8:11], s56 offen offset:0 nt
    buffer_load_dwordx4 v[224:227], v4, s[8:11], s56 offen offset:1024 nt
    s_waitcnt vmcnt(21)
    v_mfma_f32_16x16x32_bf16 v[76:79], a[156:159], v[48:51], 0
    s_waitcnt vmcnt(20)
    v_mfma_f32_16x16x32_bf16 v[76:79], a[164:167], v[52:55], v[76:79]
    s_waitcnt vmcnt(19)
    v_mfma_f32_16x16x32_bf16 v[76:79], a[172:175], v[56:59], v[76:79]
    s_waitcnt vmcnt(17)
    v_mfma_f32_16x16x32_bf16 v[76:79], a[188:191], v[60:63], v[76:79]
    v_mov_b32_dpp v128, v72 quad_perm:[0,0,0,0] row_mask:0xf bank_mask:0xf
    v_add_f32_dpp v128, v73, v128 quad_perm:[1,1,1,1] row_mask:0xf bank_mask:0xf
    v_add_f32_dpp v128, v74, v128 quad_perm:[2,2,2,2] row_mask:0xf bank_mask:0xf
    v_add_f32_dpp v128, v75, v128 quad_perm:[3,3,3,3] row_mask:0xf bank_mask:0xf
    v_cvt_pk_bf16_f32 v128, 0, v128
    v_mul_f32 v128, 0x3db504f3, v128
    v_cvt_pk_bf16_f32 v128, 0, v128
    v_max_f32 v13, v13, v128
    buffer_load_dwordx4 v[228:231], v4, s[8:11], s56 offen offset:2048 nt
    buffer_load_dwordx4 v[232:235], v4, s[8:11], s56 offen offset:3072 nt
    buffer_load_dwordx4 v[236:239], v8, s[20:23], s59 offen offset:768
    s_add_u32 s56, s51, 491520
    buffer_load_dwordx4 v[240:243], v4, s[8:11], s56 offen offset:0 nt
    buffer_load_dwordx4 v[244:247], v4, s[8:11], s56 offen offset:1024 nt
    s_waitcnt vmcnt(21)
    v_mfma_f32_16x16x32_bf16 v[72:75], a[196:199], v[48:51], 0
    s_waitcnt vmcnt(20)
    v_mfma_f32_16x16x32_bf16 v[72:75], a[204:207], v[52:55], v[72:75]
    s_waitcnt vmcnt(19)
    v_mfma_f32_16x16x32_bf16 v[72:75], a[212:215], v[56:59], v[72:75]
    s_waitcnt vmcnt(17)
    v_mfma_f32_16x16x32_bf16 v[72:75], a[228:231], v[60:63], v[72:75]
    v_mov_b32_dpp v129, v76 quad_perm:[0,0,0,0] row_mask:0xf bank_mask:0xf
    v_add_f32_dpp v129, v77, v129 quad_perm:[1,1,1,1] row_mask:0xf bank_mask:0xf
    v_add_f32_dpp v129, v78, v129 quad_perm:[2,2,2,2] row_mask:0xf bank_mask:0xf
    v_add_f32_dpp v129, v79, v129 quad_perm:[3,3,3,3] row_mask:0xf bank_mask:0xf
    v_cvt_pk_bf16_f32 v129, 0, v129
    v_mul_f32 v129, 0x3db504f3, v129
    v_cvt_pk_bf16_f32 v129, 0, v129
    v_max_f32 v13, v13, v129
    buffer_load_dwordx4 v[248:251], v4, s[8:11], s56 offen offset:2048 nt
    buffer_load_dwordx4 v[252:255], v4, s[8:11], s56 offen offset:3072 nt
    buffer_load_dwordx4 a[8:11], v8, s[20:23], s59 offen offset:1024
    s_add_u32 s56, s51, 507904
    buffer_load_dwordx4 a[16:19], v4, s[8:11], s56 offen offset:0 nt
    buffer_load_dwordx4 a[24:27], v4, s[8:11], s56 offen offset:1024 nt
    s_waitcnt vmcnt(21)
    v_mfma_f32_16x16x32_bf16 v[76:79], a[236:239], v[48:51], 0
    s_waitcnt vmcnt(20)
    v_mfma_f32_16x16x32_bf16 v[76:79], a[244:247], v[52:55], v[76:79]
    s_waitcnt vmcnt(19)
    v_mfma_f32_16x16x32_bf16 v[76:79], a[252:255], v[56:59], v[76:79]
    s_waitcnt vmcnt(17)
    v_mfma_f32_16x16x32_bf16 v[76:79], v[168:171], v[60:63], v[76:79]
    v_mov_b32_dpp v130, v72 quad_perm:[0,0,0,0] row_mask:0xf bank_mask:0xf
    v_add_f32_dpp v130, v73, v130 quad_perm:[1,1,1,1] row_mask:0xf bank_mask:0xf
    v_add_f32_dpp v130, v74, v130 quad_perm:[2,2,2,2] row_mask:0xf bank_mask:0xf
    v_add_f32_dpp v130, v75, v130 quad_perm:[3,3,3,3] row_mask:0xf bank_mask:0xf
    v_cvt_pk_bf16_f32 v130, 0, v130
    v_mul_f32 v130, 0x3db504f3, v130
    v_cvt_pk_bf16_f32 v130, 0, v130
    v_max_f32 v13, v13, v130
    buffer_load_dwordx4 a[32:35], v4, s[8:11], s56 offen offset:2048 nt
    buffer_load_dwordx4 a[40:43], v4, s[8:11], s56 offen offset:3072 nt
    buffer_load_dwordx4 a[48:51], v8, s[20:23], s59 offen offset:1280
    s_add_u32 s56, s51, 0
    buffer_load_dwordx4 a[56:59], v5, s[12:15], s56 offen offset:0 nt
    buffer_load_dwordx4 a[64:67], v5, s[12:15], s56 offen offset:1024 nt
    s_waitcnt vmcnt(21)
    v_mfma_f32_16x16x32_bf16 v[72:75], v[176:179], v[48:51], 0
    s_waitcnt vmcnt(20)
    v_mfma_f32_16x16x32_bf16 v[72:75], v[184:187], v[52:55], v[72:75]
    s_waitcnt vmcnt(19)
    v_mfma_f32_16x16x32_bf16 v[72:75], v[192:195], v[56:59], v[72:75]
    s_waitcnt vmcnt(17)
    v_mfma_f32_16x16x32_bf16 v[72:75], v[208:211], v[60:63], v[72:75]
    v_mov_b32_dpp v131, v76 quad_perm:[0,0,0,0] row_mask:0xf bank_mask:0xf
    v_add_f32_dpp v131, v77, v131 quad_perm:[1,1,1,1] row_mask:0xf bank_mask:0xf
    v_add_f32_dpp v131, v78, v131 quad_perm:[2,2,2,2] row_mask:0xf bank_mask:0xf
    v_add_f32_dpp v131, v79, v131 quad_perm:[3,3,3,3] row_mask:0xf bank_mask:0xf
    v_cvt_pk_bf16_f32 v131, 0, v131
    v_mul_f32 v131, 0x3db504f3, v131
    v_cvt_pk_bf16_f32 v131, 0, v131
    v_max_f32 v13, v13, v131
    buffer_load_dwordx4 a[72:75], v5, s[12:15], s56 offen offset:2048 nt
    buffer_load_dwordx4 a[80:83], v5, s[12:15], s56 offen offset:3072 nt
    buffer_load_dwordx4 a[88:91], v8, s[20:23], s59 offen offset:1536
    s_add_u32 s56, s51, 16384
    buffer_load_dwordx4 a[96:99], v5, s[12:15], s56 offen offset:0 nt
    s_waitcnt vmcnt(20)
    v_mfma_f32_16x16x32_bf16 v[76:79], v[216:219], v[48:51], 0
    s_waitcnt vmcnt(19)
    v_mfma_f32_16x16x32_bf16 v[76:79], v[224:227], v[52:55], v[76:79]
    s_waitcnt vmcnt(18)
    v_mfma_f32_16x16x32_bf16 v[76:79], v[228:231], v[56:59], v[76:79]
    s_waitcnt vmcnt(17)
    v_mfma_f32_16x16x32_bf16 v[76:79], v[232:235], v[60:63], v[76:79]
    v_mov_b32_dpp v132, v72 quad_perm:[0,0,0,0] row_mask:0xf bank_mask:0xf
    v_add_f32_dpp v132, v73, v132 quad_perm:[1,1,1,1] row_mask:0xf bank_mask:0xf
    v_add_f32_dpp v132, v74, v132 quad_perm:[2,2,2,2] row_mask:0xf bank_mask:0xf
    v_add_f32_dpp v132, v75, v132 quad_perm:[3,3,3,3] row_mask:0xf bank_mask:0xf
    v_cvt_pk_bf16_f32 v132, 0, v132
    v_mul_f32 v132, 0x3db504f3, v132
    v_cvt_pk_bf16_f32 v132, 0, v132
    v_max_f32 v13, v13, v132
    buffer_load_dwordx4 a[104:107], v5, s[12:15], s56 offen offset:1024 nt
    buffer_load_dwordx4 a[112:115], v5, s[12:15], s56 offen offset:2048 nt
    buffer_load_dwordx4 a[120:123], v5, s[12:15], s56 offen offset:3072 nt
    s_add_u32 s56, s51, 32768
    buffer_load_dwordx4 a[136:139], v5, s[12:15], s56 offen offset:0 nt
    buffer_load_dwordx4 a[144:147], v8, s[20:23], s59 offen offset:1792
    s_waitcnt vmcnt(20)
    v_mfma_f32_16x16x32_bf16 v[72:75], v[240:243], v[48:51], 0
    s_waitcnt vmcnt(19)
    v_mfma_f32_16x16x32_bf16 v[72:75], v[244:247], v[52:55], v[72:75]
    s_waitcnt vmcnt(18)
    v_mfma_f32_16x16x32_bf16 v[72:75], v[248:251], v[56:59], v[72:75]
    s_waitcnt vmcnt(17)
    v_mfma_f32_16x16x32_bf16 v[72:75], v[252:255], v[60:63], v[72:75]
    v_mov_b32_dpp v133, v76 quad_perm:[0,0,0,0] row_mask:0xf bank_mask:0xf
    v_add_f32_dpp v133, v77, v133 quad_perm:[1,1,1,1] row_mask:0xf bank_mask:0xf
    v_add_f32_dpp v133, v78, v133 quad_perm:[2,2,2,2] row_mask:0xf bank_mask:0xf
    v_add_f32_dpp v133, v79, v133 quad_perm:[3,3,3,3] row_mask:0xf bank_mask:0xf
    v_cvt_pk_bf16_f32 v133, 0, v133
    v_mul_f32 v133, 0x3db504f3, v133
    v_cvt_pk_bf16_f32 v133, 0, v133
    v_max_f32 v13, v13, v133
    buffer_load_dwordx4 a[152:155], v5, s[12:15], s56 offen offset:1024 nt
    buffer_load_dwordx4 a[160:163], v5, s[12:15], s56 offen offset:2048 nt
    buffer_load_dwordx4 a[168:171], v5, s[12:15], s56 offen offset:3072 nt
    s_add_u32 s56, s51, 49152
    buffer_load_dwordx4 a[184:187], v5, s[12:15], s56 offen offset:0 nt
    buffer_load_dwordx4 a[192:195], v8, s[20:23], s59 offen offset:2048
    s_waitcnt vmcnt(20)
    v_mfma_f32_16x16x32_bf16 v[76:79], a[16:19], v[48:51], 0
    s_waitcnt vmcnt(19)
    v_mfma_f32_16x16x32_bf16 v[76:79], a[24:27], v[52:55], v[76:79]
    s_waitcnt vmcnt(18)
    v_mfma_f32_16x16x32_bf16 v[76:79], a[32:35], v[56:59], v[76:79]
    s_waitcnt vmcnt(17)
    v_mfma_f32_16x16x32_bf16 v[76:79], a[40:43], v[60:63], v[76:79]
    v_mov_b32_dpp v134, v72 quad_perm:[0,0,0,0] row_mask:0xf bank_mask:0xf
    v_add_f32_dpp v134, v73, v134 quad_perm:[1,1,1,1] row_mask:0xf bank_mask:0xf
    v_add_f32_dpp v134, v74, v134 quad_perm:[2,2,2,2] row_mask:0xf bank_mask:0xf
    v_add_f32_dpp v134, v75, v134 quad_perm:[3,3,3,3] row_mask:0xf bank_mask:0xf
    v_cvt_pk_bf16_f32 v134, 0, v134
    v_mul_f32 v134, 0x3db504f3, v134
    v_cvt_pk_bf16_f32 v134, 0, v134
    v_max_f32 v13, v13, v134
    v_mov_b32_dpp v135, v76 quad_perm:[0,0,0,0] row_mask:0xf bank_mask:0xf
    v_add_f32_dpp v135, v77, v135 quad_perm:[1,1,1,1] row_mask:0xf bank_mask:0xf
    v_add_f32_dpp v135, v78, v135 quad_perm:[2,2,2,2] row_mask:0xf bank_mask:0xf
    v_add_f32_dpp v135, v79, v135 quad_perm:[3,3,3,3] row_mask:0xf bank_mask:0xf
    v_cvt_pk_bf16_f32 v135, 0, v135
    v_mul_f32 v135, 0x3db504f3, v135
    v_cvt_pk_bf16_f32 v135, 0, v135
    v_max_f32 v13, v13, v135
    buffer_load_dwordx4 a[200:203], v5, s[12:15], s56 offen offset:1024 nt
    s_nop 0
    v_max_f32_dpp v13, v13, v13 row_ror:4 row_mask:0xf bank_mask:0xf
    s_nop 1
    v_max_f32_dpp v13, v13, v13 row_ror:8 row_mask:0xf bank_mask:0xf
    s_lshl_b32 s3, s46, 4
    v_lshl_add_u32 v20, v2, 2, s3
    ds_write_b32 v20, v13 offset:8192
    v_lshlrev_b32 v12, 2, v3
    s_waitcnt lgkmcnt(0)
    s_barrier
    ds_read_b32 v13, v12 offset:8192
    s_waitcnt lgkmcnt(0)
    v_max_f32_dpp v13, v13, v13 quad_perm:[1,0,3,2] row_mask:0xf bank_mask:0xf
    s_nop 1
    v_max_f32_dpp v13, v13, v13 quad_perm:[2,3,0,1] row_mask:0xf bank_mask:0xf
    s_nop 1
    v_max_f32_dpp v13, v13, v13 row_half_mirror row_mask:0xf bank_mask:0xf
    s_nop 1
    v_max_f32_dpp v13, v13, v13 row_mirror row_mask:0xf bank_mask:0xf
    v_mul_f32 v14, s60, v13
    buffer_load_dwordx4 a[208:211], v5, s[12:15], s56 offen offset:2048 nt
    v_fma_f32 v104, v104, s60, -v14
    v_exp_f32 v104, v104
    s_nop 0
    v_add_f32 v15, v15, v104
    v_cvt_pk_bf16_f32 v104, v104, v104
    v_fma_f32 v105, v105, s60, -v14
    v_exp_f32 v105, v105
    s_nop 0
    v_add_f32 v15, v15, v105
    v_cvt_pk_bf16_f32 v105, v105, v105
    v_and_b32_dpp v44, v104, v28 row_newbcast:0 row_mask:0xf bank_mask:0xf
    v_and_b32_dpp v45, v104, v29 row_newbcast:0 row_mask:0xf bank_mask:0xf
    v_and_b32_dpp v46, v104, v30 row_newbcast:0 row_mask:0xf bank_mask:0xf
    v_and_b32_dpp v47, v104, v31 row_newbcast:0 row_mask:0xf bank_mask:0xf
    s_waitcnt vmcnt(17)
    s_nop 0
    v_mfma_f32_16x16x32_bf16 v[80:83], v[44:47], a[56:59], 0
    buffer_load_dwordx4 a[224:227], v5, s[12:15], s56 offen offset:3072 nt
    v_and_b32_dpp v40, v104, v28 row_newbcast:4 row_mask:0xf bank_mask:0xf
    v_and_b32_dpp v41, v104, v29 row_newbcast:4 row_mask:0xf bank_mask:0xf
    v_and_b32_dpp v42, v104, v30 row_newbcast:4 row_mask:0xf bank_mask:0xf
    v_and_b32_dpp v43, v104, v31 row_newbcast:4 row_mask:0xf bank_mask:0xf
    s_waitcnt vmcnt(17)
    s_nop 0
    v_mfma_f32_16x16x32_bf16 v[80:83], v[40:43], a[64:67], v[80:83]
    s_add_u32 s56, s51, 65536
    buffer_load_dwordx4 a[232:235], v5, s[12:15], s56 offen offset:0 nt
    v_and_b32_dpp v44, v104, v28 row_newbcast:8 row_mask:0xf bank_mask:0xf
    v_and_b32_dpp v45, v104, v29 row_newbcast:8 row_mask:0xf bank_mask:0xf
    v_and_b32_dpp v46, v104, v30 row_newbcast:8 row_mask:0xf bank_mask:0xf
    v_and_b32_dpp v47, v104, v31 row_newbcast:8 row_mask:0xf bank_mask:0xf
    s_waitcnt vmcnt(17)
    s_nop 0
    v_mfma_f32_16x16x32_bf16 v[80:83], v[44:47], a[72:75], v[80:83]
    buffer_load_dwordx4 a[240:243], v8, s[20:23], s59 offen offset:2304
    v_and_b32_dpp v40, v104, v28 row_newbcast:12 row_mask:0xf bank_mask:0xf
    v_and_b32_dpp v41, v104, v29 row_newbcast:12 row_mask:0xf bank_mask:0xf
    v_and_b32_dpp v42, v104, v30 row_newbcast:12 row_mask:0xf bank_mask:0xf
    v_and_b32_dpp v43, v104, v31 row_newbcast:12 row_mask:0xf bank_mask:0xf
    s_waitcnt vmcnt(17)
    s_nop 0
    v_mfma_f32_16x16x32_bf16 v[80:83], v[40:43], a[80:83], v[80:83]
    buffer_load_dwordx4 a[248:251], v5, s[12:15], s56 offen offset:1024 nt
    buffer_load_dwordx4 v[164:167], v5, s[12:15], s56 offen offset:2048 nt
    v_fma_f32 v106, v106, s60, -v14
    v_exp_f32 v106, v106
    s_nop 0
    v_add_f32 v15, v15, v106
    v_cvt_pk_bf16_f32 v106, v106, v106
    v_fma_f32 v107, v107, s60, -v14
    v_exp_f32 v107, v107
    s_nop 0
    v_add_f32 v15, v15, v107
    v_cvt_pk_bf16_f32 v107, v107, v107
    v_and_b32_dpp v44, v105, v28 row_newbcast:0 row_mask:0xf bank_mask:0xf
    v_and_b32_dpp v45, v105, v29 row_newbcast:0 row_mask:0xf bank_mask:0xf
    v_and_b32_dpp v46, v105, v30 row_newbcast:0 row_mask:0xf bank_mask:0xf
    v_and_b32_dpp v47, v105, v31 row_newbcast:0 row_mask:0xf bank_mask:0xf
    s_waitcnt vmcnt(17)
    s_nop 0
    v_mfma_f32_16x16x32_bf16 v[80:83], v[44:47], a[96:99], v[80:83]
    buffer_load_dwordx4 v[172:175], v5, s[12:15], s56 offen offset:3072 nt
    v_and_b32_dpp v40, v105, v28 row_newbcast:4 row_mask:0xf bank_mask:0xf
    v_and_b32_dpp v41, v105, v29 row_newbcast:4 row_mask:0xf bank_mask:0xf
    v_and_b32_dpp v42, v105, v30 row_newbcast:4 row_mask:0xf bank_mask:0xf
    v_and_b32_dpp v43, v105, v31 row_newbcast:4 row_mask:0xf bank_mask:0xf
    s_waitcnt vmcnt(17)
    s_nop 0
    v_mfma_f32_16x16x32_bf16 v[80:83], v[40:43], a[104:107], v[80:83]
    s_add_u32 s56, s51, 81920
    buffer_load_dwordx4 v[180:183], v5, s[12:15], s56 offen offset:0 nt
    v_and_b32_dpp v44, v105, v28 row_newbcast:8 row_mask:0xf bank_mask:0xf
    v_and_b32_dpp v45, v105, v29 row_newbcast:8 row_mask:0xf bank_mask:0xf
    v_and_b32_dpp v46, v105, v30 row_newbcast:8 row_mask:0xf bank_mask:0xf
    v_and_b32_dpp v47, v105, v31 row_newbcast:8 row_mask:0xf bank_mask:0xf
    s_waitcnt vmcnt(17)
    s_nop 0
    v_mfma_f32_16x16x32_bf16 v[80:83], v[44:47], a[112:115], v[80:83]
    s_add_u32 s59, s54, 5120
    buffer_load_dwordx4 v[188:191], v8, s[20:23], s59 offen offset:0
    v_and_b32_dpp v40, v105, v28 row_newbcast:12 row_mask:0xf bank_mask:0xf
    v_and_b32_dpp v41, v105, v29 row_newbcast:12 row_mask:0xf bank_mask:0xf
    v_and_b32_dpp v42, v105, v30 row_newbcast:12 row_mask:0xf bank_mask:0xf
    v_and_b32_dpp v43, v105, v31 row_newbcast:12 row_mask:0xf bank_mask:0xf
    s_waitcnt vmcnt(17)
    s_nop 0
    v_mfma_f32_16x16x32_bf16 v[80:83], v[40:43], a[120:123], v[80:83]
    buffer_load_dwordx4 v[204:207], v5, s[12:15], s56 offen offset:1024 nt
    v_fma_f32 v108, v108, s60, -v14
    v_exp_f32 v108, v108
    s_nop 0
    v_add_f32 v15, v15, v108
    v_cvt_pk_bf16_f32 v108, v108, v108
    v_fma_f32 v109, v109, s60, -v14
    v_exp_f32 v109, v109
    s_nop 0
    v_add_f32 v15, v15, v109
    v_cvt_pk_bf16_f32 v109, v109, v109
    v_and_b32_dpp v44, v106, v28 row_newbcast:0 row_mask:0xf bank_mask:0xf
    v_and_b32_dpp v45, v106, v29 row_newbcast:0 row_mask:0xf bank_mask:0xf
    v_and_b32_dpp v46, v106, v30 row_newbcast:0 row_mask:0xf bank_mask:0xf
    v_and_b32_dpp v47, v106, v31 row_newbcast:0 row_mask:0xf bank_mask:0xf
    s_waitcnt vmcnt(17)
    s_nop 0
    v_mfma_f32_16x16x32_bf16 v[80:83], v[44:47], a[136:139], v[80:83]
    buffer_load_dwordx4 v[212:215], v5, s[12:15], s56 offen offset:2048 nt
    buffer_load_dwordx4 v[220:223], v5, s[12:15], s56 offen offset:3072 nt
    v_and_b32_dpp v40, v106, v28 row_newbcast:4 row_mask:0xf bank_mask:0xf
    v_and_b32_dpp v41, v106, v29 row_newbcast:4 row_mask:0xf bank_mask:0xf
    v_and_b32_dpp v42, v106, v30 row_newbcast:4 row_mask:0xf bank_mask:0xf
    v_and_b32_dpp v43, v106, v31 row_newbcast:4 row_mask:0xf bank_mask:0xf
    s_waitcnt vmcnt(17)
    s_nop 0
    v_mfma_f32_16x16x32_bf16 v[80:83], v[40:43], a[152:155], v[80:83]
    s_add_u32 s56, s51, 98304
    buffer_load_dwordx4 a[0:3], v5, s[12:15], s56 offen offset:0 nt
    v_and_b32_dpp v44, v106, v28 row_newbcast:8 row_mask:0xf bank_mask:0xf
    v_and_b32_dpp v45, v106, v29 row_newbcast:8 row_mask:0xf bank_mask:0xf
    v_and_b32_dpp v46, v106, v30 row_newbcast:8 row_mask:0xf bank_mask:0xf
    v_and_b32_dpp v47, v106, v31 row_newbcast:8 row_mask:0xf bank_mask:0xf
    s_waitcnt vmcnt(17)
    s_nop 0
    v_mfma_f32_16x16x32_bf16 v[80:83], v[44:47], a[160:163], v[80:83]
    buffer_load_dwordx4 a[4:7], v5, s[12:15], s56 offen offset:1024 nt
    v_and_b32_dpp v40, v106, v28 row_newbcast:12 row_mask:0xf bank_mask:0xf
    v_and_b32_dpp v41, v106, v29 row_newbcast:12 row_mask:0xf bank_mask:0xf
    v_and_b32_dpp v42, v106, v30 row_newbcast:12 row_mask:0xf bank_mask:0xf
    v_and_b32_dpp v43, v106, v31 row_newbcast:12 row_mask:0xf bank_mask:0xf
    s_waitcnt vmcnt(17)
    s_nop 0
    v_mfma_f32_16x16x32_bf16 v[80:83], v[40:43], a[168:171], v[80:83]
    buffer_load_dwordx4 a[20:23], v8, s[20:23], s59 offen offset:256
    v_fma_f32 v110, v110, s60, -v14
    v_exp_f32 v110, v110
    s_nop 0
    v_add_f32 v15, v15, v110
    v_cvt_pk_bf16_f32 v110, v110, v110
    v_fma_f32 v111, v111, s60, -v14
    v_exp_f32 v111, v111
    s_nop 0
    v_add_f32 v15, v15, v111
    v_cvt_pk_bf16_f32 v111, v111, v111
    v_and_b32_dpp v44, v107, v28 row_newbcast:0 row_mask:0xf bank_mask:0xf
    v_and_b32_dpp v45, v107, v29 row_newbcast:0 row_mask:0xf bank_mask:0xf
    v_and_b32_dpp v46, v107, v30 row_newbcast:0 row_mask:0xf bank_mask:0xf
    v_and_b32_dpp v47, v107, v31 row_newbcast:0 row_mask:0xf bank_mask:0xf
    s_waitcnt vmcnt(17)
    s_nop 0
    v_mfma_f32_16x16x32_bf16 v[80:83], v[44:47], a[184:187], v[80:83]
    buffer_load_dwordx4 a[28:31], v5, s[12:15], s56 offen offset:2048 nt
    buffer_load_dwordx4 a[36:39], v5, s[12:15], s56 offen offset:3072 nt
    v_and_b32_dpp v40, v107, v28 row_newbcast:4 row_mask:0xf bank_mask:0xf
    v_and_b32_dpp v41, v107, v29 row_newbcast:4 row_mask:0xf bank_mask:0xf
    v_and_b32_dpp v42, v107, v30 row_newbcast:4 row_mask:0xf bank_mask:0xf
    v_and_b32_dpp v43, v107, v31 row_newbcast:4 row_mask:0xf bank_mask:0xf
    s_waitcnt vmcnt(17)
    s_nop 0
    v_mfma_f32_16x16x32_bf16 v[80:83], v[40:43], a[200:203], v[80:83]
    s_add_u32 s56, s51, 114688
    buffer_load_dwordx4 a[44:47], v5, s[12:15], s56 offen offset:0 nt
    v_and_b32_dpp v44, v107, v28 row_newbcast:8 row_mask:0xf bank_mask:0xf
    v_and_b32_dpp v45, v107, v29 row_newbcast:8 row_mask:0xf bank_mask:0xf
    v_and_b32_dpp v46, v107, v30 row_newbcast:8 row_mask:0xf bank_mask:0xf
    v_and_b32_dpp v47, v107, v31 row_newbcast:8 row_mask:0xf bank_mask:0xf
    s_waitcnt vmcnt(17)
    s_nop 0
    v_mfma_f32_16x16x32_bf16 v[80:83], v[44:47], a[208:211], v[80:83]
    buffer_load_dwordx4 a[60:63], v5, s[12:15], s56 offen offset:1024 nt
    v_and_b32_dpp v40, v107, v28 row_newbcast:12 row_mask:0xf bank_mask:0xf
    v_and_b32_dpp v41, v107, v29 row_newbcast:12 row_mask:0xf bank_mask:0xf
    v_and_b32_dpp v42, v107, v30 row_newbcast:12 row_mask:0xf bank_mask:0xf
    v_and_b32_dpp v43, v107, v31 row_newbcast:12 row_mask:0xf bank_mask:0xf
    s_waitcnt vmcnt(17)
    s_nop 0
    v_mfma_f32_16x16x32_bf16 v[80:83], v[40:43], a[224:227], v[80:83]
    buffer_load_dwordx4 a[68:71], v8, s[20:23], s59 offen offset:512
    v_fma_f32 v112, v112, s60, -v14
    v_exp_f32 v112, v112
    s_nop 0
    v_add_f32 v15, v15, v112
    v_cvt_pk_bf16_f32 v112, v112, v112
    v_fma_f32 v113, v113, s60, -v14
    v_exp_f32 v113, v113
    s_nop 0
    v_add_f32 v15, v15, v113
    v_cvt_pk_bf16_f32 v113, v113, v113
    v_and_b32_dpp v44, v108, v28 row_newbcast:0 row_mask:0xf bank_mask:0xf
    v_and_b32_dpp v45, v108, v29 row_newbcast:0 row_mask:0xf bank_mask:0xf
    v_and_b32_dpp v46, v108, v30 row_newbcast:0 row_mask:0xf bank_mask:0xf
    v_and_b32_dpp v47, v108, v31 row_newbcast:0 row_mask:0xf bank_mask:0xf
    s_waitcnt vmcnt(17)
    s_nop 0
    v_mfma_f32_16x16x32_bf16 v[80:83], v[44:47], a[232:235], v[80:83]
    buffer_load_dwordx4 a[76:79], v5, s[12:15], s56 offen offset:2048 nt
    buffer_load_dwordx4 a[84:87], v5, s[12:15], s56 offen offset:3072 nt
    v_and_b32_dpp v40, v108, v28 row_newbcast:4 row_mask:0xf bank_mask:0xf
    v_and_b32_dpp v41, v108, v29 row_newbcast:4 row_mask:0xf bank_mask:0xf
    v_and_b32_dpp v42, v108, v30 row_newbcast:4 row_mask:0xf bank_mask:0xf
    v_and_b32_dpp v43, v108, v31 row_newbcast:4 row_mask:0xf bank_mask:0xf
    s_waitcnt vmcnt(17)
    s_nop 0
    v_mfma_f32_16x16x32_bf16 v[80:83], v[40:43], a[248:251], v[80:83]
    s_add_u32 s56, s51, 131072
    buffer_load_dwordx4 a[100:103], v5, s[12:15], s56 offen offset:0 nt
    v_and_b32_dpp v44, v108, v28 row_newbcast:8 row_mask:0xf bank_mask:0xf
    v_and_b32_dpp v45, v108, v29 row_newbcast:8 row_mask:0xf bank_mask:0xf
    v_and_b32_dpp v46, v108, v30 row_newbcast:8 row_mask:0xf bank_mask:0xf
    v_and_b32_dpp v47, v108, v31 row_newbcast:8 row_mask:0xf bank_mask:0xf
    s_waitcnt vmcnt(17)
    s_nop 0
    v_mfma_f32_16x16x32_bf16 v[80:83], v[44:47], v[164:167], v[80:83]
    buffer_load_dwordx4 a[108:111], v5, s[12:15], s56 offen offset:1024 nt
    v_and_b32_dpp v40, v108, v28 row_newbcast:12 row_mask:0xf bank_mask:0xf
    v_and_b32_dpp v41, v108, v29 row_newbcast:12 row_mask:0xf bank_mask:0xf
    v_and_b32_dpp v42, v108, v30 row_newbcast:12 row_mask:0xf bank_mask:0xf
    v_and_b32_dpp v43, v108, v31 row_newbcast:12 row_mask:0xf bank_mask:0xf
    s_waitcnt vmcnt(17)
    s_nop 0
    v_mfma_f32_16x16x32_bf16 v[80:83], v[40:43], v[172:175], v[80:83]
    buffer_load_dwordx4 a[116:119], v8, s[20:23], s59 offen offset:768
    v_fma_f32 v114, v114, s60, -v14
    v_exp_f32 v114, v114
    s_nop 0
    v_add_f32 v15, v15, v114
    v_cvt_pk_bf16_f32 v114, v114, v114
    v_fma_f32 v115, v115, s60, -v14
    v_exp_f32 v115, v115
    s_nop 0
    v_add_f32 v15, v15, v115
    v_cvt_pk_bf16_f32 v115, v115, v115
    v_and_b32_dpp v44, v109, v28 row_newbcast:0 row_mask:0xf bank_mask:0xf
    v_and_b32_dpp v45, v109, v29 row_newbcast:0 row_mask:0xf bank_mask:0xf
    v_and_b32_dpp v46, v109, v30 row_newbcast:0 row_mask:0xf bank_mask:0xf
    v_and_b32_dpp v47, v109, v31 row_newbcast:0 row_mask:0xf bank_mask:0xf
    s_waitcnt vmcnt(17)
    s_nop 0
    v_mfma_f32_16x16x32_bf16 v[80:83], v[44:47], v[180:183], v[80:83]
    buffer_load_dwordx4 a[124:127], v5, s[12:15], s56 offen offset:2048 nt
    buffer_load_dwordx4 a[140:143], v5, s[12:15], s56 offen offset:3072 nt
    v_and_b32_dpp v40, v109, v28 row_newbcast:4 row_mask:0xf bank_mask:0xf
    v_and_b32_dpp v41, v109, v29 row_newbcast:4 row_mask:0xf bank_mask:0xf
    v_and_b32_dpp v42, v109, v30 row_newbcast:4 row_mask:0xf bank_mask:0xf
    v_and_b32_dpp v43, v109, v31 row_newbcast:4 row_mask:0xf bank_mask:0xf
    s_waitcnt vmcnt(17)
    s_nop 0
    v_mfma_f32_16x16x32_bf16 v[80:83], v[40:43], v[204:207], v[80:83]
    s_add_u32 s56, s51, 147456
    buffer_load_dwordx4 a[148:151], v5, s[12:15], s56 offen offset:0 nt
    v_and_b32_dpp v44, v109, v28 row_newbcast:8 row_mask:0xf bank_mask:0xf
    v_and_b32_dpp v45, v109, v29 row_newbcast:8 row_mask:0xf bank_mask:0xf
    v_and_b32_dpp v46, v109, v30 row_newbcast:8 row_mask:0xf bank_mask:0xf
    v_and_b32_dpp v47, v109, v31 row_newbcast:8 row_mask:0xf bank_mask:0xf
    s_waitcnt vmcnt(17)
    s_nop 0
    v_mfma_f32_16x16x32_bf16 v[80:83], v[44:47], v[212:215], v[80:83]
    buffer_load_dwordx4 a[156:159], v5, s[12:15], s56 offen offset:1024 nt
    v_and_b32_dpp v40, v109, v28 row_newbcast:12 row_mask:0xf bank_mask:0xf
    v_and_b32_dpp v41, v109, v29 row_newbcast:12 row_mask:0xf bank_mask:0xf
    v_and_b32_dpp v42, v109, v30 row_newbcast:12 row_mask:0xf bank_mask:0xf
    v_and_b32_dpp v43, v109, v31 row_newbcast:12 row_mask:0xf bank_mask:0xf
    s_waitcnt vmcnt(17)
    s_nop 0
    v_mfma_f32_16x16x32_bf16 v[80:83], v[40:43], v[220:223], v[80:83]
    buffer_load_dwordx4 a[164:167], v8, s[20:23], s59 offen offset:1024
    v_fma_f32 v116, v116, s60, -v14
    v_exp_f32 v116, v116
    s_nop 0
    v_add_f32 v15, v15, v116
    v_cvt_pk_bf16_f32 v116, v116, v116
    v_fma_f32 v117, v117, s60, -v14
    v_exp_f32 v117, v117
    s_nop 0
    v_add_f32 v15, v15, v117
    v_cvt_pk_bf16_f32 v117, v117, v117
    v_and_b32_dpp v44, v110, v28 row_newbcast:0 row_mask:0xf bank_mask:0xf
    v_and_b32_dpp v45, v110, v29 row_newbcast:0 row_mask:0xf bank_mask:0xf
    v_and_b32_dpp v46, v110, v30 row_newbcast:0 row_mask:0xf bank_mask:0xf
    v_and_b32_dpp v47, v110, v31 row_newbcast:0 row_mask:0xf bank_mask:0xf
    s_waitcnt vmcnt(17)
    s_nop 0
    v_mfma_f32_16x16x32_bf16 v[80:83], v[44:47], a[0:3], v[80:83]
    buffer_load_dwordx4 a[172:175], v5, s[12:15], s56 offen offset:2048 nt
    v_and_b32_dpp v40, v110, v28 row_newbcast:4 row_mask:0xf bank_mask:0xf
    v_and_b32_dpp v41, v110, v29 row_newbcast:4 row_mask:0xf bank_mask:0xf
    v_and_b32_dpp v42, v110, v30 row_newbcast:4 row_mask:0xf bank_mask:0xf
    v_and_b32_dpp v43, v110, v31 row_newbcast:4 row_mask:0xf bank_mask:0xf
    s_waitcnt vmcnt(17)
    s_nop 0
    v_mfma_f32_16x16x32_bf16 v[80:83], v[40:43], a[4:7], v[80:83]
    buffer_load_dwordx4 a[188:191], v5, s[12:15], s56 offen offset:3072 nt
    s_add_u32 s56, s51, 163840
    buffer_load_dwordx4 a[196:199], v5, s[12:15], s56 offen offset:0 nt
    v_and_b32_dpp v44, v110, v28 row_newbcast:8 row_mask:0xf bank_mask:0xf
    v_and_b32_dpp v45, v110, v29 row_newbcast:8 row_mask:0xf bank_mask:0xf
    v_and_b32_dpp v46, v110, v30 row_newbcast:8 row_mask:0xf bank_mask:0xf
    v_and_b32_dpp v47, v110, v31 row_newbcast:8 row_mask:0xf bank_mask:0xf
    s_waitcnt vmcnt(17)
    s_nop 0
    v_mfma_f32_16x16x32_bf16 v[80:83], v[44:47], a[28:31], v[80:83]
    buffer_load_dwordx4 a[204:207], v5, s[12:15], s56 offen offset:1024 nt
    v_and_b32_dpp v40, v110, v28 row_newbcast:12 row_mask:0xf bank_mask:0xf
    v_and_b32_dpp v41, v110, v29 row_newbcast:12 row_mask:0xf bank_mask:0xf
    v_and_b32_dpp v42, v110, v30 row_newbcast:12 row_mask:0xf bank_mask:0xf
    v_and_b32_dpp v43, v110, v31 row_newbcast:12 row_mask:0xf bank_mask:0xf
    s_waitcnt vmcnt(17)
    s_nop 0
    v_mfma_f32_16x16x32_bf16 v[80:83], v[40:43], a[36:39], v[80:83]
    buffer_load_dwordx4 a[212:215], v5, s[12:15], s56 offen offset:2048 nt
    v_fma_f32 v118, v118, s60, -v14
    v_exp_f32 v118, v118
    s_nop 0
    v_add_f32 v15, v15, v118
    v_cvt_pk_bf16_f32 v118, v118, v118
    v_fma_f32 v119, v119, s60, -v14
    v_exp_f32 v119, v119
    s_nop 0
    v_add_f32 v15, v15, v119
    v_cvt_pk_bf16_f32 v119, v119, v119
    v_and_b32_dpp v44, v111, v28 row_newbcast:0 row_mask:0xf bank_mask:0xf
    v_and_b32_dpp v45, v111, v29 row_newbcast:0 row_mask:0xf bank_mask:0xf
    v_and_b32_dpp v46, v111, v30 row_newbcast:0 row_mask:0xf bank_mask:0xf
    v_and_b32_dpp v47, v111, v31 row_newbcast:0 row_mask:0xf bank_mask:0xf
    s_waitcnt vmcnt(17)
    s_nop 0
    v_mfma_f32_16x16x32_bf16 v[80:83], v[44:47], a[44:47], v[80:83]
    buffer_load_dwordx4 a[228:231], v8, s[20:23], s59 offen offset:1280
    v_and_b32_dpp v40, v111, v28 row_newbcast:4 row_mask:0xf bank_mask:0xf
    v_and_b32_dpp v41, v111, v29 row_newbcast:4 row_mask:0xf bank_mask:0xf
    v_and_b32_dpp v42, v111, v30 row_newbcast:4 row_mask:0xf bank_mask:0xf
    v_and_b32_dpp v43, v111, v31 row_newbcast:4 row_mask:0xf bank_mask:0xf
    s_waitcnt vmcnt(17)
    s_nop 0
    v_mfma_f32_16x16x32_bf16 v[80:83], v[40:43], a[60:63], v[80:83]
    buffer_load_dwordx4 a[236:239], v5, s[12:15], s56 offen offset:3072 nt
    s_add_u32 s56, s51, 180224
    buffer_load_dwordx4 a[244:247], v5, s[12:15], s56 offen offset:0 nt
    v_and_b32_dpp v44, v111, v28 row_newbcast:8 row_mask:0xf bank_mask:0xf
    v_and_b32_dpp v45, v111, v29 row_newbcast:8 row_mask:0xf bank_mask:0xf
    v_and_b32_dpp v46, v111, v30 row_newbcast:8 row_mask:0xf bank_mask:0xf
    v_and_b32_dpp v47, v111, v31 row_newbcast:8 row_mask:0xf bank_mask:0xf
    s_waitcnt vmcnt(17)
    s_nop 0
    v_mfma_f32_16x16x32_bf16 v[80:83], v[44:47], a[76:79], v[80:83]
    buffer_load_dwordx4 a[252:255], v5, s[12:15], s56 offen offset:1024 nt
    v_and_b32_dpp v40, v111, v28 row_newbcast:12 row_mask:0xf bank_mask:0xf
    v_and_b32_dpp v41, v111, v29 row_newbcast:12 row_mask:0xf bank_mask:0xf
    v_and_b32_dpp v42, v111, v30 row_newbcast:12 row_mask:0xf bank_mask:0xf
    v_and_b32_dpp v43, v111, v31 row_newbcast:12 row_mask:0xf bank_mask:0xf
    s_waitcnt vmcnt(17)
    s_nop 0
    v_mfma_f32_16x16x32_bf16 v[80:83], v[40:43], a[84:87], v[80:83]
    buffer_load_dwordx4 v[168:171], v5, s[12:15], s56 offen offset:2048 nt
    v_fma_f32 v120, v120, s60, -v14
    v_exp_f32 v120, v120
    s_nop 0
    v_add_f32 v15, v15, v120
    v_cvt_pk_bf16_f32 v120, v120, v120
    v_fma_f32 v121, v121, s60, -v14
    v_exp_f32 v121, v121
    s_nop 0
    v_add_f32 v15, v15, v121
    v_cvt_pk_bf16_f32 v121, v121, v121
    v_and_b32_dpp v44, v112, v28 row_newbcast:0 row_mask:0xf bank_mask:0xf
    v_and_b32_dpp v45, v112, v29 row_newbcast:0 row_mask:0xf bank_mask:0xf
    v_and_b32_dpp v46, v112, v30 row_newbcast:0 row_mask:0xf bank_mask:0xf
    v_and_b32_dpp v47, v112, v31 row_newbcast:0 row_mask:0xf bank_mask:0xf
    s_waitcnt vmcnt(17)
    s_nop 0
    v_mfma_f32_16x16x32_bf16 v[80:83], v[44:47], a[100:103], v[80:83]
    buffer_load_dwordx4 v[176:179], v8, s[20:23], s59 offen offset:1536
    v_and_b32_dpp v40, v112, v28 row_newbcast:4 row_mask:0xf bank_mask:0xf
    v_and_b32_dpp v41, v112, v29 row_newbcast:4 row_mask:0xf bank_mask:0xf
    v_and_b32_dpp v42, v112, v30 row_newbcast:4 row_mask:0xf bank_mask:0xf
    v_and_b32_dpp v43, v112, v31 row_newbcast:4 row_mask:0xf bank_mask:0xf
    s_waitcnt vmcnt(17)
    s_nop 0
    v_mfma_f32_16x16x32_bf16 v[80:83], v[40:43], a[108:111], v[80:83]
    buffer_load_dwordx4 v[184:187], v5, s[12:15], s56 offen offset:3072 nt
    s_add_u32 s56, s51, 196608
    buffer_load_dwordx4 v[192:195], v5, s[12:15], s56 offen offset:0 nt
    v_and_b32_dpp v44, v112, v28 row_newbcast:8 row_mask:0xf bank_mask:0xf
    v_and_b32_dpp v45, v112, v29 row_newbcast:8 row_mask:0xf bank_mask:0xf
    v_and_b32_dpp v46, v112, v30 row_newbcast:8 row_mask:0xf bank_mask:0xf
    v_and_b32_dpp v47, v112, v31 row_newbcast:8 row_mask:0xf bank_mask:0xf
    s_waitcnt vmcnt(17)
    s_nop 0
    v_mfma_f32_16x16x32_bf16 v[80:83], v[44:47], a[124:127], v[80:83]
    buffer_load_dwordx4 v[208:211], v5, s[12:15], s56 offen offset:1024 nt
    v_and_b32_dpp v40, v112, v28 row_newbcast:12 row_mask:0xf bank_mask:0xf
    v_and_b32_dpp v41, v112, v29 row_newbcast:12 row_mask:0xf bank_mask:0xf
    v_and_b32_dpp v42, v112, v30 row_newbcast:12 row_mask:0xf bank_mask:0xf
    v_and_b32_dpp v43, v112, v31 row_newbcast:12 row_mask:0xf bank_mask:0xf
    s_waitcnt vmcnt(17)
    s_nop 0
    v_mfma_f32_16x16x32_bf16 v[80:83], v[40:43], a[140:143], v[80:83]
    buffer_load_dwordx4 v[216:219], v5, s[12:15], s56 offen offset:2048 nt
    v_fma_f32 v122, v122, s60, -v14
    v_exp_f32 v122, v122
    s_nop 0
    v_add_f32 v15, v15, v122
    v_cvt_pk_bf16_f32 v122, v122, v122
    v_fma_f32 v123, v123, s60, -v14
    v_exp_f32 v123, v123
    s_nop 0
    v_add_f32 v15, v15, v123
    v_cvt_pk_bf16_f32 v123, v123, v123
    v_and_b32_dpp v44, v113, v28 row_newbcast:0 row_mask:0xf bank_mask:0xf
    v_and_b32_dpp v45, v113, v29 row_newbcast:0 row_mask:0xf bank_mask:0xf
    v_and_b32_dpp v46, v113, v30 row_newbcast:0 row_mask:0xf bank_mask:0xf
    v_and_b32_dpp v47, v113, v31 row_newbcast:0 row_mask:0xf bank_mask:0xf
    s_waitcnt vmcnt(17)
    s_nop 0
    v_mfma_f32_16x16x32_bf16 v[80:83], v[44:47], a[148:151], v[80:83]
    buffer_load_dwordx4 v[224:227], v8, s[20:23], s59 offen offset:1792
    v_and_b32_dpp v40, v113, v28 row_newbcast:4 row_mask:0xf bank_mask:0xf
    v_and_b32_dpp v41, v113, v29 row_newbcast:4 row_mask:0xf bank_mask:0xf
    v_and_b32_dpp v42, v113, v30 row_newbcast:4 row_mask:0xf bank_mask:0xf
    v_and_b32_dpp v43, v113, v31 row_newbcast:4 row_mask:0xf bank_mask:0xf
    s_waitcnt vmcnt(17)
    s_nop 0
    v_mfma_f32_16x16x32_bf16 v[80:83], v[40:43], a[156:159], v[80:83]
    buffer_load_dwordx4 v[228:231], v5, s[12:15], s56 offen offset:3072 nt
    s_add_u32 s56, s51, 212992
    buffer_load_dwordx4 v[232:235], v5, s[12:15], s56 offen offset:0 nt
    v_and_b32_dpp v44, v113, v28 row_newbcast:8 row_mask:0xf bank_mask:0xf
    v_and_b32_dpp v45, v113, v29 row_newbcast:8 row_mask:0xf bank_mask:0xf
    v_and_b32_dpp v46, v113, v30 row_newbcast:8 row_mask:0xf bank_mask:0xf
    v_and_b32_dpp v47, v113, v31 row_newbcast:8 row_mask:0xf bank_mask:0xf
    s_waitcnt vmcnt(17)
    s_nop 0
    v_mfma_f32_16x16x32_bf16 v[80:83], v[44:47], a[172:175], v[80:83]
    buffer_load_dwordx4 v[240:243], v5, s[12:15], s56 offen offset:1024 nt
    v_and_b32_dpp v40, v113, v28 row_newbcast:12 row_mask:0xf bank_mask:0xf
    v_and_b32_dpp v41, v113, v29 row_newbcast:12 row_mask:0xf bank_mask:0xf
    v_and_b32_dpp v42, v113, v30 row_newbcast:12 row_mask:0xf bank_mask:0xf
    v_and_b32_dpp v43, v113, v31 row_newbcast:12 row_mask:0xf bank_mask:0xf
    s_waitcnt vmcnt(17)
    s_nop 0
    v_mfma_f32_16x16x32_bf16 v[80:83], v[40:43], a[188:191], v[80:83]
    buffer_load_dwordx4 v[244:247], v5, s[12:15], s56 offen offset:2048 nt
    v_fma_f32 v124, v124, s60, -v14
    v_exp_f32 v124, v124
    s_nop 0
    v_add_f32 v15, v15, v124
    v_cvt_pk_bf16_f32 v124, v124, v124
    v_fma_f32 v125, v125, s60, -v14
    v_exp_f32 v125, v125
    s_nop 0
    v_add_f32 v15, v15, v125
    v_cvt_pk_bf16_f32 v125, v125, v125
    v_and_b32_dpp v44, v114, v28 row_newbcast:0 row_mask:0xf bank_mask:0xf
    v_and_b32_dpp v45, v114, v29 row_newbcast:0 row_mask:0xf bank_mask:0xf
    v_and_b32_dpp v46, v114, v30 row_newbcast:0 row_mask:0xf bank_mask:0xf
    v_and_b32_dpp v47, v114, v31 row_newbcast:0 row_mask:0xf bank_mask:0xf
    s_waitcnt vmcnt(17)
    s_nop 0
    v_mfma_f32_16x16x32_bf16 v[80:83], v[44:47], a[196:199], v[80:83]
    buffer_load_dwordx4 v[248:251], v8, s[20:23], s59 offen offset:2048
    v_and_b32_dpp v40, v114, v28 row_newbcast:4 row_mask:0xf bank_mask:0xf
    v_and_b32_dpp v41, v114, v29 row_newbcast:4 row_mask:0xf bank_mask:0xf
    v_and_b32_dpp v42, v114, v30 row_newbcast:4 row_mask:0xf bank_mask:0xf
    v_and_b32_dpp v43, v114, v31 row_newbcast:4 row_mask:0xf bank_mask:0xf
    s_waitcnt vmcnt(17)
    s_nop 0
    v_mfma_f32_16x16x32_bf16 v[80:83], v[40:43], a[204:207], v[80:83]
    buffer_load_dwordx4 v[252:255], v5, s[12:15], s56 offen offset:3072 nt
    v_and_b32_dpp v44, v114, v28 row_newbcast:8 row_mask:0xf bank_mask:0xf
    v_and_b32_dpp v45, v114, v29 row_newbcast:8 row_mask:0xf bank_mask:0xf
    v_and_b32_dpp v46, v114, v30 row_newbcast:8 row_mask:0xf bank_mask:0xf
    v_and_b32_dpp v47, v114, v31 row_newbcast:8 row_mask:0xf bank_mask:0xf
    s_waitcnt vmcnt(17)
    s_nop 0
    v_mfma_f32_16x16x32_bf16 v[80:83], v[44:47], a[212:215], v[80:83]
    s_add_u32 s56, s51, 229376
    buffer_load_dwordx4 a[16:19], v5, s[12:15], s56 offen offset:0 nt
    buffer_load_dwordx4 a[24:27], v5, s[12:15], s56 offen offset:1024 nt
    v_and_b32_dpp v40, v114, v28 row_newbcast:12 row_mask:0xf bank_mask:0xf
    v_and_b32_dpp v41, v114, v29 row_newbcast:12 row_mask:0xf bank_mask:0xf
    v_and_b32_dpp v42, v114, v30 row_newbcast:12 row_mask:0xf bank_mask:0xf
    v_and_b32_dpp v43, v114, v31 row_newbcast:12 row_mask:0xf bank_mask:0xf
    s_waitcnt vmcnt(17)
    s_nop 0
    v_mfma_f32_16x16x32_bf16 v[80:83], v[40:43], a[236:239], v[80:83]
    buffer_load_dwordx4 a[32:35], v5, s[12:15], s56 offen offset:2048 nt
    v_fma_f32 v126, v126, s60, -v14
    v_exp_f32 v126, v126
    s_nop 0
    v_add_f32 v15, v15, v126
    v_cvt_pk_bf16_f32 v126, v126, v126
    v_fma_f32 v127, v127, s60, -v14
    v_exp_f32 v127, v127
    s_nop 0
    v_add_f32 v15, v15, v127
    v_cvt_pk_bf16_f32 v127, v127, v127
    v_and_b32_dpp v44, v115, v28 row_newbcast:0 row_mask:0xf bank_mask:0xf
    v_and_b32_dpp v45, v115, v29 row_newbcast:0 row_mask:0xf bank_mask:0xf
    v_and_b32_dpp v46, v115, v30 row_newbcast:0 row_mask:0xf bank_mask:0xf
    v_and_b32_dpp v47, v115, v31 row_newbcast:0 row_mask:0xf bank_mask:0xf
    s_waitcnt vmcnt(17)
    s_nop 0
    v_mfma_f32_16x16x32_bf16 v[80:83], v[44:47], a[244:247], v[80:83]
    buffer_load_dwordx4 a[40:43], v5, s[12:15], s56 offen offset:3072 nt
    v_and_b32_dpp v40, v115, v28 row_newbcast:4 row_mask:0xf bank_mask:0xf
    v_and_b32_dpp v41, v115, v29 row_newbcast:4 row_mask:0xf bank_mask:0xf
    v_and_b32_dpp v42, v115, v30 row_newbcast:4 row_mask:0xf bank_mask:0xf
    v_and_b32_dpp v43, v115, v31 row_newbcast:4 row_mask:0xf bank_mask:0xf
    s_waitcnt vmcnt(17)
    s_nop 0
    v_mfma_f32_16x16x32_bf16 v[80:83], v[40:43], a[252:255], v[80:83]
    buffer_load_dwordx4 a[56:59], v8, s[20:23], s59 offen offset:2304
    v_and_b32_dpp v44, v115, v28 row_newbcast:8 row_mask:0xf bank_mask:0xf
    v_and_b32_dpp v45, v115, v29 row_newbcast:8 row_mask:0xf bank_mask:0xf
    v_and_b32_dpp v46, v115, v30 row_newbcast:8 row_mask:0xf bank_mask:0xf
    v_and_b32_dpp v47, v115, v31 row_newbcast:8 row_mask:0xf bank_mask:0xf
    s_waitcnt vmcnt(17)
    s_nop 0
    v_mfma_f32_16x16x32_bf16 v[80:83], v[44:47], v[168:171], v[80:83]
    s_add_u32 s56, s51, 245760
    buffer_load_dwordx4 a[64:67], v5, s[12:15], s56 offen offset:0 nt
    buffer_load_dwordx4 a[72:75], v5, s[12:15], s56 offen offset:1024 nt
    v_and_b32_dpp v40, v115, v28 row_newbcast:12 row_mask:0xf bank_mask:0xf
    v_and_b32_dpp v41, v115, v29 row_newbcast:12 row_mask:0xf bank_mask:0xf
    v_and_b32_dpp v42, v115, v30 row_newbcast:12 row_mask:0xf bank_mask:0xf
    v_and_b32_dpp v43, v115, v31 row_newbcast:12 row_mask:0xf bank_mask:0xf
    s_waitcnt vmcnt(17)
    s_nop 0
    v_mfma_f32_16x16x32_bf16 v[80:83], v[40:43], v[184:187], v[80:83]
    buffer_load_dwordx4 a[80:83], v5, s[12:15], s56 offen offset:2048 nt
    v_fma_f32 v128, v128, s60, -v14
    v_exp_f32 v128, v128
    s_nop 0
    v_add_f32 v15, v15, v128
    v_cvt_pk_bf16_f32 v128, v128, v128
    v_fma_f32 v129, v129, s60, -v14
    v_exp_f32 v129, v129
    s_nop 0
    v_add_f32 v15, v15, v129
    v_cvt_pk_bf16_f32 v129, v129, v129
    v_and_b32_dpp v44, v116, v28 row_newbcast:0 row_mask:0xf bank_mask:0xf
    v_and_b32_dpp v45, v116, v29 row_newbcast:0 row_mask:0xf bank_mask:0xf
    v_and_b32_dpp v46, v116, v30 row_newbcast:0 row_mask:0xf bank_mask:0xf
    v_and_b32_dpp v47, v116, v31 row_newbcast:0 row_mask:0xf bank_mask:0xf
    s_waitcnt vmcnt(17)
    s_nop 0
    v_mfma_f32_16x16x32_bf16 v[80:83], v[44:47], v[192:195], v[80:83]
    buffer_load_dwordx4 a[96:99], v5, s[12:15], s56 offen offset:3072 nt
    v_and_b32_dpp v40, v116, v28 row_newbcast:4 row_mask:0xf bank_mask:0xf
    v_and_b32_dpp v41, v116, v29 row_newbcast:4 row_mask:0xf bank_mask:0xf
    v_and_b32_dpp v42, v116, v30 row_newbcast:4 row_mask:0xf bank_mask:0xf
    v_and_b32_dpp v43, v116, v31 row_newbcast:4 row_mask:0xf bank_mask:0xf
    s_waitcnt vmcnt(17)
    s_nop 0
    v_mfma_f32_16x16x32_bf16 v[80:83], v[40:43], v[208:211], v[80:83]
    s_add_u32 s59, s54, 7680
    buffer_load_dwordx4 a[104:107], v8, s[20:23], s59 offen offset:0
    v_and_b32_dpp v44, v116, v28 row_newbcast:8 row_mask:0xf bank_mask:0xf
    v_and_b32_dpp v45, v116, v29 row_newbcast:8 row_mask:0xf bank_mask:0xf
    v_and_b32_dpp v46, v116, v30 row_newbcast:8 row_mask:0xf bank_mask:0xf
    v_and_b32_dpp v47, v116, v31 row_newbcast:8 row_mask:0xf bank_mask:0xf
    s_waitcnt vmcnt(17)
    s_nop 0
    v_mfma_f32_16x16x32_bf16 v[80:83], v[44:47], v[216:219], v[80:83]
    s_add_u32 s56, s51, 262144
    buffer_load_dwordx4 a[112:115], v5, s[12:15], s56 offen offset:0 nt
    buffer_load_dwordx4 a[120:123], v5, s[12:15], s56 offen offset:1024 nt
    v_and_b32_dpp v40, v116, v28 row_newbcast:12 row_mask:0xf bank_mask:0xf
    v_and_b32_dpp v41, v116, v29 row_newbcast:12 row_mask:0xf bank_mask:0xf
    v_and_b32_dpp v42, v116, v30 row_newbcast:12 row_mask:0xf bank_mask:0xf
    v_and_b32_dpp v43, v116, v31 row_newbcast:12 row_mask:0xf bank_mask:0xf
    s_waitcnt vmcnt(17)
    s_nop 0
    v_mfma_f32_16x16x32_bf16 v[80:83], v[40:43], v[228:231], v[80:83]
    buffer_load_dwordx4 a[136:139], v5, s[12:15], s56 offen offset:2048 nt
    v_fma_f32 v130, v130, s60, -v14
    v_exp_f32 v130, v130
    s_nop 0
    v_add_f32 v15, v15, v130
    v_cvt_pk_bf16_f32 v130, v130, v130
    v_fma_f32 v131, v131, s60, -v14
    v_exp_f32 v131, v131
    s_nop 0
    v_add_f32 v15, v15, v131
    v_cvt_pk_bf16_f32 v131, v131, v131
    v_and_b32_dpp v44, v117, v28 row_newbcast:0 row_mask:0xf bank_mask:0xf
    v_and_b32_dpp v45, v117, v29 row_newbcast:0 row_mask:0xf bank_mask:0xf
    v_and_b32_dpp v46, v117, v30 row_newbcast:0 row_mask:0xf bank_mask:0xf
    v_and_b32_dpp v47, v117, v31 row_newbcast:0 row_mask:0xf bank_mask:0xf
    s_waitcnt vmcnt(17)
    s_nop 0
    v_mfma_f32_16x16x32_bf16 v[80:83], v[44:47], v[232:235], v[80:83]
    buffer_load_dwordx4 a[152:155], v5, s[12:15], s56 offen offset:3072 nt
    v_and_b32_dpp v40, v117, v28 row_newbcast:4 row_mask:0xf bank_mask:0xf
    v_and_b32_dpp v41, v117, v29 row_newbcast:4 row_mask:0xf bank_mask:0xf
    v_and_b32_dpp v42, v117, v30 row_newbcast:4 row_mask:0xf bank_mask:0xf
    v_and_b32_dpp v43, v117, v31 row_newbcast:4 row_mask:0xf bank_mask:0xf
    s_waitcnt vmcnt(17)
    s_nop 0
    v_mfma_f32_16x16x32_bf16 v[80:83], v[40:43], v[240:243], v[80:83]
    buffer_load_dwordx4 a[160:163], v8, s[20:23], s59 offen offset:256
    v_and_b32_dpp v44, v117, v28 row_newbcast:8 row_mask:0xf bank_mask:0xf
    v_and_b32_dpp v45, v117, v29 row_newbcast:8 row_mask:0xf bank_mask:0xf
    v_and_b32_dpp v46, v117, v30 row_newbcast:8 row_mask:0xf bank_mask:0xf
    v_and_b32_dpp v47, v117, v31 row_newbcast:8 row_mask:0xf bank_mask:0xf
    s_waitcnt vmcnt(17)
    s_nop 0
    v_mfma_f32_16x16x32_bf16 v[80:83], v[44:47], v[244:247], v[80:83]
    s_add_u32 s56, s51, 278528
    buffer_load_dwordx4 a[168:171], v5, s[12:15], s56 offen offset:0 nt
    buffer_load_dwordx4 a[184:187], v5, s[12:15], s56 offen offset:1024 nt
    v_and_b32_dpp v40, v117, v28 row_newbcast:12 row_mask:0xf bank_mask:0xf
    v_and_b32_dpp v41, v117, v29 row_newbcast:12 row_mask:0xf bank_mask:0xf
    v_and_b32_dpp v42, v117, v30 row_newbcast:12 row_mask:0xf bank_mask:0xf
    v_and_b32_dpp v43, v117, v31 row_newbcast:12 row_mask:0xf bank_mask:0xf
    s_waitcnt vmcnt(17)
    s_nop 0
    v_mfma_f32_16x16x32_bf16 v[80:83], v[40:43], v[252:255], v[80:83]
    buffer_load_dwordx4 a[200:203], v5, s[12:15], s56 offen offset:2048 nt
    v_fma_f32 v132, v132, s60, -v14
    v_exp_f32 v132, v132
    s_nop 0
    v_add_f32 v15, v15, v132
    v_cvt_pk_bf16_f32 v132, v132, v132
    v_fma_f32 v133, v133, s60, -v14
    v_exp_f32 v133, v133
    s_nop 0
    v_add_f32 v15, v15, v133
    v_cvt_pk_bf16_f32 v133, v133, v133
    v_and_b32_dpp v44, v118, v28 row_newbcast:0 row_mask:0xf bank_mask:0xf
    v_and_b32_dpp v45, v118, v29 row_newbcast:0 row_mask:0xf bank_mask:0xf
    v_and_b32_dpp v46, v118, v30 row_newbcast:0 row_mask:0xf bank_mask:0xf
    v_and_b32_dpp v47, v118, v31 row_newbcast:0 row_mask:0xf bank_mask:0xf
    s_waitcnt vmcnt(17)
    s_nop 0
    v_mfma_f32_16x16x32_bf16 v[80:83], v[44:47], a[16:19], v[80:83]
    buffer_load_dwordx4 a[208:211], v5, s[12:15], s56 offen offset:3072 nt
    v_and_b32_dpp v40, v118, v28 row_newbcast:4 row_mask:0xf bank_mask:0xf
    v_and_b32_dpp v41, v118, v29 row_newbcast:4 row_mask:0xf bank_mask:0xf
    v_and_b32_dpp v42, v118, v30 row_newbcast:4 row_mask:0xf bank_mask:0xf
    v_and_b32_dpp v43, v118, v31 row_newbcast:4 row_mask:0xf bank_mask:0xf
    s_waitcnt vmcnt(17)
    s_nop 0
    v_mfma_f32_16x16x32_bf16 v[80:83], v[40:43], a[24:27], v[80:83]
    buffer_load_dwordx4 a[224:227], v8, s[20:23], s59 offen offset:512
    v_and_b32_dpp v44, v118, v28 row_newbcast:8 row_mask:0xf bank_mask:0xf
    v_and_b32_dpp v45, v118, v29 row_newbcast:8 row_mask:0xf bank_mask:0xf
    v_and_b32_dpp v46, v118, v30 row_newbcast:8 row_mask:0xf bank_mask:0xf
    v_and_b32_dpp v47, v118, v31 row_newbcast:8 row_mask:0xf bank_mask:0xf
    s_waitcnt vmcnt(17)
    s_nop 0
    v_mfma_f32_16x16x32_bf16 v[80:83], v[44:47], a[32:35], v[80:83]
    s_add_u32 s56, s51, 294912
    buffer_load_dwordx4 a[232:235], v5, s[12:15], s56 offen offset:0 nt
    v_and_b32_dpp v40, v118, v28 row_newbcast:12 row_mask:0xf bank_mask:0xf
    v_and_b32_dpp v41, v118, v29 row_newbcast:12 row_mask:0xf bank_mask:0xf
    v_and_b32_dpp v42, v118, v30 row_newbcast:12 row_mask:0xf bank_mask:0xf
    v_and_b32_dpp v43, v118, v31 row_newbcast:12 row_mask:0xf bank_mask:0xf
    s_waitcnt vmcnt(17)
    s_nop 0
    v_mfma_f32_16x16x32_bf16 v[80:83], v[40:43], a[40:43], v[80:83]
    buffer_load_dwordx4 a[248:251], v5, s[12:15], s56 offen offset:1024 nt
    buffer_load_dwordx4 v[164:167], v5, s[12:15], s56 offen offset:2048 nt
    v_fma_f32 v134, v134, s60, -v14
    v_exp_f32 v134, v134
    s_nop 0
    v_add_f32 v15, v15, v134
    v_cvt_pk_bf16_f32 v134, v134, v134
    v_fma_f32 v135, v135, s60, -v14
    v_exp_f32 v135, v135
    s_nop 0
    v_add_f32 v15, v15, v135
    v_cvt_pk_bf16_f32 v135, v135, v135
    v_and_b32_dpp v44, v119, v28 row_newbcast:0 row_mask:0xf bank_mask:0xf
    v_and_b32_dpp v45, v119, v29 row_newbcast:0 row_mask:0xf bank_mask:0xf
    v_and_b32_dpp v46, v119, v30 row_newbcast:0 row_mask:0xf bank_mask:0xf
    v_and_b32_dpp v47, v119, v31 row_newbcast:0 row_mask:0xf bank_mask:0xf
    s_waitcnt vmcnt(17)
    s_nop 0
    v_mfma_f32_16x16x32_bf16 v[80:83], v[44:47], a[64:67], v[80:83]
    buffer_load_dwordx4 v[172:175], v5, s[12:15], s56 offen offset:3072 nt
    v_and_b32_dpp v40, v119, v28 row_newbcast:4 row_mask:0xf bank_mask:0xf
    v_and_b32_dpp v41, v119, v29 row_newbcast:4 row_mask:0xf bank_mask:0xf
    v_and_b32_dpp v42, v119, v30 row_newbcast:4 row_mask:0xf bank_mask:0xf
    v_and_b32_dpp v43, v119, v31 row_newbcast:4 row_mask:0xf bank_mask:0xf
    s_waitcnt vmcnt(17)
    s_nop 0
    v_mfma_f32_16x16x32_bf16 v[80:83], v[40:43], a[72:75], v[80:83]
    s_add_u32 s56, s51, 311296
    buffer_load_dwordx4 v[180:183], v5, s[12:15], s56 offen offset:0 nt
    v_and_b32_dpp v44, v119, v28 row_newbcast:8 row_mask:0xf bank_mask:0xf
    v_and_b32_dpp v45, v119, v29 row_newbcast:8 row_mask:0xf bank_mask:0xf
    v_and_b32_dpp v46, v119, v30 row_newbcast:8 row_mask:0xf bank_mask:0xf
    v_and_b32_dpp v47, v119, v31 row_newbcast:8 row_mask:0xf bank_mask:0xf
    s_waitcnt vmcnt(17)
    s_nop 0
    v_mfma_f32_16x16x32_bf16 v[80:83], v[44:47], a[80:83], v[80:83]
    buffer_load_dwordx4 v[204:207], v8, s[20:23], s59 offen offset:768
    v_and_b32_dpp v40, v119, v28 row_newbcast:12 row_mask:0xf bank_mask:0xf
    v_and_b32_dpp v41, v119, v29 row_newbcast:12 row_mask:0xf bank_mask:0xf
    v_and_b32_dpp v42, v119, v30 row_newbcast:12 row_mask:0xf bank_mask:0xf
    v_and_b32_dpp v43, v119, v31 row_newbcast:12 row_mask:0xf bank_mask:0xf
    s_waitcnt vmcnt(17)
    s_nop 0
    v_mfma_f32_16x16x32_bf16 v[80:83], v[40:43], a[96:99], v[80:83]
    buffer_load_dwordx4 v[212:215], v5, s[12:15], s56 offen offset:1024 nt
    buffer_load_dwordx4 v[220:223], v5, s[12:15], s56 offen offset:2048 nt
    v_add_f32_dpp v15, v15, v15 row_ror:4 row_mask:0xf bank_mask:0xf
    s_nop 1
    v_add_f32_dpp v15, v15, v15 row_ror:8 row_mask:0xf bank_mask:0xf
    ds_write_b32 v20, v15 offset:8256
    s_lshl_b32 s88, s48, 6
    s_lshl_b32 s3, s47, 1
    s_add_u32 s88, s88, s3
    s_add_u32 s88, s88, s49
    s_mul_i32 s61, s88, 2560
    s_mul_i32 s3, s46, 640
    s_add_u32 s61, s61, s3
    s_lshl_b32 s62, s88, 6
    s_add_u32 s62, s62, 655360
    s_lshl_b32 s63, s50, 1
    s_add_u32 s63, s63, s49
    s_lshl_b32 s64, s63, 5
    s_add_u32 s64, s64, s68
    s_mul_i32 s65, s48, 163840
    s_lshl_b32 s3, s63, 6
    s_add_u32 s65, s65, s3
    s_and_b32 s92, s44, 0xfff
    s_bfe_u32 s93, s44, 0xc000c
    s_and_b32 s94, s45, 0xfff
    s_bfe_u32 s95, s45, 0xc000c
    v_lshlrev_b32 v17, 1, v3
    buffer_load_ushort v18, v17, s[4:7], s64 offen
    buffer_load_dwordx4 a[0:3], v5, s[12:15], s56 offen offset:3072 nt
    v_and_b32_dpp v44, v120, v28 row_newbcast:0 row_mask:0xf bank_mask:0xf
    v_and_b32_dpp v45, v120, v29 row_newbcast:0 row_mask:0xf bank_mask:0xf
    v_and_b32_dpp v46, v120, v30 row_newbcast:0 row_mask:0xf bank_mask:0xf
    v_and_b32_dpp v47, v120, v31 row_newbcast:0 row_mask:0xf bank_mask:0xf
    s_waitcnt vmcnt(19)
    s_nop 0
    v_mfma_f32_16x16x32_bf16 v[80:83], v[44:47], a[112:115], v[80:83]
    v_and_b32_dpp v40, v120, v28 row_newbcast:4 row_mask:0xf bank_mask:0xf
    v_and_b32_dpp v41, v120, v29 row_newbcast:4 row_mask:0xf bank_mask:0xf
    v_and_b32_dpp v42, v120, v30 row_newbcast:4 row_mask:0xf bank_mask:0xf
    v_and_b32_dpp v43, v120, v31 row_newbcast:4 row_mask:0xf bank_mask:0xf
    s_waitcnt vmcnt(18)
    s_nop 0
    v_mfma_f32_16x16x32_bf16 v[80:83], v[40:43], a[120:123], v[80:83]
    s_add_u32 s56, s51, 327680
    buffer_load_dwordx4 a[4:7], v5, s[12:15], s56 offen offset:0 nt
    v_and_b32_dpp v44, v120, v28 row_newbcast:8 row_mask:0xf bank_mask:0xf
    v_and_b32_dpp v45, v120, v29 row_newbcast:8 row_mask:0xf bank_mask:0xf
    v_and_b32_dpp v46, v120, v30 row_newbcast:8 row_mask:0xf bank_mask:0xf
    v_and_b32_dpp v47, v120, v31 row_newbcast:8 row_mask:0xf bank_mask:0xf
    s_waitcnt vmcnt(18)
    s_nop 0
    v_mfma_f32_16x16x32_bf16 v[80:83], v[44:47], a[136:139], v[80:83]
    buffer_load_dwordx4 a[28:31], v8, s[20:23], s59 offen offset:1024
    v_and_b32_dpp v40, v120, v28 row_newbcast:12 row_mask:0xf bank_mask:0xf
    v_and_b32_dpp v41, v120, v29 row_newbcast:12 row_mask:0xf bank_mask:0xf
    v_and_b32_dpp v42, v120, v30 row_newbcast:12 row_mask:0xf bank_mask:0xf
    v_and_b32_dpp v43, v120, v31 row_newbcast:12 row_mask:0xf bank_mask:0xf
    s_waitcnt vmcnt(18)
    s_nop 0
    v_mfma_f32_16x16x32_bf16 v[80:83], v[40:43], a[152:155], v[80:83]
    buffer_load_dwordx4 a[36:39], v5, s[12:15], s56 offen offset:1024 nt
    buffer_load_dwordx4 a[44:47], v5, s[12:15], s56 offen offset:2048 nt
    v_and_b32_dpp v44, v121, v28 row_newbcast:0 row_mask:0xf bank_mask:0xf
    v_and_b32_dpp v45, v121, v29 row_newbcast:0 row_mask:0xf bank_mask:0xf
    v_and_b32_dpp v46, v121, v30 row_newbcast:0 row_mask:0xf bank_mask:0xf
    v_and_b32_dpp v47, v121, v31 row_newbcast:0 row_mask:0xf bank_mask:0xf
    s_waitcnt vmcnt(18)
    s_nop 0
    v_mfma_f32_16x16x32_bf16 v[80:83], v[44:47], a[168:171], v[80:83]
    buffer_load_dwordx4 a[60:63], v5, s[12:15], s56 offen offset:3072 nt
    v_and_b32_dpp v40, v121, v28 row_newbcast:4 row_mask:0xf bank_mask:0xf
    v_and_b32_dpp v41, v121, v29 row_newbcast:4 row_mask:0xf bank_mask:0xf
    v_and_b32_dpp v42, v121, v30 row_newbcast:4 row_mask:0xf bank_mask:0xf
    v_and_b32_dpp v43, v121, v31 row_newbcast:4 row_mask:0xf bank_mask:0xf
    s_waitcnt vmcnt(18)
    s_nop 0
    v_mfma_f32_16x16x32_bf16 v[80:83], v[40:43], a[184:187], v[80:83]
    s_add_u32 s56, s51, 344064
    buffer_load_dwordx4 a[76:79], v5, s[12:15], s56 offen offset:0 nt
    v_and_b32_dpp v44, v121, v28 row_newbcast:8 row_mask:0xf bank_mask:0xf
    v_and_b32_dpp v45, v121, v29 row_newbcast:8 row_mask:0xf bank_mask:0xf
    v_and_b32_dpp v46, v121, v30 row_newbcast:8 row_mask:0xf bank_mask:0xf
    v_and_b32_dpp v47, v121, v31 row_newbcast:8 row_mask:0xf bank_mask:0xf
    s_waitcnt vmcnt(18)
    s_nop 0
    v_mfma_f32_16x16x32_bf16 v[80:83], v[44:47], a[200:203], v[80:83]
    buffer_load_dwordx4 a[84:87], v8, s[20:23], s59 offen offset:1280
    v_and_b32_dpp v40, v121, v28 row_newbcast:12 row_mask:0xf bank_mask:0xf
    v_and_b32_dpp v41, v121, v29 row_newbcast:12 row_mask:0xf bank_mask:0xf
    v_and_b32_dpp v42, v121, v30 row_newbcast:12 row_mask:0xf bank_mask:0xf
    v_and_b32_dpp v43, v121, v31 row_newbcast:12 row_mask:0xf bank_mask:0xf
    s_waitcnt vmcnt(18)
    s_nop 0
    v_mfma_f32_16x16x32_bf16 v[80:83], v[40:43], a[208:211], v[80:83]
    buffer_load_dwordx4 a[100:103], v5, s[12:15], s56 offen offset:1024 nt
    buffer_load_dwordx4 a[108:111], v5, s[12:15], s56 offen offset:2048 nt
    s_waitcnt lgkmcnt(0)
    s_barrier
    ds_read_b32 v15, v12 offset:8256
    v_mov_b32 v140, v13
    v_mov_b32 v142, s44
    v_mov_b32 v143, s45
    v_mov_b32 v144, 0xfff
    s_waitcnt lgkmcnt(0)
    v_add_f32_dpp v15, v15, v15 quad_perm:[1,0,3,2] row_mask:0xf bank_mask:0xf
    s_nop 1
    v_add_f32_dpp v15, v15, v15 quad_perm:[2,3,0,1] row_mask:0xf bank_mask:0xf
    s_nop 1
    v_add_f32_dpp v15, v15, v15 row_half_mirror row_mask:0xf bank_mask:0xf
    s_nop 1
    v_add_f32_dpp v15, v15, v15 row_mirror row_mask:0xf bank_mask:0xf
    s_cmp_lg_u32 s46, 0
    s_cbranch_scc1 L_pubml_c
    v_mov_b32 v141, v15
    s_mov_b64 exec, 1
    buffer_store_dwordx4 v[140:143], off, s[36:39], s62 sc1
    s_mov_b64 exec, -1
L_pubml_c:
    s_xor_b32 s62, s62, 64
    v_and_b32_dpp v44, v122, v28 row_newbcast:0 row_mask:0xf bank_mask:0xf
    v_and_b32_dpp v45, v122, v29 row_newbcast:0 row_mask:0xf bank_mask:0xf
    v_and_b32_dpp v46, v122, v30 row_newbcast:0 row_mask:0xf bank_mask:0xf
    v_and_b32_dpp v47, v122, v31 row_newbcast:0 row_mask:0xf bank_mask:0xf
    s_waitcnt vmcnt(18)
    s_nop 0
    v_mfma_f32_16x16x32_bf16 v[80:83], v[44:47], a[232:235], v[80:83]
    buffer_load_dwordx4 a[124:127], v5, s[12:15], s56 offen offset:3072 nt
    v_and_b32_dpp v40, v122, v28 row_newbcast:4 row_mask:0xf bank_mask:0xf
    v_and_b32_dpp v41, v122, v29 row_newbcast:4 row_mask:0xf bank_mask:0xf
    v_and_b32_dpp v42, v122, v30 row_newbcast:4 row_mask:0xf bank_mask:0xf
    v_and_b32_dpp v43, v122, v31 row_newbcast:4 row_mask:0xf bank_mask:0xf
    s_waitcnt vmcnt(18)
    s_nop 0
    v_mfma_f32_16x16x32_bf16 v[80:83], v[40:43], a[248:251], v[80:83]
    s_add_u32 s56, s51, 360448
    buffer_load_dwordx4 a[140:143], v5, s[12:15], s56 offen offset:0 nt
    v_and_b32_dpp v44, v122, v28 row_newbcast:8 row_mask:0xf bank_mask:0xf
    v_and_b32_dpp v45, v122, v29 row_newbcast:8 row_mask:0xf bank_mask:0xf
    v_and_b32_dpp v46, v122, v30 row_newbcast:8 row_mask:0xf bank_mask:0xf
    v_and_b32_dpp v47, v122, v31 row_newbcast:8 row_mask:0xf bank_mask:0xf
    s_waitcnt vmcnt(18)
    s_nop 0
    v_mfma_f32_16x16x32_bf16 v[80:83], v[44:47], v[164:167], v[80:83]
    buffer_load_dwordx4 a[148:151], v8, s[20:23], s59 offen offset:1536
    v_and_b32_dpp v40, v122, v28 row_newbcast:12 row_mask:0xf bank_mask:0xf
    v_and_b32_dpp v41, v122, v29 row_newbcast:12 row_mask:0xf bank_mask:0xf
    v_and_b32_dpp v42, v122, v30 row_newbcast:12 row_mask:0xf bank_mask:0xf
    v_and_b32_dpp v43, v122, v31 row_newbcast:12 row_mask:0xf bank_mask:0xf
    s_waitcnt vmcnt(18)
    s_nop 0
    v_mfma_f32_16x16x32_bf16 v[80:83], v[40:43], v[172:175], v[80:83]
    buffer_load_dwordx4 a[156:159], v5, s[12:15], s56 offen offset:1024 nt
    v_lshrrev_b32 v10, 2, v0
    v_mul_u32_u24 v24, 2560, v10
    v_and_b32 v10, 3, v0
    v_lshl_add_u32 v24, v10, 4, v24
    v_lshrrev_b32 v25, 4, v0
    v_lshlrev_b32 v25, 6, v25
    v_lshl_add_u32 v25, v10, 4, v25
    v_lshlrev_b32 v26, 8, v2
    v_lshl_add_u32 v26, v3, 2, v26
    v_add_u32 v26, 10496, v26
    v_and_b32 v21, 31, v1
    v_lshlrev_b32 v21, 4, v21
    s_mul_i32 s3, s46, 2560
    v_add_u32 v21, s3, v21
    s_mul_i32 s3, s46, 40
    v_add_u32 v23, s3, v1
    v_lshrrev_b32 v22, 5, v23
    v_lshlrev_b32 v22, 9, v22
    v_and_b32 v10, 1, v23
    v_lshl_add_u32 v22, v10, 8, v22
    v_bfe_u32 v10, v23, 1, 4
    v_lshl_add_u32 v22, v10, 4, v22
    v_and_b32_dpp v44, v123, v28 row_newbcast:0 row_mask:0xf bank_mask:0xf
    v_and_b32_dpp v45, v123, v29 row_newbcast:0 row_mask:0xf bank_mask:0xf
    v_and_b32_dpp v46, v123, v30 row_newbcast:0 row_mask:0xf bank_mask:0xf
    v_and_b32_dpp v47, v123, v31 row_newbcast:0 row_mask:0xf bank_mask:0xf
    s_waitcnt vmcnt(18)
    s_nop 0
    v_mfma_f32_16x16x32_bf16 v[80:83], v[44:47], v[180:183], v[80:83]
    buffer_load_dwordx4 a[172:175], v5, s[12:15], s56 offen offset:2048 nt
    buffer_load_dwordx4 a[188:191], v5, s[12:15], s56 offen offset:3072 nt
    v_and_b32_dpp v40, v123, v28 row_newbcast:4 row_mask:0xf bank_mask:0xf
    v_and_b32_dpp v41, v123, v29 row_newbcast:4 row_mask:0xf bank_mask:0xf
    v_and_b32_dpp v42, v123, v30 row_newbcast:4 row_mask:0xf bank_mask:0xf
    v_and_b32_dpp v43, v123, v31 row_newbcast:4 row_mask:0xf bank_mask:0xf
    s_waitcnt vmcnt(18)
    s_nop 0
    v_mfma_f32_16x16x32_bf16 v[80:83], v[40:43], v[212:215], v[80:83]
    s_add_u32 s56, s51, 376832
    buffer_load_dwordx4 a[196:199], v5, s[12:15], s56 offen offset:0 nt
    v_and_b32_dpp v44, v123, v28 row_newbcast:8 row_mask:0xf bank_mask:0xf
    v_and_b32_dpp v45, v123, v29 row_newbcast:8 row_mask:0xf bank_mask:0xf
    v_and_b32_dpp v46, v123, v30 row_newbcast:8 row_mask:0xf bank_mask:0xf
    v_and_b32_dpp v47, v123, v31 row_newbcast:8 row_mask:0xf bank_mask:0xf
    s_waitcnt vmcnt(18)
    s_nop 0
    v_mfma_f32_16x16x32_bf16 v[80:83], v[44:47], v[220:223], v[80:83]
    buffer_load_dwordx4 a[204:207], v5, s[12:15], s56 offen offset:1024 nt
    v_and_b32_dpp v40, v123, v28 row_newbcast:12 row_mask:0xf bank_mask:0xf
    v_and_b32_dpp v41, v123, v29 row_newbcast:12 row_mask:0xf bank_mask:0xf
    v_and_b32_dpp v42, v123, v30 row_newbcast:12 row_mask:0xf bank_mask:0xf
    v_and_b32_dpp v43, v123, v31 row_newbcast:12 row_mask:0xf bank_mask:0xf
    s_waitcnt vmcnt(17)
    s_nop 0
    v_mfma_f32_16x16x32_bf16 v[80:83], v[40:43], a[0:3], v[80:83]
    buffer_load_dwordx4 a[212:215], v8, s[20:23], s59 offen offset:1792
    v_lshlrev_b32 v10, 5, v3
    v_lshl_add_u32 v10, v2, 4, v10
    s_lshl_b32 s3, s46, 9
    v_add_u32 v10, s3, v10
    v_lshrrev_b32 v11, 3, v3
    v_lshlrev_b32 v11, 10, v11
    v_lshl_add_u32 v11, v2, 5, v11
    v_and_b32 v12, 7, v3
    v_lshl_add_u32 v11, v12, 2, v11
    s_lshl_b32 s3, s46, 7
    s_add_u32 s3, s3, 8448
    v_add_u32 v11, s3, v11
    v_and_b32_dpp v44, v124, v28 row_newbcast:0 row_mask:0xf bank_mask:0xf
    v_and_b32_dpp v45, v124, v29 row_newbcast:0 row_mask:0xf bank_mask:0xf
    v_and_b32_dpp v46, v124, v30 row_newbcast:0 row_mask:0xf bank_mask:0xf
    v_and_b32_dpp v47, v124, v31 row_newbcast:0 row_mask:0xf bank_mask:0xf
    s_waitcnt vmcnt(17)
    s_nop 0
    v_mfma_f32_16x16x32_bf16 v[80:83], v[44:47], a[4:7], v[80:83]
    buffer_load_dwordx4 a[236:239], v5, s[12:15], s56 offen offset:2048 nt
    buffer_load_dwordx4 a[244:247], v5, s[12:15], s56 offen offset:3072 nt
    v_and_b32_dpp v40, v124, v28 row_newbcast:4 row_mask:0xf bank_mask:0xf
    v_and_b32_dpp v41, v124, v29 row_newbcast:4 row_mask:0xf bank_mask:0xf
    v_and_b32_dpp v42, v124, v30 row_newbcast:4 row_mask:0xf bank_mask:0xf
    v_and_b32_dpp v43, v124, v31 row_newbcast:4 row_mask:0xf bank_mask:0xf
    s_waitcnt vmcnt(17)
    s_nop 0
    v_mfma_f32_16x16x32_bf16 v[80:83], v[40:43], a[36:39], v[80:83]
    s_add_u32 s56, s51, 393216
    buffer_load_dwordx4 a[252:255], v5, s[12:15], s56 offen offset:0 nt
    v_and_b32_dpp v44, v124, v28 row_newbcast:8 row_mask:0xf bank_mask:0xf
    v_and_b32_dpp v45, v124, v29 row_newbcast:8 row_mask:0xf bank_mask:0xf
    v_and_b32_dpp v46, v124, v30 row_newbcast:8 row_mask:0xf bank_mask:0xf
    v_and_b32_dpp v47, v124, v31 row_newbcast:8 row_mask:0xf bank_mask:0xf
    s_waitcnt vmcnt(17)
    s_nop 0
    v_mfma_f32_16x16x32_bf16 v[80:83], v[44:47], a[44:47], v[80:83]
    buffer_load_dwordx4 v[168:171], v5, s[12:15], s56 offen offset:1024 nt
    v_and_b32_dpp v40, v124, v28 row_newbcast:12 row_mask:0xf bank_mask:0xf
    v_and_b32_dpp v41, v124, v29 row_newbcast:12 row_mask:0xf bank_mask:0xf
    v_and_b32_dpp v42, v124, v30 row_newbcast:12 row_mask:0xf bank_mask:0xf
    v_and_b32_dpp v43, v124, v31 row_newbcast:12 row_mask:0xf bank_mask:0xf
    s_waitcnt vmcnt(17)
    s_nop 0
    v_mfma_f32_16x16x32_bf16 v[80:83], v[40:43], a[60:63], v[80:83]
    buffer_load_dwordx4 v[184:187], v8, s[20:23], s59 offen offset:2048
    v_and_b32_dpp v44, v125, v28 row_newbcast:0 row_mask:0xf bank_mask:0xf
    v_and_b32_dpp v45, v125, v29 row_newbcast:0 row_mask:0xf bank_mask:0xf
    v_and_b32_dpp v46, v125, v30 row_newbcast:0 row_mask:0xf bank_mask:0xf
    v_and_b32_dpp v47, v125, v31 row_newbcast:0 row_mask:0xf bank_mask:0xf
    s_waitcnt vmcnt(17)
    s_nop 0
    v_mfma_f32_16x16x32_bf16 v[80:83], v[44:47], a[76:79], v[80:83]
    buffer_load_dwordx4 v[192:195], v5, s[12:15], s56 offen offset:2048 nt
    buffer_load_dwordx4 v[208:211], v5, s[12:15], s56 offen offset:3072 nt
    v_and_b32_dpp v40, v125, v28 row_newbcast:4 row_mask:0xf bank_mask:0xf
    v_and_b32_dpp v41, v125, v29 row_newbcast:4 row_mask:0xf bank_mask:0xf
    v_and_b32_dpp v42, v125, v30 row_newbcast:4 row_mask:0xf bank_mask:0xf
    v_and_b32_dpp v43, v125, v31 row_newbcast:4 row_mask:0xf bank_mask:0xf
    s_waitcnt vmcnt(17)
    s_nop 0
    v_mfma_f32_16x16x32_bf16 v[80:83], v[40:43], a[100:103], v[80:83]
    s_add_u32 s56, s51, 409600
    buffer_load_dwordx4 v[216:219], v5, s[12:15], s56 offen offset:0 nt
    v_and_b32_dpp v44, v125, v28 row_newbcast:8 row_mask:0xf bank_mask:0xf
    v_and_b32_dpp v45, v125, v29 row_newbcast:8 row_mask:0xf bank_mask:0xf
    v_and_b32_dpp v46, v125, v30 row_newbcast:8 row_mask:0xf bank_mask:0xf
    v_and_b32_dpp v47, v125, v31 row_newbcast:8 row_mask:0xf bank_mask:0xf
    s_waitcnt vmcnt(17)
    s_nop 0
    v_mfma_f32_16x16x32_bf16 v[80:83], v[44:47], a[108:111], v[80:83]
    buffer_load_dwordx4 v[228:231], v5, s[12:15], s56 offen offset:1024 nt
    v_and_b32_dpp v40, v125, v28 row_newbcast:12 row_mask:0xf bank_mask:0xf
    v_and_b32_dpp v41, v125, v29 row_newbcast:12 row_mask:0xf bank_mask:0xf
    v_and_b32_dpp v42, v125, v30 row_newbcast:12 row_mask:0xf bank_mask:0xf
    v_and_b32_dpp v43, v125, v31 row_newbcast:12 row_mask:0xf bank_mask:0xf
    s_waitcnt vmcnt(17)
    s_nop 0
    v_mfma_f32_16x16x32_bf16 v[80:83], v[40:43], a[124:127], v[80:83]
    buffer_load_dwordx4 v[232:235], v8, s[20:23], s59 offen offset:2304
    v_and_b32_dpp v44, v126, v28 row_newbcast:0 row_mask:0xf bank_mask:0xf
    v_and_b32_dpp v45, v126, v29 row_newbcast:0 row_mask:0xf bank_mask:0xf
    v_and_b32_dpp v46, v126, v30 row_newbcast:0 row_mask:0xf bank_mask:0xf
    v_and_b32_dpp v47, v126, v31 row_newbcast:0 row_mask:0xf bank_mask:0xf
    s_waitcnt vmcnt(17)
    s_nop 0
    v_mfma_f32_16x16x32_bf16 v[80:83], v[44:47], a[140:143], v[80:83]
    buffer_load_dwordx4 v[240:243], v5, s[12:15], s56 offen offset:2048 nt
    buffer_load_dwordx4 v[244:247], v5, s[12:15], s56 offen offset:3072 nt
    v_and_b32_dpp v40, v126, v28 row_newbcast:4 row_mask:0xf bank_mask:0xf
    v_and_b32_dpp v41, v126, v29 row_newbcast:4 row_mask:0xf bank_mask:0xf
    v_and_b32_dpp v42, v126, v30 row_newbcast:4 row_mask:0xf bank_mask:0xf
    v_and_b32_dpp v43, v126, v31 row_newbcast:4 row_mask:0xf bank_mask:0xf
    s_waitcnt vmcnt(17)
    s_nop 0
    v_mfma_f32_16x16x32_bf16 v[80:83], v[40:43], a[156:159], v[80:83]
    s_add_u32 s56, s51, 425984
    buffer_load_dwordx4 v[252:255], v5, s[12:15], s56 offen offset:0 nt
    v_and_b32_dpp v44, v126, v28 row_newbcast:8 row_mask:0xf bank_mask:0xf
    v_and_b32_dpp v45, v126, v29 row_newbcast:8 row_mask:0xf bank_mask:0xf
    v_and_b32_dpp v46, v126, v30 row_newbcast:8 row_mask:0xf bank_mask:0xf
    v_and_b32_dpp v47, v126, v31 row_newbcast:8 row_mask:0xf bank_mask:0xf
    s_waitcnt vmcnt(17)
    s_nop 0
    v_mfma_f32_16x16x32_bf16 v[80:83], v[44:47], a[172:175], v[80:83]
    buffer_load_dwordx4 a[16:19], v5, s[12:15], s56 offen offset:1024 nt
    v_and_b32_dpp v40, v126, v28 row_newbcast:12 row_mask:0xf bank_mask:0xf
    v_and_b32_dpp v41, v126, v29 row_newbcast:12 row_mask:0xf bank_mask:0xf
    v_and_b32_dpp v42, v126, v30 row_newbcast:12 row_mask:0xf bank_mask:0xf
    v_and_b32_dpp v43, v126, v31 row_newbcast:12 row_mask:0xf bank_mask:0xf
    s_waitcnt vmcnt(17)
    s_nop 0
    v_mfma_f32_16x16x32_bf16 v[80:83], v[40:43], a[188:191], v[80:83]
    buffer_load_dwordx4 a[24:27], v5, s[12:15], s56 offen offset:2048 nt
    v_and_b32_dpp v44, v127, v28 row_newbcast:0 row_mask:0xf bank_mask:0xf
    v_and_b32_dpp v45, v127, v29 row_newbcast:0 row_mask:0xf bank_mask:0xf
    v_and_b32_dpp v46, v127, v30 row_newbcast:0 row_mask:0xf bank_mask:0xf
    v_and_b32_dpp v47, v127, v31 row_newbcast:0 row_mask:0xf bank_mask:0xf
    s_waitcnt vmcnt(17)
    s_nop 0
    v_mfma_f32_16x16x32_bf16 v[80:83], v[44:47], a[196:199], v[80:83]
    buffer_load_dwordx4 a[32:35], v5, s[12:15], s56 offen offset:3072 nt
    v_and_b32_dpp v40, v127, v28 row_newbcast:4 row_mask:0xf bank_mask:0xf
    v_and_b32_dpp v41, v127, v29 row_newbcast:4 row_mask:0xf bank_mask:0xf
    v_and_b32_dpp v42, v127, v30 row_newbcast:4 row_mask:0xf bank_mask:0xf
    v_and_b32_dpp v43, v127, v31 row_newbcast:4 row_mask:0xf bank_mask:0xf
    s_waitcnt vmcnt(17)
    s_nop 0
    v_mfma_f32_16x16x32_bf16 v[80:83], v[40:43], a[204:207], v[80:83]
    s_add_u32 s56, s51, 442368
    buffer_load_dwordx4 a[40:43], v5, s[12:15], s56 offen offset:0 nt
    buffer_load_dwordx4 a[64:67], v5, s[12:15], s56 offen offset:1024 nt
    v_and_b32_dpp v44, v127, v28 row_newbcast:8 row_mask:0xf bank_mask:0xf
    v_and_b32_dpp v45, v127, v29 row_newbcast:8 row_mask:0xf bank_mask:0xf
    v_and_b32_dpp v46, v127, v30 row_newbcast:8 row_mask:0xf bank_mask:0xf
    v_and_b32_dpp v47, v127, v31 row_newbcast:8 row_mask:0xf bank_mask:0xf
    s_waitcnt vmcnt(17)
    s_nop 0
    v_mfma_f32_16x16x32_bf16 v[80:83], v[44:47], a[236:239], v[80:83]
    buffer_load_dwordx4 a[72:75], v5, s[12:15], s56 offen offset:2048 nt
    v_and_b32_dpp v40, v127, v28 row_newbcast:12 row_mask:0xf bank_mask:0xf
    v_and_b32_dpp v41, v127, v29 row_newbcast:12 row_mask:0xf bank_mask:0xf
    v_and_b32_dpp v42, v127, v30 row_newbcast:12 row_mask:0xf bank_mask:0xf
    v_and_b32_dpp v43, v127, v31 row_newbcast:12 row_mask:0xf bank_mask:0xf
    s_waitcnt vmcnt(17)
    s_nop 0
    v_mfma_f32_16x16x32_bf16 v[80:83], v[40:43], a[244:247], v[80:83]
    buffer_load_dwordx4 a[80:83], v5, s[12:15], s56 offen offset:3072 nt
    v_and_b32_dpp v44, v128, v28 row_newbcast:0 row_mask:0xf bank_mask:0xf
    v_and_b32_dpp v45, v128, v29 row_newbcast:0 row_mask:0xf bank_mask:0xf
    v_and_b32_dpp v46, v128, v30 row_newbcast:0 row_mask:0xf bank_mask:0xf
    v_and_b32_dpp v47, v128, v31 row_newbcast:0 row_mask:0xf bank_mask:0xf
    s_waitcnt vmcnt(17)
    s_nop 0
    v_mfma_f32_16x16x32_bf16 v[80:83], v[44:47], a[252:255], v[80:83]
    s_add_u32 s56, s51, 458752
    buffer_load_dwordx4 a[96:99], v5, s[12:15], s56 offen offset:0 nt
    v_and_b32_dpp v40, v128, v28 row_newbcast:4 row_mask:0xf bank_mask:0xf
    v_and_b32_dpp v41, v128, v29 row_newbcast:4 row_mask:0xf bank_mask:0xf
    v_and_b32_dpp v42, v128, v30 row_newbcast:4 row_mask:0xf bank_mask:0xf
    v_and_b32_dpp v43, v128, v31 row_newbcast:4 row_mask:0xf bank_mask:0xf
    s_waitcnt vmcnt(17)
    s_nop 0
    v_mfma_f32_16x16x32_bf16 v[80:83], v[40:43], v[168:171], v[80:83]
    buffer_load_dwordx4 a[112:115], v5, s[12:15], s56 offen offset:1024 nt
    buffer_load_dwordx4 a[120:123], v5, s[12:15], s56 offen offset:2048 nt
    v_and_b32_dpp v44, v128, v28 row_newbcast:8 row_mask:0xf bank_mask:0xf
    v_and_b32_dpp v45, v128, v29 row_newbcast:8 row_mask:0xf bank_mask:0xf
    v_and_b32_dpp v46, v128, v30 row_newbcast:8 row_mask:0xf bank_mask:0xf
    v_and_b32_dpp v47, v128, v31 row_newbcast:8 row_mask:0xf bank_mask:0xf
    s_waitcnt vmcnt(17)
    s_nop 0
    v_mfma_f32_16x16x32_bf16 v[80:83], v[44:47], v[192:195], v[80:83]
    buffer_load_dwordx4 a[136:139], v5, s[12:15], s56 offen offset:3072 nt
    v_and_b32_dpp v40, v128, v28 row_newbcast:12 row_mask:0xf bank_mask:0xf
    v_and_b32_dpp v41, v128, v29 row_newbcast:12 row_mask:0xf bank_mask:0xf
    v_and_b32_dpp v42, v128, v30 row_newbcast:12 row_mask:0xf bank_mask:0xf
    v_and_b32_dpp v43, v128, v31 row_newbcast:12 row_mask:0xf bank_mask:0xf
    s_waitcnt vmcnt(17)
    s_nop 0
    v_mfma_f32_16x16x32_bf16 v[80:83], v[40:43], v[208:211], v[80:83]
    s_add_u32 s56, s51, 475136
    buffer_load_dwordx4 a[152:155], v5, s[12:15], s56 offen offset:0 nt
    buffer_load_dwordx4 v[36:39], off, s[36:39], s62 sc1
    v_and_b32_dpp v44, v129, v28 row_newbcast:0 row_mask:0xf bank_mask:0xf
    v_and_b32_dpp v45, v129, v29 row_newbcast:0 row_mask:0xf bank_mask:0xf
    v_and_b32_dpp v46, v129, v30 row_newbcast:0 row_mask:0xf bank_mask:0xf
    v_and_b32_dpp v47, v129, v31 row_newbcast:0 row_mask:0xf bank_mask:0xf
    s_waitcnt vmcnt(18)
    s_nop 0
    v_mfma_f32_16x16x32_bf16 v[80:83], v[44:47], v[216:219], v[80:83]
    buffer_load_dwordx4 a[168:171], v5, s[12:15], s56 offen offset:1024 nt
    v_and_b32_dpp v40, v129, v28 row_newbcast:4 row_mask:0xf bank_mask:0xf
    v_and_b32_dpp v41, v129, v29 row_newbcast:4 row_mask:0xf bank_mask:0xf
    v_and_b32_dpp v42, v129, v30 row_newbcast:4 row_mask:0xf bank_mask:0xf
    v_and_b32_dpp v43, v129, v31 row_newbcast:4 row_mask:0xf bank_mask:0xf
    s_waitcnt vmcnt(18)
    s_nop 0
    v_mfma_f32_16x16x32_bf16 v[80:83], v[40:43], v[228:231], v[80:83]
    buffer_load_dwordx4 a[184:187], v5, s[12:15], s56 offen offset:2048 nt
    buffer_load_dwordx4 a[200:203], v5, s[12:15], s56 offen offset:3072 nt
    v_and_b32_dpp v44, v129, v28 row_newbcast:8 row_mask:0xf bank_mask:0xf
    v_and_b32_dpp v45, v129, v29 row_newbcast:8 row_mask:0xf bank_mask:0xf
    v_and_b32_dpp v46, v129, v30 row_newbcast:8 row_mask:0xf bank_mask:0xf
    v_and_b32_dpp v47, v129, v31 row_newbcast:8 row_mask:0xf bank_mask:0xf
    s_waitcnt vmcnt(18)
    s_nop 0
    v_mfma_f32_16x16x32_bf16 v[80:83], v[44:47], v[240:243], v[80:83]
    s_add_u32 s56, s51, 491520
    buffer_load_dwordx4 a[208:211], v5, s[12:15], s56 offen offset:0 nt
    v_and_b32_dpp v40, v129, v28 row_newbcast:12 row_mask:0xf bank_mask:0xf
    v_and_b32_dpp v41, v129, v29 row_newbcast:12 row_mask:0xf bank_mask:0xf
    v_and_b32_dpp v42, v129, v30 row_newbcast:12 row_mask:0xf bank_mask:0xf
    v_and_b32_dpp v43, v129, v31 row_newbcast:12 row_mask:0xf bank_mask:0xf
    s_waitcnt vmcnt(18)
    s_nop 0
    v_mfma_f32_16x16x32_bf16 v[80:83], v[40:43], v[244:247], v[80:83]
    buffer_load_dwordx4 a[232:235], v5, s[12:15], s56 offen offset:1024 nt
    v_and_b32_dpp v44, v130, v28 row_newbcast:0 row_mask:0xf bank_mask:0xf
    v_and_b32_dpp v45, v130, v29 row_newbcast:0 row_mask:0xf bank_mask:0xf
    v_and_b32_dpp v46, v130, v30 row_newbcast:0 row_mask:0xf bank_mask:0xf
    v_and_b32_dpp v47, v130, v31 row_newbcast:0 row_mask:0xf bank_mask:0xf
    s_waitcnt vmcnt(18)
    s_nop 0
    v_mfma_f32_16x16x32_bf16 v[80:83], v[44:47], v[252:255], v[80:83]
    buffer_load_dwordx4 a[248:251], v5, s[12:15], s56 offen offset:2048 nt
    v_and_b32_dpp v40, v130, v28 row_newbcast:4 row_mask:0xf bank_mask:0xf
    v_and_b32_dpp v41, v130, v29 row_newbcast:4 row_mask:0xf bank_mask:0xf
    v_and_b32_dpp v42, v130, v30 row_newbcast:4 row_mask:0xf bank_mask:0xf
    v_and_b32_dpp v43, v130, v31 row_newbcast:4 row_mask:0xf bank_mask:0xf
    s_waitcnt vmcnt(18)
    s_nop 0
    v_mfma_f32_16x16x32_bf16 v[80:83], v[40:43], a[16:19], v[80:83]
    buffer_load_dwordx4 v[164:167], v5, s[12:15], s56 offen offset:3072 nt
    v_and_b32_dpp v44, v130, v28 row_newbcast:8 row_mask:0xf bank_mask:0xf
    v_and_b32_dpp v45, v130, v29 row_newbcast:8 row_mask:0xf bank_mask:0xf
    v_and_b32_dpp v46, v130, v30 row_newbcast:8 row_mask:0xf bank_mask:0xf
    v_and_b32_dpp v47, v130, v31 row_newbcast:8 row_mask:0xf bank_mask:0xf
    s_waitcnt vmcnt(18)
    s_nop 0
    v_mfma_f32_16x16x32_bf16 v[80:83], v[44:47], a[24:27], v[80:83]
    s_add_u32 s56, s51, 507904
    buffer_load_dwordx4 v[172:175], v5, s[12:15], s56 offen offset:0 nt
    v_and_b32_dpp v40, v130, v28 row_newbcast:12 row_mask:0xf bank_mask:0xf
    v_and_b32_dpp v41, v130, v29 row_newbcast:12 row_mask:0xf bank_mask:0xf
    v_and_b32_dpp v42, v130, v30 row_newbcast:12 row_mask:0xf bank_mask:0xf
    v_and_b32_dpp v43, v130, v31 row_newbcast:12 row_mask:0xf bank_mask:0xf
    s_waitcnt vmcnt(18)
    s_nop 0
    v_mfma_f32_16x16x32_bf16 v[80:83], v[40:43], a[32:35], v[80:83]
    buffer_load_dwordx4 v[180:183], v5, s[12:15], s56 offen offset:1024 nt
    v_and_b32_dpp v44, v131, v28 row_newbcast:0 row_mask:0xf bank_mask:0xf
    v_and_b32_dpp v45, v131, v29 row_newbcast:0 row_mask:0xf bank_mask:0xf
    v_and_b32_dpp v46, v131, v30 row_newbcast:0 row_mask:0xf bank_mask:0xf
    v_and_b32_dpp v47, v131, v31 row_newbcast:0 row_mask:0xf bank_mask:0xf
    s_waitcnt vmcnt(18)
    s_nop 0
    v_mfma_f32_16x16x32_bf16 v[80:83], v[44:47], a[40:43], v[80:83]
    buffer_load_dwordx4 v[212:215], v5, s[12:15], s56 offen offset:2048 nt
    v_and_b32_dpp v40, v131, v28 row_newbcast:4 row_mask:0xf bank_mask:0xf
    v_and_b32_dpp v41, v131, v29 row_newbcast:4 row_mask:0xf bank_mask:0xf
    v_and_b32_dpp v42, v131, v30 row_newbcast:4 row_mask:0xf bank_mask:0xf
    v_and_b32_dpp v43, v131, v31 row_newbcast:4 row_mask:0xf bank_mask:0xf
    s_waitcnt vmcnt(18)
    s_nop 0
    v_mfma_f32_16x16x32_bf16 v[80:83], v[40:43], a[64:67], v[80:83]
    buffer_load_dwordx4 v[220:223], v5, s[12:15], s56 offen offset:3072 nt
    v_and_b32_dpp v44, v131, v28 row_newbcast:8 row_mask:0xf bank_mask:0xf
    v_and_b32_dpp v45, v131, v29 row_newbcast:8 row_mask:0xf bank_mask:0xf
    v_and_b32_dpp v46, v131, v30 row_newbcast:8 row_mask:0xf bank_mask:0xf
    v_and_b32_dpp v47, v131, v31 row_newbcast:8 row_mask:0xf bank_mask:0xf
    s_waitcnt vmcnt(18)
    s_nop 0
    v_mfma_f32_16x16x32_bf16 v[80:83], v[44:47], a[72:75], v[80:83]
    v_and_b32_dpp v40, v131, v28 row_newbcast:12 row_mask:0xf bank_mask:0xf
    v_and_b32_dpp v41, v131, v29 row_newbcast:12 row_mask:0xf bank_mask:0xf
    v_and_b32_dpp v42, v131, v30 row_newbcast:12 row_mask:0xf bank_mask:0xf
    v_and_b32_dpp v43, v131, v31 row_newbcast:12 row_mask:0xf bank_mask:0xf
    s_waitcnt vmcnt(17)
    s_nop 0
    v_mfma_f32_16x16x32_bf16 v[80:83], v[40:43], a[80:83], v[80:83]
    v_and_b32_dpp v44, v132, v28 row_newbcast:0 row_mask:0xf bank_mask:0xf
    v_and_b32_dpp v45, v132, v29 row_newbcast:0 row_mask:0xf bank_mask:0xf
    v_and_b32_dpp v46, v132, v30 row_newbcast:0 row_mask:0xf bank_mask:0xf
    v_and_b32_dpp v47, v132, v31 row_newbcast:0 row_mask:0xf bank_mask:0xf
    s_waitcnt vmcnt(16)
    s_nop 0
    v_mfma_f32_16x16x32_bf16 v[80:83], v[44:47], a[96:99], v[80:83]
    v_and_b32_dpp v40, v132, v28 row_newbcast:4 row_mask:0xf bank_mask:0xf
    v_and_b32_dpp v41, v132, v29 row_newbcast:4 row_mask:0xf bank_mask:0xf
    v_and_b32_dpp v42, v132, v30 row_newbcast:4 row_mask:0xf bank_mask:0xf
    v_and_b32_dpp v43, v132, v31 row_newbcast:4 row_mask:0xf bank_mask:0xf
    s_waitcnt vmcnt(15)
    s_nop 0
    v_mfma_f32_16x16x32_bf16 v[80:83], v[40:43], a[112:115], v[80:83]
    v_and_b32_dpp v44, v132, v28 row_newbcast:8 row_mask:0xf bank_mask:0xf
    v_and_b32_dpp v45, v132, v29 row_newbcast:8 row_mask:0xf bank_mask:0xf
    v_and_b32_dpp v46, v132, v30 row_newbcast:8 row_mask:0xf bank_mask:0xf
    v_and_b32_dpp v47, v132, v31 row_newbcast:8 row_mask:0xf bank_mask:0xf
    s_waitcnt vmcnt(14)
    s_nop 0
    v_mfma_f32_16x16x32_bf16 v[80:83], v[44:47], a[120:123], v[80:83]
    v_and_b32_dpp v40, v132, v28 row_newbcast:12 row_mask:0xf bank_mask:0xf
    v_and_b32_dpp v41, v132, v29 row_newbcast:12 row_mask:0xf bank_mask:0xf
    v_and_b32_dpp v42, v132, v30 row_newbcast:12 row_mask:0xf bank_mask:0xf
    v_and_b32_dpp v43, v132, v31 row_newbcast:12 row_mask:0xf bank_mask:0xf
    s_waitcnt vmcnt(13)
    s_nop 0
    v_mfma_f32_16x16x32_bf16 v[80:83], v[40:43], a[136:139], v[80:83]
    v_and_b32_dpp v44, v133, v28 row_newbcast:0 row_mask:0xf bank_mask:0xf
    v_and_b32_dpp v45, v133, v29 row_newbcast:0 row_mask:0xf bank_mask:0xf
    v_and_b32_dpp v46, v133, v30 row_newbcast:0 row_mask:0xf bank_mask:0xf
    v_and_b32_dpp v47, v133, v31 row_newbcast:0 row_mask:0xf bank_mask:0xf
    s_waitcnt vmcnt(12)
    s_nop 0
    v_mfma_f32_16x16x32_bf16 v[80:83], v[44:47], a[152:155], v[80:83]
    v_and_b32_dpp v40, v133, v28 row_newbcast:4 row_mask:0xf bank_mask:0xf
    v_and_b32_dpp v41, v133, v29 row_newbcast:4 row_mask:0xf bank_mask:0xf
    v_and_b32_dpp v42, v133, v30 row_newbcast:4 row_mask:0xf bank_mask:0xf
    v_and_b32_dpp v43, v133, v31 row_newbcast:4 row_mask:0xf bank_mask:0xf
    s_waitcnt vmcnt(10)
    s_nop 0
    v_mfma_f32_16x16x32_bf16 v[80:83], v[40:43], a[168:171], v[80:83]
    v_and_b32_dpp v44, v133, v28 row_newbcast:8 row_mask:0xf bank_mask:0xf
    v_and_b32_dpp v45, v133, v29 row_newbcast:8 row_mask:0xf bank_mask:0xf
    v_and_b32_dpp v46, v133, v30 row_newbcast:8 row_mask:0xf bank_mask:0xf
    v_and_b32_dpp v47, v133, v31 row_newbcast:8 row_mask:0xf bank_mask:0xf
    s_waitcnt vmcnt(9)
    s_nop 0
    v_mfma_f32_16x16x32_bf16 v[80:83], v[44:47], a[184:187], v[80:83]
    v_and_b32_dpp v40, v133, v28 row_newbcast:12 row_mask:0xf bank_mask:0xf
    v_and_b32_dpp v41, v133, v29 row_newbcast:12 row_mask:0xf bank_mask:0xf
    v_and_b32_dpp v42, v133, v30 row_newbcast:12 row_mask:0xf bank_mask:0xf
    v_and_b32_dpp v43, v133, v31 row_newbcast:12 row_mask:0xf bank_mask:0xf
    s_waitcnt vmcnt(8)
    s_nop 0
    v_mfma_f32_16x16x32_bf16 v[80:83], v[40:43], a[200:203], v[80:83]
    v_and_b32_dpp v44, v134, v28 row_newbcast:0 row_mask:0xf bank_mask:0xf
    v_and_b32_dpp v45, v134, v29 row_newbcast:0 row_mask:0xf bank_mask:0xf
    v_and_b32_dpp v46, v134, v30 row_newbcast:0 row_mask:0xf bank_mask:0xf
    v_and_b32_dpp v47, v134, v31 row_newbcast:0 row_mask:0xf bank_mask:0xf
    s_waitcnt vmcnt(7)
    s_nop 0
    v_mfma_f32_16x16x32_bf16 v[80:83], v[44:47], a[208:211], v[80:83]
    v_and_b32_dpp v40, v134, v28 row_newbcast:4 row_mask:0xf bank_mask:0xf
    v_and_b32_dpp v41, v134, v29 row_newbcast:4 row_mask:0xf bank_mask:0xf
    v_and_b32_dpp v42, v134, v30 row_newbcast:4 row_mask:0xf bank_mask:0xf
    v_and_b32_dpp v43, v134, v31 row_newbcast:4 row_mask:0xf bank_mask:0xf
    s_waitcnt vmcnt(6)
    s_nop 0
    v_mfma_f32_16x16x32_bf16 v[80:83], v[40:43], a[232:235], v[80:83]
    v_and_b32_dpp v44, v134, v28 row_newbcast:8 row_mask:0xf bank_mask:0xf
    v_and_b32_dpp v45, v134, v29 row_newbcast:8 row_mask:0xf bank_mask:0xf
    v_and_b32_dpp v46, v134, v30 row_newbcast:8 row_mask:0xf bank_mask:0xf
    v_and_b32_dpp v47, v134, v31 row_newbcast:8 row_mask:0xf bank_mask:0xf
    s_waitcnt vmcnt(5)
    s_nop 0
    v_mfma_f32_16x16x32_bf16 v[80:83], v[44:47], a[248:251], v[80:83]
    v_and_b32_dpp v40, v134, v28 row_newbcast:12 row_mask:0xf bank_mask:0xf
    v_and_b32_dpp v41, v134, v29 row_newbcast:12 row_mask:0xf bank_mask:0xf
    v_and_b32_dpp v42, v134, v30 row_newbcast:12 row_mask:0xf bank_mask:0xf
    v_and_b32_dpp v43, v134, v31 row_newbcast:12 row_mask:0xf bank_mask:0xf
    s_waitcnt vmcnt(4)
    s_nop 0
    v_mfma_f32_16x16x32_bf16 v[80:83], v[40:43], v[164:167], v[80:83]
    v_cmp_ne_u64 vcc, s[44:45], v[38:39]
    s_mov_b32 s66, 0
    s_cmp_eq_u64 vcc, 0
    s_cbranch_scc1 L_mlok_c
L_mlwait_c:
    buffer_load_dwordx4 v[36:39], off, s[36:39], s62 sc1
    s_add_u32 s66, s66, 1
    s_waitcnt vmcnt(0)
    v_cmp_ne_u64 vcc, s[44:45], v[38:39]
    s_cmp_gt_u32 s66, 0x200000
    s_cbranch_scc1 L_mlok_c
    s_cmp_lg_u64 vcc, 0
    s_cbranch_scc1 L_mlwait_c
L_mlok_c:
    v_max_f32 v16, v36, v13
    v_sub_f32 v36, v36, v16
    v_sub_f32 v38, v13, v16
    v_mul_f32 v36, s60, v36
    v_mul_f32 v38, s60, v38
    v_exp_f32 v36, v36
    v_exp_f32 v38, v38
    v_mul_f32 v16, v36, v37
    v_fmac_f32 v16, v38, v15
    v_rcp_f32 v16, v16
    v_lshlrev_b32 v18, 16, v18
    v_mul_f32 v16, v16, v38
    v_and_b32_dpp v44, v135, v28 row_newbcast:0 row_mask:0xf bank_mask:0xf
    v_and_b32_dpp v45, v135, v29 row_newbcast:0 row_mask:0xf bank_mask:0xf
    v_and_b32_dpp v46, v135, v30 row_newbcast:0 row_mask:0xf bank_mask:0xf
    v_and_b32_dpp v47, v135, v31 row_newbcast:0 row_mask:0xf bank_mask:0xf
    s_waitcnt vmcnt(3)
    s_nop 0
    v_mfma_f32_16x16x32_bf16 v[80:83], v[44:47], v[172:175], v[80:83]
    v_and_b32_dpp v40, v135, v28 row_newbcast:4 row_mask:0xf bank_mask:0xf
    v_and_b32_dpp v41, v135, v29 row_newbcast:4 row_mask:0xf bank_mask:0xf
    v_and_b32_dpp v42, v135, v30 row_newbcast:4 row_mask:0xf bank_mask:0xf
    v_and_b32_dpp v43, v135, v31 row_newbcast:4 row_mask:0xf bank_mask:0xf
    s_waitcnt vmcnt(2)
    s_nop 0
    v_mfma_f32_16x16x32_bf16 v[80:83], v[40:43], v[180:183], v[80:83]
    v_and_b32_dpp v44, v135, v28 row_newbcast:8 row_mask:0xf bank_mask:0xf
    v_and_b32_dpp v45, v135, v29 row_newbcast:8 row_mask:0xf bank_mask:0xf
    v_and_b32_dpp v46, v135, v30 row_newbcast:8 row_mask:0xf bank_mask:0xf
    v_and_b32_dpp v47, v135, v31 row_newbcast:8 row_mask:0xf bank_mask:0xf
    s_waitcnt vmcnt(1)
    s_nop 0
    v_mfma_f32_16x16x32_bf16 v[80:83], v[44:47], v[212:215], v[80:83]
    v_and_b32_dpp v40, v135, v28 row_newbcast:12 row_mask:0xf bank_mask:0xf
    v_and_b32_dpp v41, v135, v29 row_newbcast:12 row_mask:0xf bank_mask:0xf
    v_and_b32_dpp v42, v135, v30 row_newbcast:12 row_mask:0xf bank_mask:0xf
    v_and_b32_dpp v43, v135, v31 row_newbcast:12 row_mask:0xf bank_mask:0xf
    s_waitcnt vmcnt(0)
    s_nop 0
    v_mfma_f32_16x16x32_bf16 v[80:83], v[40:43], v[220:223], v[80:83]
    s_mov_b32 exec_hi, 0
    s_nop 6
    ds_write_b128 v10, v[80:83] offset:8448
    s_mov_b32 exec_hi, -1
    s_waitcnt lgkmcnt(0)
    s_barrier
    ds_read2_b32 v[36:37], v11 offset0:0 offset1:128
    s_waitcnt lgkmcnt(0)
    v_add_f32 v36, v36, v37
    v_mul_f32 v36, v36, v16
    s_nop 1
    v_add_f32_dpp v36, v36, v36 row_ror:8 row_mask:0xf bank_mask:0xf
    v_cvt_pk_bf16_f32 v36, v36, v36
    s_nop 1
    v_and_b32_dpp v104, v36, v28 row_newbcast:0 row_mask:0xf bank_mask:0xf
    v_and_b32_dpp v105, v36, v29 row_newbcast:0 row_mask:0xf bank_mask:0xf
    v_and_b32_dpp v106, v36, v30 row_newbcast:0 row_mask:0xf bank_mask:0xf
    v_and_b32_dpp v107, v36, v31 row_newbcast:0 row_mask:0xf bank_mask:0xf
    s_nop 1
    v_mfma_f32_16x16x32_bf16 v[84:87], v[104:107], a[128:131], 0
    v_and_b32_dpp v108, v36, v28 row_newbcast:1 row_mask:0xf bank_mask:0xf
    v_and_b32_dpp v109, v36, v29 row_newbcast:1 row_mask:0xf bank_mask:0xf
    v_mfma_f32_16x16x32_bf16 v[88:91], v[104:107], a[176:179], 0
    v_and_b32_dpp v110, v36, v30 row_newbcast:1 row_mask:0xf bank_mask:0xf
    v_and_b32_dpp v111, v36, v31 row_newbcast:1 row_mask:0xf bank_mask:0xf
    v_mfma_f32_16x16x32_bf16 v[92:95], v[104:107], a[216:219], 0
    s_nop 0
    v_mfma_f32_16x16x32_bf16 v[84:87], v[108:111], a[12:15], v[84:87]
    v_and_b32_dpp v112, v36, v28 row_newbcast:2 row_mask:0xf bank_mask:0xf
    v_and_b32_dpp v113, v36, v29 row_newbcast:2 row_mask:0xf bank_mask:0xf
    v_mfma_f32_16x16x32_bf16 v[88:91], v[108:111], a[52:55], v[88:91]
    v_and_b32_dpp v114, v36, v30 row_newbcast:2 row_mask:0xf bank_mask:0xf
    v_and_b32_dpp v115, v36, v31 row_newbcast:2 row_mask:0xf bank_mask:0xf
    v_mfma_f32_16x16x32_bf16 v[92:95], v[108:111], a[92:95], v[92:95]
    s_nop 0
    v_mfma_f32_16x16x32_bf16 v[84:87], v[112:115], a[220:223], v[84:87]
    v_and_b32_dpp v116, v36, v28 row_newbcast:3 row_mask:0xf bank_mask:0xf
    v_and_b32_dpp v117, v36, v29 row_newbcast:3 row_mask:0xf bank_mask:0xf
    v_mfma_f32_16x16x32_bf16 v[88:91], v[112:115], v[160:163], v[88:91]
    v_and_b32_dpp v118, v36, v30 row_newbcast:3 row_mask:0xf bank_mask:0xf
    v_and_b32_dpp v119, v36, v31 row_newbcast:3 row_mask:0xf bank_mask:0xf
    v_mfma_f32_16x16x32_bf16 v[92:95], v[112:115], v[200:203], v[92:95]
    s_nop 0
    v_mfma_f32_16x16x32_bf16 v[84:87], v[116:119], a[48:51], v[84:87]
    v_and_b32_dpp v120, v36, v28 row_newbcast:4 row_mask:0xf bank_mask:0xf
    v_and_b32_dpp v121, v36, v29 row_newbcast:4 row_mask:0xf bank_mask:0xf
    v_mfma_f32_16x16x32_bf16 v[88:91], v[116:119], a[88:91], v[88:91]
    v_and_b32_dpp v122, v36, v30 row_newbcast:4 row_mask:0xf bank_mask:0xf
    v_and_b32_dpp v123, v36, v31 row_newbcast:4 row_mask:0xf bank_mask:0xf
    v_mfma_f32_16x16x32_bf16 v[92:95], v[116:119], a[144:147], v[92:95]
    s_nop 0
    v_mfma_f32_16x16x32_bf16 v[84:87], v[120:123], v[188:191], v[84:87]
    v_and_b32_dpp v124, v36, v28 row_newbcast:5 row_mask:0xf bank_mask:0xf
    v_and_b32_dpp v125, v36, v29 row_newbcast:5 row_mask:0xf bank_mask:0xf
    v_mfma_f32_16x16x32_bf16 v[88:91], v[120:123], a[20:23], v[88:91]
    v_and_b32_dpp v126, v36, v30 row_newbcast:5 row_mask:0xf bank_mask:0xf
    v_and_b32_dpp v127, v36, v31 row_newbcast:5 row_mask:0xf bank_mask:0xf
    v_mfma_f32_16x16x32_bf16 v[92:95], v[120:123], a[68:71], v[92:95]
    s_nop 0
    v_mfma_f32_16x16x32_bf16 v[84:87], v[124:127], a[228:231], v[84:87]
    v_and_b32_dpp v128, v36, v28 row_newbcast:6 row_mask:0xf bank_mask:0xf
    v_and_b32_dpp v129, v36, v29 row_newbcast:6 row_mask:0xf bank_mask:0xf
    v_mfma_f32_16x16x32_bf16 v[88:91], v[124:127], v[176:179], v[88:91]
    v_and_b32_dpp v130, v36, v30 row_newbcast:6 row_mask:0xf bank_mask:0xf
    v_and_b32_dpp v131, v36, v31 row_newbcast:6 row_mask:0xf bank_mask:0xf
    v_mfma_f32_16x16x32_bf16 v[92:95], v[124:127], v[224:227], v[92:95]
    s_nop 0
    v_mfma_f32_16x16x32_bf16 v[84:87], v[128:131], a[104:107], v[84:87]
    v_and_b32_dpp v132, v36, v28 row_newbcast:7 row_mask:0xf bank_mask:0xf
    v_and_b32_dpp v133, v36, v29 row_newbcast:7 row_mask:0xf bank_mask:0xf
    v_mfma_f32_16x16x32_bf16 v[88:91], v[128:131], a[160:163], v[88:91]
    v_and_b32_dpp v134, v36, v30 row_newbcast:7 row_mask:0xf bank_mask:0xf
    v_and_b32_dpp v135, v36, v31 row_newbcast:7 row_mask:0xf bank_mask:0xf
    v_mfma_f32_16x16x32_bf16 v[92:95], v[128:131], a[224:227], v[92:95]
    s_nop 0
    v_mfma_f32_16x16x32_bf16 v[84:87], v[132:135], a[84:87], v[84:87]
    v_mfma_f32_16x16x32_bf16 v[88:91], v[132:135], a[148:151], v[88:91]
    v_mfma_f32_16x16x32_bf16 v[92:95], v[132:135], a[212:215], v[92:95]
    v_mfma_f32_16x16x32_bf16 v[96:99], v[104:107], v[156:159], 0
    v_mfma_f32_16x16x32_bf16 v[96:99], v[108:111], a[132:135], v[96:99]
    v_mfma_f32_16x16x32_bf16 v[96:99], v[112:115], v[236:239], v[96:99]
    v_mfma_f32_16x16x32_bf16 v[96:99], v[116:119], a[192:195], v[96:99]
    v_mfma_f32_16x16x32_bf16 v[96:99], v[120:123], a[116:119], v[96:99]
    v_mfma_f32_16x16x32_bf16 v[96:99], v[124:127], v[248:251], v[96:99]
    v_mfma_f32_16x16x32_bf16 v[96:99], v[128:131], v[204:207], v[96:99]
    ds_write_b128 v21, v[84:87] offset:11520
    v_mfma_f32_16x16x32_bf16 v[96:99], v[132:135], v[184:187], v[96:99]
    ds_write_b128 v21, v[88:91] offset:12032
    v_mfma_f32_16x16x32_bf16 v[100:103], v[104:107], v[196:199], 0
    ds_write_b128 v21, v[92:95] offset:12544
    v_mfma_f32_16x16x32_bf16 v[100:103], v[108:111], a[180:183], v[100:103]
    v_mfma_f32_16x16x32_bf16 v[100:103], v[112:115], a[8:11], v[100:103]
    v_mfma_f32_16x16x32_bf16 v[100:103], v[116:119], a[240:243], v[100:103]
    v_mfma_f32_16x16x32_bf16 v[100:103], v[120:123], a[164:167], v[100:103]
    v_mfma_f32_16x16x32_bf16 v[100:103], v[124:127], a[56:59], v[100:103]
    v_mfma_f32_16x16x32_bf16 v[100:103], v[128:131], a[28:31], v[100:103]
    v_mfma_f32_16x16x32_bf16 v[100:103], v[132:135], v[232:235], v[100:103]
    ds_write_b128 v21, v[96:99] offset:13056
    s_nop 6
    ds_write_b128 v21, v[100:103] offset:13568
    s_mov_b32 exec_hi, 0xff
    s_waitcnt lgkmcnt(0)
    s_barrier
    ds_read_b128 v[104:107], v22 offset:11520
    ds_read_b128 v[108:111], v22 offset:14080
    ds_read_b128 v[112:115], v22 offset:16640
    ds_read_b128 v[116:119], v22 offset:19200
    s_waitcnt lgkmcnt(2)
    v_pk_add_f32 v[104:105], v[104:105], v[108:109]
    v_pk_add_f32 v[106:107], v[106:107], v[110:111]
    s_waitcnt lgkmcnt(0)
    v_pk_add_f32 v[112:113], v[112:113], v[116:117]
    v_pk_add_f32 v[114:115], v[114:115], v[118:119]
    v_pk_add_f32 v[104:105], v[104:105], v[112:113]
    v_pk_add_f32 v[106:107], v[106:107], v[114:115]
    v_add_u32 v104, 0x800, v104
    v_add_u32 v105, 0x800, v105
    v_add_u32 v106, 0x800, v106
    v_add_u32 v107, 0x800, v107
    v_bfi_b32 v104, v144, s92, v104
    v_bfi_b32 v105, v144, s93, v105
    v_bfi_b32 v106, v144, s94, v106
    v_bfi_b32 v107, v144, s95, v107
    buffer_store_dwordx4 v[104:107], v5, s[36:39], s61 offen sc1
    s_mov_b32 exec_hi, -1
    s_cmp_ge_u32 s63, 40
    s_cbranch_scc1 L_fin_done_c
    s_mov_b32 s66, 0
    s_branch L_zload_c
L_zwait_c:
L_zload_c:
    buffer_load_dwordx4 v[84:87], v24, s[36:39], s65 offen sc1
    s_add_u32 s66, s66, 1
    s_waitcnt vmcnt(0)
    v_xor_b32 v84, s92, v84
    v_xor_b32 v85, s93, v85
    v_xor_b32 v86, s94, v86
    v_xor_b32 v87, s95, v87
    v_or3_b32 v88, v84, v85, v86
    v_or_b32 v88, v88, v87
    v_and_b32 v88, v88, v144
    v_cmp_ne_u32 vcc, 0, v88
    s_cmp_gt_u32 s66, 0x200000
    s_cbranch_scc1 L_polled_c
    s_and_b64 exec, exec, vcc
    s_cbranch_scc1 L_zwait_c
L_polled_c:
    s_mov_b64 exec, -1
    v_add_f32_dpp v84, v84, v84 row_ror:4 row_mask:0xf bank_mask:0xf
    v_add_f32_dpp v85, v85, v85 row_ror:4 row_mask:0xf bank_mask:0xf
    v_add_f32_dpp v86, v86, v86 row_ror:4 row_mask:0xf bank_mask:0xf
    v_add_f32_dpp v87, v87, v87 row_ror:4 row_mask:0xf bank_mask:0xf
    v_add_f32_dpp v84, v84, v84 row_ror:8 row_mask:0xf bank_mask:0xf
    v_add_f32_dpp v85, v85, v85 row_ror:8 row_mask:0xf bank_mask:0xf
    v_add_f32_dpp v86, v86, v86 row_ror:8 row_mask:0xf bank_mask:0xf
    v_add_f32_dpp v87, v87, v87 row_ror:8 row_mask:0xf bank_mask:0xf
    ds_write_b128 v25, v[84:87] offset:10496
    s_waitcnt lgkmcnt(0)
    s_barrier
    s_cmp_lg_u32 s46, 0
    s_cbranch_scc1 L_fin_done_c
    ds_read2_b32 v[84:85], v26 offset0:0 offset1:16
    ds_read2_b32 v[86:87], v26 offset0:32 offset1:48
    s_waitcnt lgkmcnt(0)
    v_pk_add_f32 v[84:85], v[84:85], v[86:87]
    v_add_f32 v84, v84, v85
    v_mov_b32 v85, v84
    s_nop 1
    v_permlane32_swap_b32 v84, v85
    v_add_f32 v84, v84, v85
    v_mov_b32 v85, v84
    s_nop 1
    v_permlane16_swap_b32 v84, v85
    v_add_f32 v84, v84, v85
    v_add_f32 v84, v84, v18
    v_cvt_pk_bf16_f32 v84, v84, v84
    s_mov_b64 exec, 0xffff
    buffer_store_short v84, v17, s[40:43], s64 offen
    s_cmp_lg_u32 s63, 0
    s_cbranch_scc1 L_fin_done_c
    s_mov_b64 exec, 1
    buffer_store_dwordx2 v[142:143], off, s[36:39], s67 sc1
L_fin_done_c:
    s_endpgm
.section .rodata,"a"
.p2align 6
.amdhsa_kernel parallel_sum__mha_block_cached__swiglu_ffn__decode_kernel
  .amdhsa_next_free_vgpr 512
  .amdhsa_next_free_sgpr 96
  .amdhsa_accum_offset 256
  .amdhsa_group_segment_fixed_size 0
  .amdhsa_kernarg_size 96
  .amdhsa_user_sgpr_count 2
  .amdhsa_user_sgpr_kernarg_segment_ptr 1
  .amdhsa_system_sgpr_workgroup_id_x 1
  .amdhsa_float_denorm_mode_32 3
.end_amdhsa_kernel
```
